```python
import torch

def _softmax(x, axis=-1):
    return torch.softmax(x, dim=axis)
def _gelu(x):
    return torch.nn.functional.gelu(x, approximate="tanh")
def _silu(x):
    return torch.nn.functional.silu(x)
def _sigmoid(x):
    return torch.sigmoid(x)
def _layernorm(x, axis=-1, eps=1e-5):
    m = x.mean(dim=axis, keepdim=True)
    v = x.var(dim=axis, keepdim=True, unbiased=False)
    return (x - m) / torch.sqrt(v + eps)
def _scatter_add(tgt, idx, src, axis=0):
    return tgt.clone().index_add_(axis, idx, src)
def _segment_sum(src, seg, n):
    out = torch.zeros((n,) + src.shape[1:], dtype=src.dtype)
    return out.index_add_(0, seg, src)
def _pad(x, pw):
    flat = tuple(v for pair in reversed(pw) for v in pair)
    return torch.nn.functional.pad(x, flat)

kernel_name = 'sequential_preLN__sliding_block__mixer_channel_mlp__prompt'

def setup_inputs():

    _w = (lambda a: (lambda t: t.to(torch.bfloat16) if t.is_floating_point() else t)(torch.as_tensor(a)))
    def _A_setup():
        B, S, D = 1, 2048, 640
        return {
            "x": _w((lambda *s: torch.randn(*s, dtype=torch.bfloat16) * 0.05)(B, S, D)),
            "wqkv": _w((lambda *s: torch.randn(*s, dtype=torch.bfloat16) * 0.05)(D, 3 * D)),
            "wo": _w((lambda *s: torch.randn(*s, dtype=torch.bfloat16) * 0.05)(D, D)),
        }
    _A_in = _A_setup()

    def _B_setup():
        B, S, D, F = 1, 2048, 640, 1536
        return {
            "x": _w((lambda *s: torch.randn(*s, dtype=torch.bfloat16) * 0.05)(B, S, D)),
            "w1": _w((lambda *s: torch.randn(*s, dtype=torch.bfloat16) * 3.2)(D, F) * (D ** -0.5)),
            "b1": _w((lambda *s: torch.randn(*s, dtype=torch.bfloat16) * 1.6)(F)),
            "w2": _w((lambda *s: torch.randn(*s, dtype=torch.bfloat16) * 0.2)(F, D) * (F ** -0.5)),
            "b2": _w((lambda *s: torch.randn(*s, dtype=torch.bfloat16) * 0.4)(D)),
        }
    _B_in = _B_setup()

    return {
        "A_x": _A_in["x"],
        "A_wqkv": _A_in["wqkv"],
        "A_wo": _A_in["wo"],
        "B_x": _B_in["x"],
        "B_w1": _B_in["w1"],
        "B_b1": _B_in["b1"],
        "B_w2": _B_in["w2"],
        "B_b2": _B_in["b2"],
    }

def reference(A_x, A_wqkv, A_wo, B_x, B_w1, B_b1, B_w2, B_b2):
    def _A_ref(x, wqkv, wo):
        B, S, D = x.shape
        H = 32; Dh = D // H; W = 256
        qkv = (lambda x, *d: x.permute(*d))((x @ wqkv).reshape(B, S, 3, H, Dh), 2, 0, 3, 1, 4)
        q, k, v = qkv[0], qkv[1], qkv[2]
        scores = torch.einsum("bhqd,bhkd->bhqk", q, k) * (Dh ** -0.5)
        idx = torch.arange(S)
        mask = (idx[:, None] - idx[None, :] >= 0) & (idx[:, None] - idx[None, :] < W)
        scores = torch.where(mask[None, None], scores, -1e9)
        p = _softmax(scores, axis=-1)
        o = torch.einsum("bhqk,bhkd->bhqd", p, v)
        return (lambda x, *d: x.permute(*d))(o, 0, 2, 1, 3).reshape(B, S, D) @ wo

    def _B_ref(x, w1, b1, w2, b2):
        y = _layernorm(x, axis=-1)
        h = _gelu(torch.einsum("bsd,df->bsf", y, w1) + b1)
        return torch.einsum("bsf,fd->bsd", h, w2) + b2

    x = A_x
    h = x + _A_ref(_layernorm(x, axis=-1), A_wqkv, A_wo)
    h2 = h + _B_ref(_layernorm(h, axis=-1), B_w1, B_b1, B_w2, B_b2)
    return h2
```

```asm
; @launch grid=(256,1,1) block=(512,1,1) lds=163840
.amdgcn_target "amdgcn-amd-amdhsa--gfx950"
.text
.globl sequential_preLN__sliding_block__mixer_channel_mlp__prompt_kernel
.p2align 8
.type sequential_preLN__sliding_block__mixer_channel_mlp__prompt_kernel,@function
sequential_preLN__sliding_block__mixer_channel_mlp__prompt_kernel:
    s_cmp_ge_u32 s2, 256
    s_cbranch_scc1 L_exit
    s_load_dwordx16 s[48:63], s[0:1], 0
    s_load_dwordx4 s[64:67], s[0:1], 64
    s_load_dwordx2 s[68:69], s[0:1], 80
    v_lshrrev_b32 v1, 6, v0
    v_and_b32 v0, 63, v0
    v_readfirstlane_b32 s40, v1
    s_and_b32 s41, s2, 7
    s_getreg_b32 s3, hwreg(HW_REG_XCC_ID, 0, 4)
    s_lshr_b32 s42, s2, 3
    s_and_b32 s46, s40, 3
    s_lshl_b32 s47, s42, 2
    s_add_u32 s47, s47, s46
    s_cmp_ge_u32 s42, 15
    s_cselect_b32 s43, 1, 0
    s_cselect_b32 s44, 15, 0
    s_sub_u32 s44, s42, s44
    s_cmp_ge_u32 s42, 30
    s_cbranch_scc0 L_nospare_1
    s_sub_u32 s43, s42, 30
    s_mov_b32 s44, 15
L_nospare_1:
    s_lshl_b32 s73, s41, 1
    s_add_u32 s43, s43, s73
    s_waitcnt lgkmcnt(0)
    s_load_dword s72, s[68:69], 20480
    s_mov_b32 s4, s48
    s_and_b32 s5, s49, 0xffff
    s_mov_b32 s6, 2621440
    s_mov_b32 s7, 0x00020000
    s_mov_b32 s8, s50
    s_and_b32 s9, s51, 0xffff
    s_mov_b32 s10, 2457600
    s_mov_b32 s11, 0x00020000
    s_mov_b32 s12, s52
    s_and_b32 s13, s53, 0xffff
    s_mov_b32 s14, 819200
    s_mov_b32 s15, 0x00020000
    s_mov_b32 s16, s56
    s_and_b32 s17, s57, 0xffff
    s_mov_b32 s18, 1966080
    s_mov_b32 s19, 0x00020000
    s_mov_b32 s32, s58
    s_and_b32 s33, s59, 0xffff
    s_mov_b32 s34, 3072
    s_mov_b32 s35, 0x00020000
    s_mov_b32 s20, s60
    s_and_b32 s21, s61, 0xffff
    s_mov_b32 s22, 1966080
    s_mov_b32 s23, 0x00020000
    s_mov_b32 s36, s62
    s_and_b32 s37, s63, 0xffff
    s_mov_b32 s38, 1280
    s_mov_b32 s39, 0x00020000
    s_mov_b32 s28, s64
    s_and_b32 s29, s65, 0xffff
    s_mov_b32 s30, 2621440
    s_mov_b32 s31, 0x00020000
    s_mov_b32 s24, s68
    s_and_b32 s25, s69, 0xffff
    s_mov_b32 s26, 25559040
    s_mov_b32 s27, 0x00020000
    s_mov_b32 s57, 0x3f803f80
    s_cmp_ge_u32 s40, 4
    s_cbranch_scc1 L_s1_l
    s_cmp_eq_u32 s44, 15
    s_cbranch_scc1 L_s1_spare_c
    v_lshrrev_b32 v1, 5, v0
    v_mul_u32_u24 v1, 0x500, v1
    v_and_b32 v32, 31, v0
    v_lshl_add_u32 v1, v32, 3, v1
    s_lshl_b32 s48, s41, 8
    s_lshl_b32 s49, s47, 1
    s_add_u32 s48, s48, s49
    s_mul_i32 s49, s48, 1280
    buffer_load_dwordx2 v[2:3], v1, s[4:7], s49 offen offset:0
    buffer_load_dwordx2 v[4:5], v1, s[4:7], s49 offen offset:256
    buffer_load_dwordx2 v[6:7], v1, s[4:7], s49 offen offset:512
    buffer_load_dwordx2 v[8:9], v1, s[4:7], s49 offen offset:768
    buffer_load_dwordx2 v[10:11], v1, s[4:7], s49 offen offset:1024
    s_waitcnt vmcnt(0)
    v_lshlrev_b32 v12, 16, v2
    v_and_b32 v13, 0xffff0000, v2
    v_lshlrev_b32 v14, 16, v3
    v_and_b32 v15, 0xffff0000, v3
    v_lshlrev_b32 v16, 16, v4
    v_and_b32 v17, 0xffff0000, v4
    v_lshlrev_b32 v18, 16, v5
    v_and_b32 v19, 0xffff0000, v5
    v_lshlrev_b32 v20, 16, v6
    v_and_b32 v21, 0xffff0000, v6
    v_lshlrev_b32 v22, 16, v7
    v_and_b32 v23, 0xffff0000, v7
    v_lshlrev_b32 v24, 16, v8
    v_and_b32 v25, 0xffff0000, v8
    v_lshlrev_b32 v26, 16, v9
    v_and_b32 v27, 0xffff0000, v9
    v_lshlrev_b32 v28, 16, v10
    v_and_b32 v29, 0xffff0000, v10
    v_lshlrev_b32 v30, 16, v11
    v_and_b32 v31, 0xffff0000, v11
    v_add_f32 v33, v12, v13
    v_add_f32 v33, v33, v14
    v_add_f32 v33, v33, v15
    v_add_f32 v33, v33, v16
    v_add_f32 v33, v33, v17
    v_add_f32 v33, v33, v18
    v_add_f32 v33, v33, v19
    v_add_f32 v33, v33, v20
    v_add_f32 v33, v33, v21
    v_add_f32 v33, v33, v22
    v_add_f32 v33, v33, v23
    v_add_f32 v33, v33, v24
    v_add_f32 v33, v33, v25
    v_add_f32 v33, v33, v26
    v_add_f32 v33, v33, v27
    v_add_f32 v33, v33, v28
    v_add_f32 v33, v33, v29
    v_add_f32 v33, v33, v30
    v_add_f32 v33, v33, v31
    s_nop 1
    v_add_f32_dpp v33, v33, v33 row_ror:8 row_mask:0xf bank_mask:0xf
    s_nop 1
    v_add_f32_dpp v33, v33, v33 row_ror:4 row_mask:0xf bank_mask:0xf
    s_nop 1
    v_add_f32_dpp v33, v33, v33 row_ror:2 row_mask:0xf bank_mask:0xf
    s_nop 1
    v_add_f32_dpp v33, v33, v33 row_ror:1 row_mask:0xf bank_mask:0xf
    v_mov_b32 v1, v33
    s_nop 1
    v_permlane16_swap_b32 v1, v33
    v_add_f32 v33, v33, v1
    v_mul_f32 v33, 0x3acccccd, v33
    v_sub_f32 v12, v12, v33
    v_mul_f32 v34, v12, v12
    v_sub_f32 v13, v13, v33
    v_fmac_f32 v34, v13, v13
    v_sub_f32 v14, v14, v33
    v_fmac_f32 v34, v14, v14
    v_sub_f32 v15, v15, v33
    v_fmac_f32 v34, v15, v15
    v_sub_f32 v16, v16, v33
    v_fmac_f32 v34, v16, v16
    v_sub_f32 v17, v17, v33
    v_fmac_f32 v34, v17, v17
    v_sub_f32 v18, v18, v33
    v_fmac_f32 v34, v18, v18
    v_sub_f32 v19, v19, v33
    v_fmac_f32 v34, v19, v19
    v_sub_f32 v20, v20, v33
    v_fmac_f32 v34, v20, v20
    v_sub_f32 v21, v21, v33
    v_fmac_f32 v34, v21, v21
    v_sub_f32 v22, v22, v33
    v_fmac_f32 v34, v22, v22
    v_sub_f32 v23, v23, v33
    v_fmac_f32 v34, v23, v23
    v_sub_f32 v24, v24, v33
    v_fmac_f32 v34, v24, v24
    v_sub_f32 v25, v25, v33
    v_fmac_f32 v34, v25, v25
    v_sub_f32 v26, v26, v33
    v_fmac_f32 v34, v26, v26
    v_sub_f32 v27, v27, v33
    v_fmac_f32 v34, v27, v27
    v_sub_f32 v28, v28, v33
    v_fmac_f32 v34, v28, v28
    v_sub_f32 v29, v29, v33
    v_fmac_f32 v34, v29, v29
    v_sub_f32 v30, v30, v33
    v_fmac_f32 v34, v30, v30
    v_sub_f32 v31, v31, v33
    v_fmac_f32 v34, v31, v31
    s_nop 1
    v_add_f32_dpp v34, v34, v34 row_ror:8 row_mask:0xf bank_mask:0xf
    s_nop 1
    v_add_f32_dpp v34, v34, v34 row_ror:4 row_mask:0xf bank_mask:0xf
    s_nop 1
    v_add_f32_dpp v34, v34, v34 row_ror:2 row_mask:0xf bank_mask:0xf
    s_nop 1
    v_add_f32_dpp v34, v34, v34 row_ror:1 row_mask:0xf bank_mask:0xf
    v_mov_b32 v1, v34
    s_nop 1
    v_permlane16_swap_b32 v1, v34
    v_add_f32 v34, v34, v1
    v_mov_b32 v32, 0x3727c5ac
    v_fmac_f32 v32, 0x3acccccd, v34
    v_rsq_f32 v36, v32
    s_nop 0
    v_mul_f32 v37, v33, v36
    v_sub_f32 v37, 0, v37
    v_lshrrev_b32 v1, 5, v0
    v_lshlrev_b32 v1, 3, v1
    v_and_b32 v32, 31, v0
    v_mov_b32 v33, 0x7f000000
    v_cmp_eq_u32 vcc, 0, v32
    s_nop 1
    v_cndmask_b32 v1, v33, v1, vcc
    s_lshl_b32 s48, s48, 3
    s_add_u32 s48, s48, 22413312
    buffer_store_dwordx2 v[36:37], v1, s[24:27], s48 offen sc1
    s_cmp_ge_u32 s44, 10
    s_cbranch_scc1 L_s1_v
    s_lshr_b32 s48, s40, 1
    s_and_b32 s49, s40, 1
    s_lshl_b32 s60, s48, 1
    s_add_u32 s60, s60, 0
    s_and_b32 s60, s60, 3
    s_lshl_b32 s61, s48, 1
    s_add_u32 s61, s61, 1
    s_and_b32 s61, s61, 3
    s_lshl_b32 s62, s48, 1
    s_add_u32 s62, s62, 2
    s_and_b32 s62, s62, 3
    s_lshl_b32 s63, s48, 1
    s_add_u32 s63, s63, 3
    s_and_b32 s63, s63, 3
    v_and_b32 v161, 15, v0
    v_lshrrev_b32 v162, 4, v0
    v_bfe_u32 v163, v0, 1, 3
    s_lshl_b32 s50, s48, 13
    v_lshl_add_u32 v164, v161, 7, s50
    v_add_u32 v165, 0, v162
    v_xor_b32 v165, v165, v163
    v_lshl_add_u32 v1, v165, 4, v164
    v_add_u32 v3, 0x10000, v1
    v_add_u32 v165, 4, v162
    v_xor_b32 v165, v165, v163
    v_lshl_add_u32 v2, v165, 4, v164
    v_add_u32 v152, 0x10000, v2
    v_bfe_u32 v163, v0, 2, 2
    v_lshl_add_u32 v164, v162, 3, v163
    v_lshlrev_b32 v164, 8, v164
    v_and_b32 v165, 1, v0
    v_lshl_add_u32 v164, v165, 3, v164
    v_add_u32 v164, 0x4000, v164
    v_and_b32 v165, 1, v162
    v_lshl_or_b32 v163, v165, 2, v163
    v_lshlrev_b32 v163, 1, v163
    v_bfe_u32 v165, v0, 1, 1
    s_lshl_b32 s50, s49, 3
    v_add_u32 v165, s50, v165
    s_lshl_b32 s51, s60, 1
    v_add_u32 v153, s51, v165
    v_xor_b32 v153, v153, v163
    v_lshl_add_u32 v153, v153, 4, v164
    v_add_u32 v157, 0x10000, v153
    s_lshl_b32 s51, s61, 1
    v_add_u32 v154, s51, v165
    v_xor_b32 v154, v154, v163
    v_lshl_add_u32 v154, v154, 4, v164
    v_add_u32 v158, 0x10000, v154
    s_lshl_b32 s51, s62, 1
    v_add_u32 v155, s51, v165
    v_xor_b32 v155, v155, v163
    v_lshl_add_u32 v155, v155, 4, v164
    v_add_u32 v159, 0x10000, v155
    s_lshl_b32 s51, s63, 1
    v_add_u32 v156, s51, v165
    v_xor_b32 v156, v156, v163
    v_lshl_add_u32 v156, v156, 4, v164
    v_add_u32 v160, 0x10000, v156
    v_mov_b32 v84, s57
    v_mov_b32 v85, s57
    v_mov_b32 v86, s57
    v_mov_b32 v87, s57
    s_barrier
    ds_read_b128 v[88:91], v1 offset:0
    ds_read_b128 v[92:95], v1 offset:2048
    ds_read_b128 v[96:99], v1 offset:4096
    ds_read_b128 v[100:103], v1 offset:6144
    ds_read_b64_tr_b16 v[120:121], v153 offset:0
    ds_read_b64_tr_b16 v[122:123], v153 offset:1024
    ds_read_b64_tr_b16 v[124:125], v154 offset:0
    ds_read_b64_tr_b16 v[126:127], v154 offset:1024
    ds_read_b64_tr_b16 v[128:129], v155 offset:0
    ds_read_b64_tr_b16 v[130:131], v155 offset:1024
    ds_read_b64_tr_b16 v[132:133], v156 offset:0
    ds_read_b64_tr_b16 v[134:135], v156 offset:1024
    s_waitcnt lgkmcnt(0)
    s_mul_i32 s45, s72, 0x9E3779B1
    s_add_u32 s45, s45, 1
    v_mfma_f32_16x16x32_bf16 v[4:7], v[120:123], v[88:91], 0
    ds_read_b128 v[104:107], v2 offset:0
    v_mfma_f32_16x16x32_bf16 v[20:23], v[120:123], v[92:95], 0
    ds_read_b128 v[108:111], v2 offset:2048
    v_mfma_f32_16x16x32_bf16 v[36:39], v[120:123], v[96:99], 0
    ds_read_b128 v[112:115], v2 offset:4096
    v_mfma_f32_16x16x32_bf16 v[52:55], v[120:123], v[100:103], 0
    ds_read_b128 v[116:119], v2 offset:6144
    v_mfma_f32_16x16x32_bf16 v[68:71], v[120:123], v[84:87], 0
    ds_read_b64_tr_b16 v[136:137], v153 offset:8192
    v_mfma_f32_16x16x32_bf16 v[8:11], v[124:127], v[88:91], 0
    ds_read_b64_tr_b16 v[138:139], v153 offset:9216
    v_mfma_f32_16x16x32_bf16 v[24:27], v[124:127], v[92:95], 0
    ds_read_b64_tr_b16 v[140:141], v154 offset:8192
    v_mfma_f32_16x16x32_bf16 v[40:43], v[124:127], v[96:99], 0
    ds_read_b64_tr_b16 v[142:143], v154 offset:9216
    v_mfma_f32_16x16x32_bf16 v[56:59], v[124:127], v[100:103], 0
    ds_read_b64_tr_b16 v[144:145], v155 offset:8192
    v_mfma_f32_16x16x32_bf16 v[72:75], v[124:127], v[84:87], 0
    ds_read_b64_tr_b16 v[146:147], v155 offset:9216
    v_mfma_f32_16x16x32_bf16 v[12:15], v[128:131], v[88:91], 0
    ds_read_b64_tr_b16 v[148:149], v156 offset:8192
    v_mfma_f32_16x16x32_bf16 v[28:31], v[128:131], v[92:95], 0
    ds_read_b64_tr_b16 v[150:151], v156 offset:9216
    v_mfma_f32_16x16x32_bf16 v[44:47], v[128:131], v[96:99], 0
    v_mfma_f32_16x16x32_bf16 v[60:63], v[128:131], v[100:103], 0
    v_mfma_f32_16x16x32_bf16 v[16:19], v[132:135], v[88:91], 0
    v_mfma_f32_16x16x32_bf16 v[32:35], v[132:135], v[92:95], 0
    v_mfma_f32_16x16x32_bf16 v[48:51], v[132:135], v[96:99], 0
    v_mfma_f32_16x16x32_bf16 v[64:67], v[132:135], v[100:103], 0
    s_waitcnt lgkmcnt(0)
    s_barrier
    v_mfma_f32_16x16x32_bf16 v[4:7], v[136:139], v[104:107], v[4:7]
    ds_read_b128 v[88:91], v1 offset:32768
    v_mfma_f32_16x16x32_bf16 v[20:23], v[136:139], v[108:111], v[20:23]
    ds_read_b128 v[92:95], v1 offset:34816
    v_mfma_f32_16x16x32_bf16 v[36:39], v[136:139], v[112:115], v[36:39]
    ds_read_b128 v[96:99], v1 offset:36864
    v_mfma_f32_16x16x32_bf16 v[52:55], v[136:139], v[116:119], v[52:55]
    ds_read_b128 v[100:103], v1 offset:38912
    v_mfma_f32_16x16x32_bf16 v[68:71], v[136:139], v[84:87], v[68:71]
    ds_read_b64_tr_b16 v[120:121], v153 offset:32768
    v_mfma_f32_16x16x32_bf16 v[8:11], v[140:143], v[104:107], v[8:11]
    ds_read_b64_tr_b16 v[122:123], v153 offset:33792
    v_mfma_f32_16x16x32_bf16 v[24:27], v[140:143], v[108:111], v[24:27]
    ds_read_b64_tr_b16 v[124:125], v154 offset:32768
    v_mfma_f32_16x16x32_bf16 v[40:43], v[140:143], v[112:115], v[40:43]
    ds_read_b64_tr_b16 v[126:127], v154 offset:33792
    v_mfma_f32_16x16x32_bf16 v[56:59], v[140:143], v[116:119], v[56:59]
    ds_read_b64_tr_b16 v[128:129], v155 offset:32768
    v_mfma_f32_16x16x32_bf16 v[72:75], v[140:143], v[84:87], v[72:75]
    ds_read_b64_tr_b16 v[130:131], v155 offset:33792
    v_mfma_f32_16x16x32_bf16 v[12:15], v[144:147], v[104:107], v[12:15]
    ds_read_b64_tr_b16 v[132:133], v156 offset:32768
    v_mfma_f32_16x16x32_bf16 v[28:31], v[144:147], v[108:111], v[28:31]
    ds_read_b64_tr_b16 v[134:135], v156 offset:33792
    v_mfma_f32_16x16x32_bf16 v[44:47], v[144:147], v[112:115], v[44:47]
    v_mfma_f32_16x16x32_bf16 v[60:63], v[144:147], v[116:119], v[60:63]
    v_mfma_f32_16x16x32_bf16 v[16:19], v[148:151], v[104:107], v[16:19]
    v_mfma_f32_16x16x32_bf16 v[32:35], v[148:151], v[108:111], v[32:35]
    v_mfma_f32_16x16x32_bf16 v[48:51], v[148:151], v[112:115], v[48:51]
    v_mfma_f32_16x16x32_bf16 v[64:67], v[148:151], v[116:119], v[64:67]
    s_waitcnt lgkmcnt(0)
    v_mfma_f32_16x16x32_bf16 v[4:7], v[120:123], v[88:91], v[4:7]
    ds_read_b128 v[104:107], v2 offset:32768
    v_mfma_f32_16x16x32_bf16 v[20:23], v[120:123], v[92:95], v[20:23]
    ds_read_b128 v[108:111], v2 offset:34816
    v_mfma_f32_16x16x32_bf16 v[36:39], v[120:123], v[96:99], v[36:39]
    ds_read_b128 v[112:115], v2 offset:36864
    v_mfma_f32_16x16x32_bf16 v[52:55], v[120:123], v[100:103], v[52:55]
    ds_read_b128 v[116:119], v2 offset:38912
    v_mfma_f32_16x16x32_bf16 v[68:71], v[120:123], v[84:87], v[68:71]
    ds_read_b64_tr_b16 v[136:137], v153 offset:40960
    v_mfma_f32_16x16x32_bf16 v[8:11], v[124:127], v[88:91], v[8:11]
    ds_read_b64_tr_b16 v[138:139], v153 offset:41984
    v_mfma_f32_16x16x32_bf16 v[24:27], v[124:127], v[92:95], v[24:27]
    ds_read_b64_tr_b16 v[140:141], v154 offset:40960
    v_mfma_f32_16x16x32_bf16 v[40:43], v[124:127], v[96:99], v[40:43]
    ds_read_b64_tr_b16 v[142:143], v154 offset:41984
    v_mfma_f32_16x16x32_bf16 v[56:59], v[124:127], v[100:103], v[56:59]
    ds_read_b64_tr_b16 v[144:145], v155 offset:40960
    v_mfma_f32_16x16x32_bf16 v[72:75], v[124:127], v[84:87], v[72:75]
    ds_read_b64_tr_b16 v[146:147], v155 offset:41984
    v_mfma_f32_16x16x32_bf16 v[12:15], v[128:131], v[88:91], v[12:15]
    ds_read_b64_tr_b16 v[148:149], v156 offset:40960
    v_mfma_f32_16x16x32_bf16 v[28:31], v[128:131], v[92:95], v[28:31]
    ds_read_b64_tr_b16 v[150:151], v156 offset:41984
    v_mfma_f32_16x16x32_bf16 v[44:47], v[128:131], v[96:99], v[44:47]
    v_mfma_f32_16x16x32_bf16 v[60:63], v[128:131], v[100:103], v[60:63]
    v_mfma_f32_16x16x32_bf16 v[16:19], v[132:135], v[88:91], v[16:19]
    v_mfma_f32_16x16x32_bf16 v[32:35], v[132:135], v[92:95], v[32:35]
    v_mfma_f32_16x16x32_bf16 v[48:51], v[132:135], v[96:99], v[48:51]
    v_mfma_f32_16x16x32_bf16 v[64:67], v[132:135], v[100:103], v[64:67]
    s_waitcnt lgkmcnt(0)
    s_barrier
    v_mfma_f32_16x16x32_bf16 v[4:7], v[136:139], v[104:107], v[4:7]
    ds_read_b128 v[88:91], v3 offset:0
    v_mfma_f32_16x16x32_bf16 v[20:23], v[136:139], v[108:111], v[20:23]
    ds_read_b128 v[92:95], v3 offset:2048
    v_mfma_f32_16x16x32_bf16 v[36:39], v[136:139], v[112:115], v[36:39]
    ds_read_b128 v[96:99], v3 offset:4096
    v_mfma_f32_16x16x32_bf16 v[52:55], v[136:139], v[116:119], v[52:55]
    ds_read_b128 v[100:103], v3 offset:6144
    v_mfma_f32_16x16x32_bf16 v[68:71], v[136:139], v[84:87], v[68:71]
    ds_read_b64_tr_b16 v[120:121], v157 offset:0
    v_mfma_f32_16x16x32_bf16 v[8:11], v[140:143], v[104:107], v[8:11]
    ds_read_b64_tr_b16 v[122:123], v157 offset:1024
    v_mfma_f32_16x16x32_bf16 v[24:27], v[140:143], v[108:111], v[24:27]
    ds_read_b64_tr_b16 v[124:125], v158 offset:0
    v_mfma_f32_16x16x32_bf16 v[40:43], v[140:143], v[112:115], v[40:43]
    ds_read_b64_tr_b16 v[126:127], v158 offset:1024
    v_mfma_f32_16x16x32_bf16 v[56:59], v[140:143], v[116:119], v[56:59]
    ds_read_b64_tr_b16 v[128:129], v159 offset:0
    v_mfma_f32_16x16x32_bf16 v[72:75], v[140:143], v[84:87], v[72:75]
    ds_read_b64_tr_b16 v[130:131], v159 offset:1024
    v_mfma_f32_16x16x32_bf16 v[12:15], v[144:147], v[104:107], v[12:15]
    ds_read_b64_tr_b16 v[132:133], v160 offset:0
    v_mfma_f32_16x16x32_bf16 v[28:31], v[144:147], v[108:111], v[28:31]
    ds_read_b64_tr_b16 v[134:135], v160 offset:1024
    v_mfma_f32_16x16x32_bf16 v[44:47], v[144:147], v[112:115], v[44:47]
    v_mfma_f32_16x16x32_bf16 v[60:63], v[144:147], v[116:119], v[60:63]
    v_mfma_f32_16x16x32_bf16 v[16:19], v[148:151], v[104:107], v[16:19]
    v_mfma_f32_16x16x32_bf16 v[32:35], v[148:151], v[108:111], v[32:35]
    v_mfma_f32_16x16x32_bf16 v[48:51], v[148:151], v[112:115], v[48:51]
    v_mfma_f32_16x16x32_bf16 v[64:67], v[148:151], v[116:119], v[64:67]
    s_waitcnt lgkmcnt(0)
    v_mfma_f32_16x16x32_bf16 v[4:7], v[120:123], v[88:91], v[4:7]
    ds_read_b128 v[104:107], v152 offset:0
    v_mfma_f32_16x16x32_bf16 v[20:23], v[120:123], v[92:95], v[20:23]
    ds_read_b128 v[108:111], v152 offset:2048
    v_mfma_f32_16x16x32_bf16 v[36:39], v[120:123], v[96:99], v[36:39]
    ds_read_b128 v[112:115], v152 offset:4096
    v_mfma_f32_16x16x32_bf16 v[52:55], v[120:123], v[100:103], v[52:55]
    ds_read_b128 v[116:119], v152 offset:6144
    v_mfma_f32_16x16x32_bf16 v[68:71], v[120:123], v[84:87], v[68:71]
    ds_read_b64_tr_b16 v[136:137], v157 offset:8192
    v_mfma_f32_16x16x32_bf16 v[8:11], v[124:127], v[88:91], v[8:11]
    ds_read_b64_tr_b16 v[138:139], v157 offset:9216
    v_mfma_f32_16x16x32_bf16 v[24:27], v[124:127], v[92:95], v[24:27]
    ds_read_b64_tr_b16 v[140:141], v158 offset:8192
    v_mfma_f32_16x16x32_bf16 v[40:43], v[124:127], v[96:99], v[40:43]
    ds_read_b64_tr_b16 v[142:143], v158 offset:9216
    v_mfma_f32_16x16x32_bf16 v[56:59], v[124:127], v[100:103], v[56:59]
    ds_read_b64_tr_b16 v[144:145], v159 offset:8192
    v_mfma_f32_16x16x32_bf16 v[72:75], v[124:127], v[84:87], v[72:75]
    ds_read_b64_tr_b16 v[146:147], v159 offset:9216
    v_mfma_f32_16x16x32_bf16 v[12:15], v[128:131], v[88:91], v[12:15]
    ds_read_b64_tr_b16 v[148:149], v160 offset:8192
    v_mfma_f32_16x16x32_bf16 v[28:31], v[128:131], v[92:95], v[28:31]
    ds_read_b64_tr_b16 v[150:151], v160 offset:9216
    v_mfma_f32_16x16x32_bf16 v[44:47], v[128:131], v[96:99], v[44:47]
    v_mfma_f32_16x16x32_bf16 v[60:63], v[128:131], v[100:103], v[60:63]
    v_mfma_f32_16x16x32_bf16 v[16:19], v[132:135], v[88:91], v[16:19]
    v_mfma_f32_16x16x32_bf16 v[32:35], v[132:135], v[92:95], v[32:35]
    v_mfma_f32_16x16x32_bf16 v[48:51], v[132:135], v[96:99], v[48:51]
    v_mfma_f32_16x16x32_bf16 v[64:67], v[132:135], v[100:103], v[64:67]
    s_waitcnt lgkmcnt(0)
    s_barrier
    v_mfma_f32_16x16x32_bf16 v[4:7], v[136:139], v[104:107], v[4:7]
    ds_read_b128 v[88:91], v3 offset:32768
    v_mfma_f32_16x16x32_bf16 v[20:23], v[136:139], v[108:111], v[20:23]
    ds_read_b128 v[92:95], v3 offset:34816
    v_mfma_f32_16x16x32_bf16 v[36:39], v[136:139], v[112:115], v[36:39]
    ds_read_b128 v[96:99], v3 offset:36864
    v_mfma_f32_16x16x32_bf16 v[52:55], v[136:139], v[116:119], v[52:55]
    ds_read_b128 v[100:103], v3 offset:38912
    v_mfma_f32_16x16x32_bf16 v[68:71], v[136:139], v[84:87], v[68:71]
    ds_read_b64_tr_b16 v[120:121], v157 offset:32768
    v_mfma_f32_16x16x32_bf16 v[8:11], v[140:143], v[104:107], v[8:11]
    ds_read_b64_tr_b16 v[122:123], v157 offset:33792
    v_mfma_f32_16x16x32_bf16 v[24:27], v[140:143], v[108:111], v[24:27]
    ds_read_b64_tr_b16 v[124:125], v158 offset:32768
    v_mfma_f32_16x16x32_bf16 v[40:43], v[140:143], v[112:115], v[40:43]
    ds_read_b64_tr_b16 v[126:127], v158 offset:33792
    v_mfma_f32_16x16x32_bf16 v[56:59], v[140:143], v[116:119], v[56:59]
    ds_read_b64_tr_b16 v[128:129], v159 offset:32768
    v_mfma_f32_16x16x32_bf16 v[72:75], v[140:143], v[84:87], v[72:75]
    ds_read_b64_tr_b16 v[130:131], v159 offset:33792
    v_mfma_f32_16x16x32_bf16 v[12:15], v[144:147], v[104:107], v[12:15]
    ds_read_b64_tr_b16 v[132:133], v160 offset:32768
    v_mfma_f32_16x16x32_bf16 v[28:31], v[144:147], v[108:111], v[28:31]
    ds_read_b64_tr_b16 v[134:135], v160 offset:33792
    v_mfma_f32_16x16x32_bf16 v[44:47], v[144:147], v[112:115], v[44:47]
    v_mfma_f32_16x16x32_bf16 v[60:63], v[144:147], v[116:119], v[60:63]
    v_mfma_f32_16x16x32_bf16 v[16:19], v[148:151], v[104:107], v[16:19]
    v_mfma_f32_16x16x32_bf16 v[32:35], v[148:151], v[108:111], v[32:35]
    v_mfma_f32_16x16x32_bf16 v[48:51], v[148:151], v[112:115], v[48:51]
    v_mfma_f32_16x16x32_bf16 v[64:67], v[148:151], v[116:119], v[64:67]
    s_waitcnt lgkmcnt(0)
    s_waitcnt vmcnt(0)
    s_lshl_b32 s54, s41, 7
    s_add_u32 s54, s54, s47
    s_lshl_b32 s54, s54, 2
    s_add_u32 s54, s54, 12288
    v_mov_b32 v161, s45
    v_mov_b32 v162, 0
    s_mov_b64 exec, 1
    buffer_store_dword v161, v162, s[24:27], s54 offen sc1
    s_mov_b64 exec, -1
    v_mfma_f32_16x16x32_bf16 v[4:7], v[120:123], v[88:91], v[4:7]
    ds_read_b128 v[104:107], v152 offset:32768
    v_mfma_f32_16x16x32_bf16 v[20:23], v[120:123], v[92:95], v[20:23]
    ds_read_b128 v[108:111], v152 offset:34816
    v_mfma_f32_16x16x32_bf16 v[36:39], v[120:123], v[96:99], v[36:39]
    ds_read_b128 v[112:115], v152 offset:36864
    v_mfma_f32_16x16x32_bf16 v[52:55], v[120:123], v[100:103], v[52:55]
    ds_read_b128 v[116:119], v152 offset:38912
    v_mfma_f32_16x16x32_bf16 v[68:71], v[120:123], v[84:87], v[68:71]
    ds_read_b64_tr_b16 v[136:137], v157 offset:40960
    v_mfma_f32_16x16x32_bf16 v[8:11], v[124:127], v[88:91], v[8:11]
    ds_read_b64_tr_b16 v[138:139], v157 offset:41984
    v_mfma_f32_16x16x32_bf16 v[24:27], v[124:127], v[92:95], v[24:27]
    ds_read_b64_tr_b16 v[140:141], v158 offset:40960
    v_mfma_f32_16x16x32_bf16 v[40:43], v[124:127], v[96:99], v[40:43]
    ds_read_b64_tr_b16 v[142:143], v158 offset:41984
    v_mfma_f32_16x16x32_bf16 v[56:59], v[124:127], v[100:103], v[56:59]
    ds_read_b64_tr_b16 v[144:145], v159 offset:40960
    v_mfma_f32_16x16x32_bf16 v[72:75], v[124:127], v[84:87], v[72:75]
    ds_read_b64_tr_b16 v[146:147], v159 offset:41984
    v_mfma_f32_16x16x32_bf16 v[12:15], v[128:131], v[88:91], v[12:15]
    ds_read_b64_tr_b16 v[148:149], v160 offset:40960
    v_mfma_f32_16x16x32_bf16 v[28:31], v[128:131], v[92:95], v[28:31]
    ds_read_b64_tr_b16 v[150:151], v160 offset:41984
    v_mfma_f32_16x16x32_bf16 v[44:47], v[128:131], v[96:99], v[44:47]
    v_mfma_f32_16x16x32_bf16 v[60:63], v[128:131], v[100:103], v[60:63]
    v_mfma_f32_16x16x32_bf16 v[16:19], v[132:135], v[88:91], v[16:19]
    v_mfma_f32_16x16x32_bf16 v[32:35], v[132:135], v[92:95], v[32:35]
    v_mfma_f32_16x16x32_bf16 v[48:51], v[132:135], v[96:99], v[48:51]
    v_mfma_f32_16x16x32_bf16 v[64:67], v[132:135], v[100:103], v[64:67]
    s_waitcnt lgkmcnt(0)
    s_barrier
    v_mfma_f32_16x16x32_bf16 v[4:7], v[136:139], v[104:107], v[4:7]
    ds_read_b128 v[88:91], v1 offset:0
    v_mfma_f32_16x16x32_bf16 v[20:23], v[136:139], v[108:111], v[20:23]
    ds_read_b128 v[92:95], v1 offset:2048
    v_mfma_f32_16x16x32_bf16 v[36:39], v[136:139], v[112:115], v[36:39]
    ds_read_b128 v[96:99], v1 offset:4096
    v_mfma_f32_16x16x32_bf16 v[52:55], v[136:139], v[116:119], v[52:55]
    ds_read_b128 v[100:103], v1 offset:6144
    v_mfma_f32_16x16x32_bf16 v[68:71], v[136:139], v[84:87], v[68:71]
    ds_read_b64_tr_b16 v[120:121], v153 offset:0
    v_mfma_f32_16x16x32_bf16 v[8:11], v[140:143], v[104:107], v[8:11]
    ds_read_b64_tr_b16 v[122:123], v153 offset:1024
    v_mfma_f32_16x16x32_bf16 v[24:27], v[140:143], v[108:111], v[24:27]
    ds_read_b64_tr_b16 v[124:125], v154 offset:0
    v_mfma_f32_16x16x32_bf16 v[40:43], v[140:143], v[112:115], v[40:43]
    ds_read_b64_tr_b16 v[126:127], v154 offset:1024
    v_mfma_f32_16x16x32_bf16 v[56:59], v[140:143], v[116:119], v[56:59]
    ds_read_b64_tr_b16 v[128:129], v155 offset:0
    v_mfma_f32_16x16x32_bf16 v[72:75], v[140:143], v[84:87], v[72:75]
    ds_read_b64_tr_b16 v[130:131], v155 offset:1024
    v_mfma_f32_16x16x32_bf16 v[12:15], v[144:147], v[104:107], v[12:15]
    ds_read_b64_tr_b16 v[132:133], v156 offset:0
    v_mfma_f32_16x16x32_bf16 v[28:31], v[144:147], v[108:111], v[28:31]
    ds_read_b64_tr_b16 v[134:135], v156 offset:1024
    v_mfma_f32_16x16x32_bf16 v[44:47], v[144:147], v[112:115], v[44:47]
    v_mfma_f32_16x16x32_bf16 v[60:63], v[144:147], v[116:119], v[60:63]
    v_mfma_f32_16x16x32_bf16 v[16:19], v[148:151], v[104:107], v[16:19]
    v_mfma_f32_16x16x32_bf16 v[32:35], v[148:151], v[108:111], v[32:35]
    v_mfma_f32_16x16x32_bf16 v[48:51], v[148:151], v[112:115], v[48:51]
    v_mfma_f32_16x16x32_bf16 v[64:67], v[148:151], v[116:119], v[64:67]
    s_waitcnt lgkmcnt(0)
    v_mfma_f32_16x16x32_bf16 v[4:7], v[120:123], v[88:91], v[4:7]
    ds_read_b128 v[104:107], v2 offset:0
    v_mfma_f32_16x16x32_bf16 v[20:23], v[120:123], v[92:95], v[20:23]
    ds_read_b128 v[108:111], v2 offset:2048
    v_mfma_f32_16x16x32_bf16 v[36:39], v[120:123], v[96:99], v[36:39]
    ds_read_b128 v[112:115], v2 offset:4096
    v_mfma_f32_16x16x32_bf16 v[52:55], v[120:123], v[100:103], v[52:55]
    ds_read_b128 v[116:119], v2 offset:6144
    v_mfma_f32_16x16x32_bf16 v[68:71], v[120:123], v[84:87], v[68:71]
    ds_read_b64_tr_b16 v[136:137], v153 offset:8192
    v_mfma_f32_16x16x32_bf16 v[8:11], v[124:127], v[88:91], v[8:11]
    ds_read_b64_tr_b16 v[138:139], v153 offset:9216
    v_mfma_f32_16x16x32_bf16 v[24:27], v[124:127], v[92:95], v[24:27]
    ds_read_b64_tr_b16 v[140:141], v154 offset:8192
    v_mfma_f32_16x16x32_bf16 v[40:43], v[124:127], v[96:99], v[40:43]
    ds_read_b64_tr_b16 v[142:143], v154 offset:9216
    v_mfma_f32_16x16x32_bf16 v[56:59], v[124:127], v[100:103], v[56:59]
    ds_read_b64_tr_b16 v[144:145], v155 offset:8192
    v_mfma_f32_16x16x32_bf16 v[72:75], v[124:127], v[84:87], v[72:75]
    ds_read_b64_tr_b16 v[146:147], v155 offset:9216
    v_mfma_f32_16x16x32_bf16 v[12:15], v[128:131], v[88:91], v[12:15]
    ds_read_b64_tr_b16 v[148:149], v156 offset:8192
    v_mfma_f32_16x16x32_bf16 v[28:31], v[128:131], v[92:95], v[28:31]
    ds_read_b64_tr_b16 v[150:151], v156 offset:9216
    v_mfma_f32_16x16x32_bf16 v[44:47], v[128:131], v[96:99], v[44:47]
    v_mfma_f32_16x16x32_bf16 v[60:63], v[128:131], v[100:103], v[60:63]
    v_mfma_f32_16x16x32_bf16 v[16:19], v[132:135], v[88:91], v[16:19]
    v_mfma_f32_16x16x32_bf16 v[32:35], v[132:135], v[92:95], v[32:35]
    v_mfma_f32_16x16x32_bf16 v[48:51], v[132:135], v[96:99], v[48:51]
    v_mfma_f32_16x16x32_bf16 v[64:67], v[132:135], v[100:103], v[64:67]
    s_waitcnt lgkmcnt(0)
    s_barrier
    v_mfma_f32_16x16x32_bf16 v[4:7], v[136:139], v[104:107], v[4:7]
    ds_read_b128 v[88:91], v1 offset:32768
    v_mfma_f32_16x16x32_bf16 v[20:23], v[136:139], v[108:111], v[20:23]
    ds_read_b128 v[92:95], v1 offset:34816
    v_mfma_f32_16x16x32_bf16 v[36:39], v[136:139], v[112:115], v[36:39]
    ds_read_b128 v[96:99], v1 offset:36864
    v_mfma_f32_16x16x32_bf16 v[52:55], v[136:139], v[116:119], v[52:55]
    ds_read_b128 v[100:103], v1 offset:38912
    v_mfma_f32_16x16x32_bf16 v[68:71], v[136:139], v[84:87], v[68:71]
    ds_read_b64_tr_b16 v[120:121], v153 offset:32768
    v_mfma_f32_16x16x32_bf16 v[8:11], v[140:143], v[104:107], v[8:11]
    ds_read_b64_tr_b16 v[122:123], v153 offset:33792
    v_mfma_f32_16x16x32_bf16 v[24:27], v[140:143], v[108:111], v[24:27]
    ds_read_b64_tr_b16 v[124:125], v154 offset:32768
    v_mfma_f32_16x16x32_bf16 v[40:43], v[140:143], v[112:115], v[40:43]
    ds_read_b64_tr_b16 v[126:127], v154 offset:33792
    v_mfma_f32_16x16x32_bf16 v[56:59], v[140:143], v[116:119], v[56:59]
    ds_read_b64_tr_b16 v[128:129], v155 offset:32768
    v_mfma_f32_16x16x32_bf16 v[72:75], v[140:143], v[84:87], v[72:75]
    ds_read_b64_tr_b16 v[130:131], v155 offset:33792
    v_mfma_f32_16x16x32_bf16 v[12:15], v[144:147], v[104:107], v[12:15]
    ds_read_b64_tr_b16 v[132:133], v156 offset:32768
    v_mfma_f32_16x16x32_bf16 v[28:31], v[144:147], v[108:111], v[28:31]
    ds_read_b64_tr_b16 v[134:135], v156 offset:33792
    v_mfma_f32_16x16x32_bf16 v[44:47], v[144:147], v[112:115], v[44:47]
    v_mfma_f32_16x16x32_bf16 v[60:63], v[144:147], v[116:119], v[60:63]
    v_mfma_f32_16x16x32_bf16 v[16:19], v[148:151], v[104:107], v[16:19]
    v_mfma_f32_16x16x32_bf16 v[32:35], v[148:151], v[108:111], v[32:35]
    v_mfma_f32_16x16x32_bf16 v[48:51], v[148:151], v[112:115], v[48:51]
    v_mfma_f32_16x16x32_bf16 v[64:67], v[148:151], v[116:119], v[64:67]
    s_waitcnt lgkmcnt(0)
    v_mfma_f32_16x16x32_bf16 v[4:7], v[120:123], v[88:91], v[4:7]
    ds_read_b128 v[104:107], v2 offset:32768
    v_mfma_f32_16x16x32_bf16 v[20:23], v[120:123], v[92:95], v[20:23]
    ds_read_b128 v[108:111], v2 offset:34816
    v_mfma_f32_16x16x32_bf16 v[36:39], v[120:123], v[96:99], v[36:39]
    ds_read_b128 v[112:115], v2 offset:36864
    v_mfma_f32_16x16x32_bf16 v[52:55], v[120:123], v[100:103], v[52:55]
    ds_read_b128 v[116:119], v2 offset:38912
    v_mfma_f32_16x16x32_bf16 v[68:71], v[120:123], v[84:87], v[68:71]
    ds_read_b64_tr_b16 v[136:137], v153 offset:40960
    v_mfma_f32_16x16x32_bf16 v[8:11], v[124:127], v[88:91], v[8:11]
    ds_read_b64_tr_b16 v[138:139], v153 offset:41984
    v_mfma_f32_16x16x32_bf16 v[24:27], v[124:127], v[92:95], v[24:27]
    ds_read_b64_tr_b16 v[140:141], v154 offset:40960
    v_mfma_f32_16x16x32_bf16 v[40:43], v[124:127], v[96:99], v[40:43]
    ds_read_b64_tr_b16 v[142:143], v154 offset:41984
    v_mfma_f32_16x16x32_bf16 v[56:59], v[124:127], v[100:103], v[56:59]
    ds_read_b64_tr_b16 v[144:145], v155 offset:40960
    v_mfma_f32_16x16x32_bf16 v[72:75], v[124:127], v[84:87], v[72:75]
    ds_read_b64_tr_b16 v[146:147], v155 offset:41984
    v_mfma_f32_16x16x32_bf16 v[12:15], v[128:131], v[88:91], v[12:15]
    ds_read_b64_tr_b16 v[148:149], v156 offset:40960
    v_mfma_f32_16x16x32_bf16 v[28:31], v[128:131], v[92:95], v[28:31]
    ds_read_b64_tr_b16 v[150:151], v156 offset:41984
    v_mfma_f32_16x16x32_bf16 v[44:47], v[128:131], v[96:99], v[44:47]
    v_mfma_f32_16x16x32_bf16 v[60:63], v[128:131], v[100:103], v[60:63]
    v_mfma_f32_16x16x32_bf16 v[16:19], v[132:135], v[88:91], v[16:19]
    v_mfma_f32_16x16x32_bf16 v[32:35], v[132:135], v[92:95], v[32:35]
    v_mfma_f32_16x16x32_bf16 v[48:51], v[132:135], v[96:99], v[48:51]
    v_mfma_f32_16x16x32_bf16 v[64:67], v[132:135], v[100:103], v[64:67]
    s_waitcnt lgkmcnt(0)
    s_barrier
    v_mfma_f32_16x16x32_bf16 v[4:7], v[136:139], v[104:107], v[4:7]
    ds_read_b128 v[88:91], v3 offset:0
    v_mfma_f32_16x16x32_bf16 v[20:23], v[136:139], v[108:111], v[20:23]
    ds_read_b128 v[92:95], v3 offset:2048
    v_mfma_f32_16x16x32_bf16 v[36:39], v[136:139], v[112:115], v[36:39]
    ds_read_b128 v[96:99], v3 offset:4096
    v_mfma_f32_16x16x32_bf16 v[52:55], v[136:139], v[116:119], v[52:55]
    ds_read_b128 v[100:103], v3 offset:6144
    v_mfma_f32_16x16x32_bf16 v[68:71], v[136:139], v[84:87], v[68:71]
    ds_read_b64_tr_b16 v[120:121], v157 offset:0
    v_mfma_f32_16x16x32_bf16 v[8:11], v[140:143], v[104:107], v[8:11]
    ds_read_b64_tr_b16 v[122:123], v157 offset:1024
    v_mfma_f32_16x16x32_bf16 v[24:27], v[140:143], v[108:111], v[24:27]
    ds_read_b64_tr_b16 v[124:125], v158 offset:0
    v_mfma_f32_16x16x32_bf16 v[40:43], v[140:143], v[112:115], v[40:43]
    ds_read_b64_tr_b16 v[126:127], v158 offset:1024
    v_mfma_f32_16x16x32_bf16 v[56:59], v[140:143], v[116:119], v[56:59]
    ds_read_b64_tr_b16 v[128:129], v159 offset:0
    v_mfma_f32_16x16x32_bf16 v[72:75], v[140:143], v[84:87], v[72:75]
    ds_read_b64_tr_b16 v[130:131], v159 offset:1024
    v_mfma_f32_16x16x32_bf16 v[12:15], v[144:147], v[104:107], v[12:15]
    ds_read_b64_tr_b16 v[132:133], v160 offset:0
    v_mfma_f32_16x16x32_bf16 v[28:31], v[144:147], v[108:111], v[28:31]
    ds_read_b64_tr_b16 v[134:135], v160 offset:1024
    v_mfma_f32_16x16x32_bf16 v[44:47], v[144:147], v[112:115], v[44:47]
    v_mfma_f32_16x16x32_bf16 v[60:63], v[144:147], v[116:119], v[60:63]
    v_mfma_f32_16x16x32_bf16 v[16:19], v[148:151], v[104:107], v[16:19]
    v_mfma_f32_16x16x32_bf16 v[32:35], v[148:151], v[108:111], v[32:35]
    v_mfma_f32_16x16x32_bf16 v[48:51], v[148:151], v[112:115], v[48:51]
    v_mfma_f32_16x16x32_bf16 v[64:67], v[148:151], v[116:119], v[64:67]
    s_waitcnt lgkmcnt(0)
    v_mfma_f32_16x16x32_bf16 v[4:7], v[120:123], v[88:91], v[4:7]
    ds_read_b128 v[104:107], v152 offset:0
    v_mfma_f32_16x16x32_bf16 v[20:23], v[120:123], v[92:95], v[20:23]
    ds_read_b128 v[108:111], v152 offset:2048
    v_mfma_f32_16x16x32_bf16 v[36:39], v[120:123], v[96:99], v[36:39]
    ds_read_b128 v[112:115], v152 offset:4096
    v_mfma_f32_16x16x32_bf16 v[52:55], v[120:123], v[100:103], v[52:55]
    ds_read_b128 v[116:119], v152 offset:6144
    v_mfma_f32_16x16x32_bf16 v[68:71], v[120:123], v[84:87], v[68:71]
    ds_read_b64_tr_b16 v[136:137], v157 offset:8192
    v_mfma_f32_16x16x32_bf16 v[8:11], v[124:127], v[88:91], v[8:11]
    ds_read_b64_tr_b16 v[138:139], v157 offset:9216
    v_mfma_f32_16x16x32_bf16 v[24:27], v[124:127], v[92:95], v[24:27]
    ds_read_b64_tr_b16 v[140:141], v158 offset:8192
    v_mfma_f32_16x16x32_bf16 v[40:43], v[124:127], v[96:99], v[40:43]
    ds_read_b64_tr_b16 v[142:143], v158 offset:9216
    v_mfma_f32_16x16x32_bf16 v[56:59], v[124:127], v[100:103], v[56:59]
    ds_read_b64_tr_b16 v[144:145], v159 offset:8192
    v_mfma_f32_16x16x32_bf16 v[72:75], v[124:127], v[84:87], v[72:75]
    ds_read_b64_tr_b16 v[146:147], v159 offset:9216
    v_mfma_f32_16x16x32_bf16 v[12:15], v[128:131], v[88:91], v[12:15]
    ds_read_b64_tr_b16 v[148:149], v160 offset:8192
    v_mfma_f32_16x16x32_bf16 v[28:31], v[128:131], v[92:95], v[28:31]
    ds_read_b64_tr_b16 v[150:151], v160 offset:9216
    v_mfma_f32_16x16x32_bf16 v[44:47], v[128:131], v[96:99], v[44:47]
    v_mfma_f32_16x16x32_bf16 v[60:63], v[128:131], v[100:103], v[60:63]
    v_mfma_f32_16x16x32_bf16 v[16:19], v[132:135], v[88:91], v[16:19]
    v_mfma_f32_16x16x32_bf16 v[32:35], v[132:135], v[92:95], v[32:35]
    v_mfma_f32_16x16x32_bf16 v[48:51], v[132:135], v[96:99], v[48:51]
    v_mfma_f32_16x16x32_bf16 v[64:67], v[132:135], v[100:103], v[64:67]
    s_waitcnt lgkmcnt(0)
    s_barrier
    v_mfma_f32_16x16x32_bf16 v[4:7], v[136:139], v[104:107], v[4:7]
    ds_read_b128 v[88:91], v3 offset:32768
    v_mfma_f32_16x16x32_bf16 v[20:23], v[136:139], v[108:111], v[20:23]
    ds_read_b128 v[92:95], v3 offset:34816
    v_mfma_f32_16x16x32_bf16 v[36:39], v[136:139], v[112:115], v[36:39]
    ds_read_b128 v[96:99], v3 offset:36864
    v_mfma_f32_16x16x32_bf16 v[52:55], v[136:139], v[116:119], v[52:55]
    ds_read_b128 v[100:103], v3 offset:38912
    v_mfma_f32_16x16x32_bf16 v[68:71], v[136:139], v[84:87], v[68:71]
    ds_read_b64_tr_b16 v[120:121], v157 offset:32768
    v_mfma_f32_16x16x32_bf16 v[8:11], v[140:143], v[104:107], v[8:11]
    ds_read_b64_tr_b16 v[122:123], v157 offset:33792
    v_mfma_f32_16x16x32_bf16 v[24:27], v[140:143], v[108:111], v[24:27]
    ds_read_b64_tr_b16 v[124:125], v158 offset:32768
    v_mfma_f32_16x16x32_bf16 v[40:43], v[140:143], v[112:115], v[40:43]
    ds_read_b64_tr_b16 v[126:127], v158 offset:33792
    v_mfma_f32_16x16x32_bf16 v[56:59], v[140:143], v[116:119], v[56:59]
    ds_read_b64_tr_b16 v[128:129], v159 offset:32768
    v_mfma_f32_16x16x32_bf16 v[72:75], v[140:143], v[84:87], v[72:75]
    ds_read_b64_tr_b16 v[130:131], v159 offset:33792
    v_mfma_f32_16x16x32_bf16 v[12:15], v[144:147], v[104:107], v[12:15]
    ds_read_b64_tr_b16 v[132:133], v160 offset:32768
    v_mfma_f32_16x16x32_bf16 v[28:31], v[144:147], v[108:111], v[28:31]
    ds_read_b64_tr_b16 v[134:135], v160 offset:33792
    v_mfma_f32_16x16x32_bf16 v[44:47], v[144:147], v[112:115], v[44:47]
    v_mfma_f32_16x16x32_bf16 v[60:63], v[144:147], v[116:119], v[60:63]
    v_mfma_f32_16x16x32_bf16 v[16:19], v[148:151], v[104:107], v[16:19]
    v_mfma_f32_16x16x32_bf16 v[32:35], v[148:151], v[108:111], v[32:35]
    v_mfma_f32_16x16x32_bf16 v[48:51], v[148:151], v[112:115], v[48:51]
    v_mfma_f32_16x16x32_bf16 v[64:67], v[148:151], v[116:119], v[64:67]
    s_waitcnt lgkmcnt(0)
    v_mfma_f32_16x16x32_bf16 v[4:7], v[120:123], v[88:91], v[4:7]
    ds_read_b128 v[104:107], v152 offset:32768
    v_mfma_f32_16x16x32_bf16 v[20:23], v[120:123], v[92:95], v[20:23]
    ds_read_b128 v[108:111], v152 offset:34816
    v_mfma_f32_16x16x32_bf16 v[36:39], v[120:123], v[96:99], v[36:39]
    ds_read_b128 v[112:115], v152 offset:36864
    v_mfma_f32_16x16x32_bf16 v[52:55], v[120:123], v[100:103], v[52:55]
    ds_read_b128 v[116:119], v152 offset:38912
    v_mfma_f32_16x16x32_bf16 v[68:71], v[120:123], v[84:87], v[68:71]
    ds_read_b64_tr_b16 v[136:137], v157 offset:40960
    v_mfma_f32_16x16x32_bf16 v[8:11], v[124:127], v[88:91], v[8:11]
    ds_read_b64_tr_b16 v[138:139], v157 offset:41984
    v_mfma_f32_16x16x32_bf16 v[24:27], v[124:127], v[92:95], v[24:27]
    ds_read_b64_tr_b16 v[140:141], v158 offset:40960
    v_mfma_f32_16x16x32_bf16 v[40:43], v[124:127], v[96:99], v[40:43]
    ds_read_b64_tr_b16 v[142:143], v158 offset:41984
    v_mfma_f32_16x16x32_bf16 v[56:59], v[124:127], v[100:103], v[56:59]
    ds_read_b64_tr_b16 v[144:145], v159 offset:40960
    v_mfma_f32_16x16x32_bf16 v[72:75], v[124:127], v[84:87], v[72:75]
    ds_read_b64_tr_b16 v[146:147], v159 offset:41984
    v_mfma_f32_16x16x32_bf16 v[12:15], v[128:131], v[88:91], v[12:15]
    ds_read_b64_tr_b16 v[148:149], v160 offset:40960
    v_mfma_f32_16x16x32_bf16 v[28:31], v[128:131], v[92:95], v[28:31]
    ds_read_b64_tr_b16 v[150:151], v160 offset:41984
    v_mfma_f32_16x16x32_bf16 v[44:47], v[128:131], v[96:99], v[44:47]
    v_mfma_f32_16x16x32_bf16 v[60:63], v[128:131], v[100:103], v[60:63]
    v_mfma_f32_16x16x32_bf16 v[16:19], v[132:135], v[88:91], v[16:19]
    v_mfma_f32_16x16x32_bf16 v[32:35], v[132:135], v[92:95], v[32:35]
    v_mfma_f32_16x16x32_bf16 v[48:51], v[132:135], v[96:99], v[48:51]
    v_mfma_f32_16x16x32_bf16 v[64:67], v[132:135], v[100:103], v[64:67]
    s_waitcnt lgkmcnt(0)
    s_barrier
    v_mfma_f32_16x16x32_bf16 v[4:7], v[136:139], v[104:107], v[4:7]
    ds_read_b128 v[88:91], v1 offset:0
    v_mfma_f32_16x16x32_bf16 v[20:23], v[136:139], v[108:111], v[20:23]
    ds_read_b128 v[92:95], v1 offset:2048
    v_mfma_f32_16x16x32_bf16 v[36:39], v[136:139], v[112:115], v[36:39]
    ds_read_b128 v[96:99], v1 offset:4096
    v_mfma_f32_16x16x32_bf16 v[52:55], v[136:139], v[116:119], v[52:55]
    ds_read_b128 v[100:103], v1 offset:6144
    v_mfma_f32_16x16x32_bf16 v[68:71], v[136:139], v[84:87], v[68:71]
    ds_read_b64_tr_b16 v[120:121], v153 offset:0
    v_mfma_f32_16x16x32_bf16 v[8:11], v[140:143], v[104:107], v[8:11]
    ds_read_b64_tr_b16 v[122:123], v153 offset:1024
    v_mfma_f32_16x16x32_bf16 v[24:27], v[140:143], v[108:111], v[24:27]
    ds_read_b64_tr_b16 v[124:125], v154 offset:0
    v_mfma_f32_16x16x32_bf16 v[40:43], v[140:143], v[112:115], v[40:43]
    ds_read_b64_tr_b16 v[126:127], v154 offset:1024
    v_mfma_f32_16x16x32_bf16 v[56:59], v[140:143], v[116:119], v[56:59]
    ds_read_b64_tr_b16 v[128:129], v155 offset:0
    v_mfma_f32_16x16x32_bf16 v[72:75], v[140:143], v[84:87], v[72:75]
    ds_read_b64_tr_b16 v[130:131], v155 offset:1024
    v_mfma_f32_16x16x32_bf16 v[12:15], v[144:147], v[104:107], v[12:15]
    ds_read_b64_tr_b16 v[132:133], v156 offset:0
    v_mfma_f32_16x16x32_bf16 v[28:31], v[144:147], v[108:111], v[28:31]
    ds_read_b64_tr_b16 v[134:135], v156 offset:1024
    v_mfma_f32_16x16x32_bf16 v[44:47], v[144:147], v[112:115], v[44:47]
    v_mfma_f32_16x16x32_bf16 v[60:63], v[144:147], v[116:119], v[60:63]
    v_mfma_f32_16x16x32_bf16 v[16:19], v[148:151], v[104:107], v[16:19]
    v_mfma_f32_16x16x32_bf16 v[32:35], v[148:151], v[108:111], v[32:35]
    v_mfma_f32_16x16x32_bf16 v[48:51], v[148:151], v[112:115], v[48:51]
    v_mfma_f32_16x16x32_bf16 v[64:67], v[148:151], v[116:119], v[64:67]
    s_waitcnt lgkmcnt(0)
    v_mfma_f32_16x16x32_bf16 v[4:7], v[120:123], v[88:91], v[4:7]
    ds_read_b128 v[104:107], v2 offset:0
    v_mfma_f32_16x16x32_bf16 v[20:23], v[120:123], v[92:95], v[20:23]
    ds_read_b128 v[108:111], v2 offset:2048
    v_mfma_f32_16x16x32_bf16 v[36:39], v[120:123], v[96:99], v[36:39]
    ds_read_b128 v[112:115], v2 offset:4096
    v_mfma_f32_16x16x32_bf16 v[52:55], v[120:123], v[100:103], v[52:55]
    ds_read_b128 v[116:119], v2 offset:6144
    v_mfma_f32_16x16x32_bf16 v[68:71], v[120:123], v[84:87], v[68:71]
    ds_read_b64_tr_b16 v[136:137], v153 offset:8192
    v_mfma_f32_16x16x32_bf16 v[8:11], v[124:127], v[88:91], v[8:11]
    ds_read_b64_tr_b16 v[138:139], v153 offset:9216
    v_mfma_f32_16x16x32_bf16 v[24:27], v[124:127], v[92:95], v[24:27]
    ds_read_b64_tr_b16 v[140:141], v154 offset:8192
    v_mfma_f32_16x16x32_bf16 v[40:43], v[124:127], v[96:99], v[40:43]
    ds_read_b64_tr_b16 v[142:143], v154 offset:9216
    v_mfma_f32_16x16x32_bf16 v[56:59], v[124:127], v[100:103], v[56:59]
    ds_read_b64_tr_b16 v[144:145], v155 offset:8192
    v_mfma_f32_16x16x32_bf16 v[72:75], v[124:127], v[84:87], v[72:75]
    ds_read_b64_tr_b16 v[146:147], v155 offset:9216
    v_mfma_f32_16x16x32_bf16 v[12:15], v[128:131], v[88:91], v[12:15]
    ds_read_b64_tr_b16 v[148:149], v156 offset:8192
    v_mfma_f32_16x16x32_bf16 v[28:31], v[128:131], v[92:95], v[28:31]
    ds_read_b64_tr_b16 v[150:151], v156 offset:9216
    v_mfma_f32_16x16x32_bf16 v[44:47], v[128:131], v[96:99], v[44:47]
    v_mfma_f32_16x16x32_bf16 v[60:63], v[128:131], v[100:103], v[60:63]
    v_mfma_f32_16x16x32_bf16 v[16:19], v[132:135], v[88:91], v[16:19]
    v_mfma_f32_16x16x32_bf16 v[32:35], v[132:135], v[92:95], v[32:35]
    v_mfma_f32_16x16x32_bf16 v[48:51], v[132:135], v[96:99], v[48:51]
    v_mfma_f32_16x16x32_bf16 v[64:67], v[132:135], v[100:103], v[64:67]
    s_waitcnt lgkmcnt(0)
    s_barrier
    v_mfma_f32_16x16x32_bf16 v[4:7], v[136:139], v[104:107], v[4:7]
    ds_read_b128 v[88:91], v1 offset:32768
    v_mfma_f32_16x16x32_bf16 v[20:23], v[136:139], v[108:111], v[20:23]
    ds_read_b128 v[92:95], v1 offset:34816
    v_mfma_f32_16x16x32_bf16 v[36:39], v[136:139], v[112:115], v[36:39]
    ds_read_b128 v[96:99], v1 offset:36864
    v_mfma_f32_16x16x32_bf16 v[52:55], v[136:139], v[116:119], v[52:55]
    ds_read_b128 v[100:103], v1 offset:38912
    v_mfma_f32_16x16x32_bf16 v[68:71], v[136:139], v[84:87], v[68:71]
    ds_read_b64_tr_b16 v[120:121], v153 offset:32768
    v_mfma_f32_16x16x32_bf16 v[8:11], v[140:143], v[104:107], v[8:11]
    ds_read_b64_tr_b16 v[122:123], v153 offset:33792
    v_mfma_f32_16x16x32_bf16 v[24:27], v[140:143], v[108:111], v[24:27]
    ds_read_b64_tr_b16 v[124:125], v154 offset:32768
    v_mfma_f32_16x16x32_bf16 v[40:43], v[140:143], v[112:115], v[40:43]
    ds_read_b64_tr_b16 v[126:127], v154 offset:33792
    v_mfma_f32_16x16x32_bf16 v[56:59], v[140:143], v[116:119], v[56:59]
    ds_read_b64_tr_b16 v[128:129], v155 offset:32768
    v_mfma_f32_16x16x32_bf16 v[72:75], v[140:143], v[84:87], v[72:75]
    ds_read_b64_tr_b16 v[130:131], v155 offset:33792
    v_mfma_f32_16x16x32_bf16 v[12:15], v[144:147], v[104:107], v[12:15]
    ds_read_b64_tr_b16 v[132:133], v156 offset:32768
    v_mfma_f32_16x16x32_bf16 v[28:31], v[144:147], v[108:111], v[28:31]
    ds_read_b64_tr_b16 v[134:135], v156 offset:33792
    v_mfma_f32_16x16x32_bf16 v[44:47], v[144:147], v[112:115], v[44:47]
    v_mfma_f32_16x16x32_bf16 v[60:63], v[144:147], v[116:119], v[60:63]
    v_mfma_f32_16x16x32_bf16 v[16:19], v[148:151], v[104:107], v[16:19]
    v_mfma_f32_16x16x32_bf16 v[32:35], v[148:151], v[108:111], v[32:35]
    v_mfma_f32_16x16x32_bf16 v[48:51], v[148:151], v[112:115], v[48:51]
    v_mfma_f32_16x16x32_bf16 v[64:67], v[148:151], v[116:119], v[64:67]
    s_waitcnt lgkmcnt(0)
    v_mfma_f32_16x16x32_bf16 v[4:7], v[120:123], v[88:91], v[4:7]
    ds_read_b128 v[104:107], v2 offset:32768
    v_mfma_f32_16x16x32_bf16 v[20:23], v[120:123], v[92:95], v[20:23]
    ds_read_b128 v[108:111], v2 offset:34816
    v_mfma_f32_16x16x32_bf16 v[36:39], v[120:123], v[96:99], v[36:39]
    ds_read_b128 v[112:115], v2 offset:36864
    v_mfma_f32_16x16x32_bf16 v[52:55], v[120:123], v[100:103], v[52:55]
    ds_read_b128 v[116:119], v2 offset:38912
    v_mfma_f32_16x16x32_bf16 v[68:71], v[120:123], v[84:87], v[68:71]
    ds_read_b64_tr_b16 v[136:137], v153 offset:40960
    v_mfma_f32_16x16x32_bf16 v[8:11], v[124:127], v[88:91], v[8:11]
    ds_read_b64_tr_b16 v[138:139], v153 offset:41984
    v_mfma_f32_16x16x32_bf16 v[24:27], v[124:127], v[92:95], v[24:27]
    ds_read_b64_tr_b16 v[140:141], v154 offset:40960
    v_mfma_f32_16x16x32_bf16 v[40:43], v[124:127], v[96:99], v[40:43]
    ds_read_b64_tr_b16 v[142:143], v154 offset:41984
    v_mfma_f32_16x16x32_bf16 v[56:59], v[124:127], v[100:103], v[56:59]
    ds_read_b64_tr_b16 v[144:145], v155 offset:40960
    v_mfma_f32_16x16x32_bf16 v[72:75], v[124:127], v[84:87], v[72:75]
    ds_read_b64_tr_b16 v[146:147], v155 offset:41984
    v_mfma_f32_16x16x32_bf16 v[12:15], v[128:131], v[88:91], v[12:15]
    ds_read_b64_tr_b16 v[148:149], v156 offset:40960
    v_mfma_f32_16x16x32_bf16 v[28:31], v[128:131], v[92:95], v[28:31]
    ds_read_b64_tr_b16 v[150:151], v156 offset:41984
    v_mfma_f32_16x16x32_bf16 v[44:47], v[128:131], v[96:99], v[44:47]
    v_mfma_f32_16x16x32_bf16 v[60:63], v[128:131], v[100:103], v[60:63]
    v_mfma_f32_16x16x32_bf16 v[16:19], v[132:135], v[88:91], v[16:19]
    v_mfma_f32_16x16x32_bf16 v[32:35], v[132:135], v[92:95], v[32:35]
    v_mfma_f32_16x16x32_bf16 v[48:51], v[132:135], v[96:99], v[48:51]
    v_mfma_f32_16x16x32_bf16 v[64:67], v[132:135], v[100:103], v[64:67]
    s_waitcnt lgkmcnt(0)
    v_mfma_f32_16x16x32_bf16 v[4:7], v[136:139], v[104:107], v[4:7]
    v_mfma_f32_16x16x32_bf16 v[20:23], v[136:139], v[108:111], v[20:23]
    v_mfma_f32_16x16x32_bf16 v[36:39], v[136:139], v[112:115], v[36:39]
    v_mfma_f32_16x16x32_bf16 v[52:55], v[136:139], v[116:119], v[52:55]
    v_mfma_f32_16x16x32_bf16 v[68:71], v[136:139], v[84:87], v[68:71]
    v_mfma_f32_16x16x32_bf16 v[8:11], v[140:143], v[104:107], v[8:11]
    v_mfma_f32_16x16x32_bf16 v[24:27], v[140:143], v[108:111], v[24:27]
    v_mfma_f32_16x16x32_bf16 v[40:43], v[140:143], v[112:115], v[40:43]
    v_mfma_f32_16x16x32_bf16 v[56:59], v[140:143], v[116:119], v[56:59]
    v_mfma_f32_16x16x32_bf16 v[72:75], v[140:143], v[84:87], v[72:75]
    v_mfma_f32_16x16x32_bf16 v[12:15], v[144:147], v[104:107], v[12:15]
    v_mfma_f32_16x16x32_bf16 v[28:31], v[144:147], v[108:111], v[28:31]
    v_mfma_f32_16x16x32_bf16 v[44:47], v[144:147], v[112:115], v[44:47]
    v_mfma_f32_16x16x32_bf16 v[60:63], v[144:147], v[116:119], v[60:63]
    v_mfma_f32_16x16x32_bf16 v[16:19], v[148:151], v[104:107], v[16:19]
    v_mfma_f32_16x16x32_bf16 v[32:35], v[148:151], v[108:111], v[32:35]
    v_mfma_f32_16x16x32_bf16 v[48:51], v[148:151], v[112:115], v[48:51]
    v_mfma_f32_16x16x32_bf16 v[64:67], v[148:151], v[116:119], v[64:67]
    s_lshl_b32 s50, s49, 8
    s_add_u32 s50, s50, 131072
    v_lshrrev_b32 v162, 4, v0
    v_lshl_add_u32 v166, v162, 4, s50
    s_lshl_b32 s51, s60, 6
    v_add_u32 v168, s51, v166
    s_lshl_b32 s51, s61, 6
    v_add_u32 v169, s51, v166
    s_lshl_b32 s51, s62, 6
    v_add_u32 v170, s51, v166
    s_lshl_b32 s51, s63, 6
    v_add_u32 v171, s51, v166
    ds_write_b128 v168, v[68:71]
    ds_write_b128 v169, v[72:75]
    s_waitcnt lgkmcnt(0)
    s_barrier
    ds_read_b128 v[76:79], v170
    ds_read_b128 v[80:83], v171
    v_and_b32 v161, 15, v0
    s_lshl_b32 s50, s48, 9
    s_add_u32 s50, s50, 162816
    v_lshl_add_u32 v161, v161, 3, s50
    ds_read_b64 v[172:173], v161 offset:0
    ds_read_b64 v[174:175], v161 offset:128
    ds_read_b64 v[176:177], v161 offset:256
    ds_read_b64 v[178:179], v161 offset:384
    s_cmp_lt_u32 s44, 5
    s_cselect_b32 s51, 0x3ea52b5c, 1.0
    s_lshl_b32 s50, s44, 5
    s_lshl_b32 s52, s49, 4
    s_add_u32 s50, s50, s52
    v_lshrrev_b32 v162, 4, v0
    v_add_u32 v162, s50, v162
    v_and_b32 v161, 15, v0
    v_lshlrev_b32 v161, 3, v161
    s_mov_b32 s52, 81920
    s_lshl_b32 s53, s60, 2
    v_add_u32 v163, s53, v162
    v_mul_u32_u24 v164, 205, v163
    v_lshrrev_b32 v164, 10, v164
    v_mul_u32_u24 v165, 5, v164
    v_sub_u32 v163, v163, v165
    v_lshl_add_u32 v163, v163, 7, v161
    v_mad_u32_u24 v204, v164, s52, v163
    s_lshl_b32 s53, s61, 2
    v_add_u32 v163, s53, v162
    v_mul_u32_u24 v164, 205, v163
    v_lshrrev_b32 v164, 10, v164
    v_mul_u32_u24 v165, 5, v164
    v_sub_u32 v163, v163, v165
    v_lshl_add_u32 v163, v163, 7, v161
    v_mad_u32_u24 v205, v164, s52, v163
    s_lshl_b32 s53, s62, 2
    v_add_u32 v163, s53, v162
    v_mul_u32_u24 v164, 205, v163
    v_lshrrev_b32 v164, 10, v164
    v_mul_u32_u24 v165, 5, v164
    v_sub_u32 v163, v163, v165
    v_lshl_add_u32 v163, v163, 7, v161
    v_mad_u32_u24 v206, v164, s52, v163
    s_lshl_b32 s53, s63, 2
    v_add_u32 v163, s53, v162
    v_mul_u32_u24 v164, 205, v163
    v_lshrrev_b32 v164, 10, v164
    v_mul_u32_u24 v165, 5, v164
    v_sub_u32 v163, v163, v165
    v_lshl_add_u32 v163, v163, 7, v161
    v_mad_u32_u24 v207, v164, s52, v163
    s_lshl_b32 s50, s43, 3
    s_lshl_b32 s52, s48, 2
    s_add_u32 s50, s50, s52
    s_mul_i32 s50, s50, 640
    s_add_u32 s50, s50, 65536
    s_waitcnt lgkmcnt(0)
    v_mul_f32 v172, s51, v172
    v_mul_f32 v173, s51, v173
    v_mul_f32 v174, s51, v174
    v_mul_f32 v175, s51, v175
    v_mul_f32 v176, s51, v176
    v_mul_f32 v177, s51, v177
    v_mul_f32 v178, s51, v178
    v_mul_f32 v179, s51, v179
    v_pk_mul_f32 v[4:5], v[4:5], v[172:173] op_sel_hi:[1,0]
    v_pk_mul_f32 v[6:7], v[6:7], v[172:173] op_sel_hi:[1,0]
    v_pk_fma_f32 v[4:5], v[68:69], v[172:173], v[4:5] op_sel:[0,1,0] op_sel_hi:[1,1,1]
    v_pk_fma_f32 v[6:7], v[70:71], v[172:173], v[6:7] op_sel:[0,1,0] op_sel_hi:[1,1,1]
    v_cvt_pk_bf16_f32 v208, v4, v5
    v_cvt_pk_bf16_f32 v209, v6, v7
    buffer_store_dwordx2 v[208:209], v204, s[24:27], s50 offen offset:0 sc1
    v_pk_mul_f32 v[20:21], v[20:21], v[174:175] op_sel_hi:[1,0]
    v_pk_mul_f32 v[22:23], v[22:23], v[174:175] op_sel_hi:[1,0]
    v_pk_fma_f32 v[20:21], v[68:69], v[174:175], v[20:21] op_sel:[0,1,0] op_sel_hi:[1,1,1]
    v_pk_fma_f32 v[22:23], v[70:71], v[174:175], v[22:23] op_sel:[0,1,0] op_sel_hi:[1,1,1]
    v_cvt_pk_bf16_f32 v210, v20, v21
    v_cvt_pk_bf16_f32 v211, v22, v23
    buffer_store_dwordx2 v[210:211], v204, s[24:27], s50 offen offset:640 sc1
    v_pk_mul_f32 v[36:37], v[36:37], v[176:177] op_sel_hi:[1,0]
    v_pk_mul_f32 v[38:39], v[38:39], v[176:177] op_sel_hi:[1,0]
    v_pk_fma_f32 v[36:37], v[68:69], v[176:177], v[36:37] op_sel:[0,1,0] op_sel_hi:[1,1,1]
    v_pk_fma_f32 v[38:39], v[70:71], v[176:177], v[38:39] op_sel:[0,1,0] op_sel_hi:[1,1,1]
    v_cvt_pk_bf16_f32 v212, v36, v37
    v_cvt_pk_bf16_f32 v213, v38, v39
    buffer_store_dwordx2 v[212:213], v204, s[24:27], s50 offen offset:1280 sc1
    v_pk_mul_f32 v[52:53], v[52:53], v[178:179] op_sel_hi:[1,0]
    v_pk_mul_f32 v[54:55], v[54:55], v[178:179] op_sel_hi:[1,0]
    v_pk_fma_f32 v[52:53], v[68:69], v[178:179], v[52:53] op_sel:[0,1,0] op_sel_hi:[1,1,1]
    v_pk_fma_f32 v[54:55], v[70:71], v[178:179], v[54:55] op_sel:[0,1,0] op_sel_hi:[1,1,1]
    v_cvt_pk_bf16_f32 v214, v52, v53
    v_cvt_pk_bf16_f32 v215, v54, v55
    buffer_store_dwordx2 v[214:215], v204, s[24:27], s50 offen offset:1920 sc1
    v_pk_mul_f32 v[8:9], v[8:9], v[172:173] op_sel_hi:[1,0]
    v_pk_mul_f32 v[10:11], v[10:11], v[172:173] op_sel_hi:[1,0]
    v_pk_fma_f32 v[8:9], v[72:73], v[172:173], v[8:9] op_sel:[0,1,0] op_sel_hi:[1,1,1]
    v_pk_fma_f32 v[10:11], v[74:75], v[172:173], v[10:11] op_sel:[0,1,0] op_sel_hi:[1,1,1]
    v_cvt_pk_bf16_f32 v208, v8, v9
    v_cvt_pk_bf16_f32 v209, v10, v11
    buffer_store_dwordx2 v[208:209], v205, s[24:27], s50 offen offset:0 sc1
    v_pk_mul_f32 v[24:25], v[24:25], v[174:175] op_sel_hi:[1,0]
    v_pk_mul_f32 v[26:27], v[26:27], v[174:175] op_sel_hi:[1,0]
    v_pk_fma_f32 v[24:25], v[72:73], v[174:175], v[24:25] op_sel:[0,1,0] op_sel_hi:[1,1,1]
    v_pk_fma_f32 v[26:27], v[74:75], v[174:175], v[26:27] op_sel:[0,1,0] op_sel_hi:[1,1,1]
    v_cvt_pk_bf16_f32 v210, v24, v25
    v_cvt_pk_bf16_f32 v211, v26, v27
    buffer_store_dwordx2 v[210:211], v205, s[24:27], s50 offen offset:640 sc1
    v_pk_mul_f32 v[40:41], v[40:41], v[176:177] op_sel_hi:[1,0]
    v_pk_mul_f32 v[42:43], v[42:43], v[176:177] op_sel_hi:[1,0]
    v_pk_fma_f32 v[40:41], v[72:73], v[176:177], v[40:41] op_sel:[0,1,0] op_sel_hi:[1,1,1]
    v_pk_fma_f32 v[42:43], v[74:75], v[176:177], v[42:43] op_sel:[0,1,0] op_sel_hi:[1,1,1]
    v_cvt_pk_bf16_f32 v212, v40, v41
    v_cvt_pk_bf16_f32 v213, v42, v43
    buffer_store_dwordx2 v[212:213], v205, s[24:27], s50 offen offset:1280 sc1
    v_pk_mul_f32 v[56:57], v[56:57], v[178:179] op_sel_hi:[1,0]
    v_pk_mul_f32 v[58:59], v[58:59], v[178:179] op_sel_hi:[1,0]
    v_pk_fma_f32 v[56:57], v[72:73], v[178:179], v[56:57] op_sel:[0,1,0] op_sel_hi:[1,1,1]
    v_pk_fma_f32 v[58:59], v[74:75], v[178:179], v[58:59] op_sel:[0,1,0] op_sel_hi:[1,1,1]
    v_cvt_pk_bf16_f32 v214, v56, v57
    v_cvt_pk_bf16_f32 v215, v58, v59
    buffer_store_dwordx2 v[214:215], v205, s[24:27], s50 offen offset:1920 sc1
    v_pk_mul_f32 v[12:13], v[12:13], v[172:173] op_sel_hi:[1,0]
    v_pk_mul_f32 v[14:15], v[14:15], v[172:173] op_sel_hi:[1,0]
    v_pk_fma_f32 v[12:13], v[76:77], v[172:173], v[12:13] op_sel:[0,1,0] op_sel_hi:[1,1,1]
    v_pk_fma_f32 v[14:15], v[78:79], v[172:173], v[14:15] op_sel:[0,1,0] op_sel_hi:[1,1,1]
    v_cvt_pk_bf16_f32 v208, v12, v13
    v_cvt_pk_bf16_f32 v209, v14, v15
    buffer_store_dwordx2 v[208:209], v206, s[24:27], s50 offen offset:0 sc1
    v_pk_mul_f32 v[28:29], v[28:29], v[174:175] op_sel_hi:[1,0]
    v_pk_mul_f32 v[30:31], v[30:31], v[174:175] op_sel_hi:[1,0]
    v_pk_fma_f32 v[28:29], v[76:77], v[174:175], v[28:29] op_sel:[0,1,0] op_sel_hi:[1,1,1]
    v_pk_fma_f32 v[30:31], v[78:79], v[174:175], v[30:31] op_sel:[0,1,0] op_sel_hi:[1,1,1]
    v_cvt_pk_bf16_f32 v210, v28, v29
    v_cvt_pk_bf16_f32 v211, v30, v31
    buffer_store_dwordx2 v[210:211], v206, s[24:27], s50 offen offset:640 sc1
    v_pk_mul_f32 v[44:45], v[44:45], v[176:177] op_sel_hi:[1,0]
    v_pk_mul_f32 v[46:47], v[46:47], v[176:177] op_sel_hi:[1,0]
    v_pk_fma_f32 v[44:45], v[76:77], v[176:177], v[44:45] op_sel:[0,1,0] op_sel_hi:[1,1,1]
    v_pk_fma_f32 v[46:47], v[78:79], v[176:177], v[46:47] op_sel:[0,1,0] op_sel_hi:[1,1,1]
    v_cvt_pk_bf16_f32 v212, v44, v45
    v_cvt_pk_bf16_f32 v213, v46, v47
    buffer_store_dwordx2 v[212:213], v206, s[24:27], s50 offen offset:1280 sc1
    v_pk_mul_f32 v[60:61], v[60:61], v[178:179] op_sel_hi:[1,0]
    v_pk_mul_f32 v[62:63], v[62:63], v[178:179] op_sel_hi:[1,0]
    v_pk_fma_f32 v[60:61], v[76:77], v[178:179], v[60:61] op_sel:[0,1,0] op_sel_hi:[1,1,1]
    v_pk_fma_f32 v[62:63], v[78:79], v[178:179], v[62:63] op_sel:[0,1,0] op_sel_hi:[1,1,1]
    v_cvt_pk_bf16_f32 v214, v60, v61
    v_cvt_pk_bf16_f32 v215, v62, v63
    buffer_store_dwordx2 v[214:215], v206, s[24:27], s50 offen offset:1920 sc1
    v_pk_mul_f32 v[16:17], v[16:17], v[172:173] op_sel_hi:[1,0]
    v_pk_mul_f32 v[18:19], v[18:19], v[172:173] op_sel_hi:[1,0]
    v_pk_fma_f32 v[16:17], v[80:81], v[172:173], v[16:17] op_sel:[0,1,0] op_sel_hi:[1,1,1]
    v_pk_fma_f32 v[18:19], v[82:83], v[172:173], v[18:19] op_sel:[0,1,0] op_sel_hi:[1,1,1]
    v_cvt_pk_bf16_f32 v208, v16, v17
    v_cvt_pk_bf16_f32 v209, v18, v19
    buffer_store_dwordx2 v[208:209], v207, s[24:27], s50 offen offset:0 sc1
    v_pk_mul_f32 v[32:33], v[32:33], v[174:175] op_sel_hi:[1,0]
    v_pk_mul_f32 v[34:35], v[34:35], v[174:175] op_sel_hi:[1,0]
    v_pk_fma_f32 v[32:33], v[80:81], v[174:175], v[32:33] op_sel:[0,1,0] op_sel_hi:[1,1,1]
    v_pk_fma_f32 v[34:35], v[82:83], v[174:175], v[34:35] op_sel:[0,1,0] op_sel_hi:[1,1,1]
    v_cvt_pk_bf16_f32 v210, v32, v33
    v_cvt_pk_bf16_f32 v211, v34, v35
    buffer_store_dwordx2 v[210:211], v207, s[24:27], s50 offen offset:640 sc1
    v_pk_mul_f32 v[48:49], v[48:49], v[176:177] op_sel_hi:[1,0]
    v_pk_mul_f32 v[50:51], v[50:51], v[176:177] op_sel_hi:[1,0]
    v_pk_fma_f32 v[48:49], v[80:81], v[176:177], v[48:49] op_sel:[0,1,0] op_sel_hi:[1,1,1]
    v_pk_fma_f32 v[50:51], v[82:83], v[176:177], v[50:51] op_sel:[0,1,0] op_sel_hi:[1,1,1]
    v_cvt_pk_bf16_f32 v212, v48, v49
    v_cvt_pk_bf16_f32 v213, v50, v51
    buffer_store_dwordx2 v[212:213], v207, s[24:27], s50 offen offset:1280 sc1
    v_pk_mul_f32 v[64:65], v[64:65], v[178:179] op_sel_hi:[1,0]
    v_pk_mul_f32 v[66:67], v[66:67], v[178:179] op_sel_hi:[1,0]
    v_pk_fma_f32 v[64:65], v[80:81], v[178:179], v[64:65] op_sel:[0,1,0] op_sel_hi:[1,1,1]
    v_pk_fma_f32 v[66:67], v[82:83], v[178:179], v[66:67] op_sel:[0,1,0] op_sel_hi:[1,1,1]
    v_cvt_pk_bf16_f32 v214, v64, v65
    v_cvt_pk_bf16_f32 v215, v66, v67
    buffer_store_dwordx2 v[214:215], v207, s[24:27], s50 offen offset:1920 sc1
    s_waitcnt vmcnt(0)
    s_barrier
    s_branch L_s1_done
L_s1_v:
    s_lshr_b32 s48, s40, 1
    s_and_b32 s49, s40, 1
    s_lshl_b32 s60, s48, 1
    s_add_u32 s60, s60, 0
    s_and_b32 s60, s60, 3
    s_lshl_b32 s61, s48, 1
    s_add_u32 s61, s61, 1
    s_and_b32 s61, s61, 3
    s_lshl_b32 s62, s48, 1
    s_add_u32 s62, s62, 2
    s_and_b32 s62, s62, 3
    s_lshl_b32 s63, s48, 1
    s_add_u32 s63, s63, 3
    s_and_b32 s63, s63, 3
    v_and_b32 v161, 15, v0
    v_lshrrev_b32 v162, 4, v0
    v_bfe_u32 v163, v0, 1, 3
    s_lshl_b32 s50, s48, 13
    v_lshl_add_u32 v164, v161, 7, s50
    v_add_u32 v165, 0, v162
    v_xor_b32 v165, v165, v163
    v_lshl_add_u32 v1, v165, 4, v164
    v_add_u32 v3, 0x10000, v1
    v_add_u32 v165, 4, v162
    v_xor_b32 v165, v165, v163
    v_lshl_add_u32 v2, v165, 4, v164
    v_add_u32 v152, 0x10000, v2
    v_bfe_u32 v163, v0, 2, 2
    v_lshl_add_u32 v164, v162, 3, v163
    v_lshlrev_b32 v164, 8, v164
    v_and_b32 v165, 1, v0
    v_lshl_add_u32 v164, v165, 3, v164
    v_add_u32 v164, 0x4000, v164
    v_and_b32 v165, 1, v162
    v_lshl_or_b32 v163, v165, 2, v163
    v_lshlrev_b32 v163, 1, v163
    v_bfe_u32 v165, v0, 1, 1
    s_lshl_b32 s50, s49, 3
    v_add_u32 v165, s50, v165
    s_lshl_b32 s51, s60, 1
    v_add_u32 v153, s51, v165
    v_xor_b32 v153, v153, v163
    v_lshl_add_u32 v153, v153, 4, v164
    v_add_u32 v157, 0x10000, v153
    s_lshl_b32 s51, s61, 1
    v_add_u32 v154, s51, v165
    v_xor_b32 v154, v154, v163
    v_lshl_add_u32 v154, v154, 4, v164
    v_add_u32 v158, 0x10000, v154
    s_lshl_b32 s51, s62, 1
    v_add_u32 v155, s51, v165
    v_xor_b32 v155, v155, v163
    v_lshl_add_u32 v155, v155, 4, v164
    v_add_u32 v159, 0x10000, v155
    s_lshl_b32 s51, s63, 1
    v_add_u32 v156, s51, v165
    v_xor_b32 v156, v156, v163
    v_lshl_add_u32 v156, v156, 4, v164
    v_add_u32 v160, 0x10000, v156
    v_mov_b32 v84, s57
    v_mov_b32 v85, s57
    v_mov_b32 v86, s57
    v_mov_b32 v87, s57
    s_barrier
    ds_read_b128 v[88:91], v1 offset:0
    ds_read_b128 v[92:95], v1 offset:2048
    ds_read_b128 v[96:99], v1 offset:4096
    ds_read_b128 v[100:103], v1 offset:6144
    ds_read_b64_tr_b16 v[120:121], v153 offset:0
    ds_read_b64_tr_b16 v[122:123], v153 offset:1024
    ds_read_b64_tr_b16 v[124:125], v154 offset:0
    ds_read_b64_tr_b16 v[126:127], v154 offset:1024
    ds_read_b64_tr_b16 v[128:129], v155 offset:0
    ds_read_b64_tr_b16 v[130:131], v155 offset:1024
    ds_read_b64_tr_b16 v[132:133], v156 offset:0
    ds_read_b64_tr_b16 v[134:135], v156 offset:1024
    s_waitcnt lgkmcnt(0)
    s_mul_i32 s45, s72, 0x9E3779B1
    s_add_u32 s45, s45, 1
    v_mfma_f32_16x16x32_bf16 v[4:7], v[88:91], v[120:123], 0
    ds_read_b128 v[104:107], v2 offset:0
    v_mfma_f32_16x16x32_bf16 v[20:23], v[92:95], v[120:123], 0
    ds_read_b128 v[108:111], v2 offset:2048
    v_mfma_f32_16x16x32_bf16 v[36:39], v[96:99], v[120:123], 0
    ds_read_b128 v[112:115], v2 offset:4096
    v_mfma_f32_16x16x32_bf16 v[52:55], v[100:103], v[120:123], 0
    ds_read_b128 v[116:119], v2 offset:6144
    v_mfma_f32_16x16x32_bf16 v[68:71], v[84:87], v[120:123], 0
    ds_read_b64_tr_b16 v[136:137], v153 offset:8192
    v_mfma_f32_16x16x32_bf16 v[8:11], v[88:91], v[124:127], 0
    ds_read_b64_tr_b16 v[138:139], v153 offset:9216
    v_mfma_f32_16x16x32_bf16 v[24:27], v[92:95], v[124:127], 0
    ds_read_b64_tr_b16 v[140:141], v154 offset:8192
    v_mfma_f32_16x16x32_bf16 v[40:43], v[96:99], v[124:127], 0
    ds_read_b64_tr_b16 v[142:143], v154 offset:9216
    v_mfma_f32_16x16x32_bf16 v[56:59], v[100:103], v[124:127], 0
    ds_read_b64_tr_b16 v[144:145], v155 offset:8192
    v_mfma_f32_16x16x32_bf16 v[72:75], v[84:87], v[124:127], 0
    ds_read_b64_tr_b16 v[146:147], v155 offset:9216
    v_mfma_f32_16x16x32_bf16 v[12:15], v[88:91], v[128:131], 0
    ds_read_b64_tr_b16 v[148:149], v156 offset:8192
    v_mfma_f32_16x16x32_bf16 v[28:31], v[92:95], v[128:131], 0
    ds_read_b64_tr_b16 v[150:151], v156 offset:9216
    v_mfma_f32_16x16x32_bf16 v[44:47], v[96:99], v[128:131], 0
    v_mfma_f32_16x16x32_bf16 v[60:63], v[100:103], v[128:131], 0
    v_mfma_f32_16x16x32_bf16 v[16:19], v[88:91], v[132:135], 0
    v_mfma_f32_16x16x32_bf16 v[32:35], v[92:95], v[132:135], 0
    v_mfma_f32_16x16x32_bf16 v[48:51], v[96:99], v[132:135], 0
    v_mfma_f32_16x16x32_bf16 v[64:67], v[100:103], v[132:135], 0
    s_waitcnt lgkmcnt(0)
    s_barrier
    v_mfma_f32_16x16x32_bf16 v[4:7], v[104:107], v[136:139], v[4:7]
    ds_read_b128 v[88:91], v1 offset:32768
    v_mfma_f32_16x16x32_bf16 v[20:23], v[108:111], v[136:139], v[20:23]
    ds_read_b128 v[92:95], v1 offset:34816
    v_mfma_f32_16x16x32_bf16 v[36:39], v[112:115], v[136:139], v[36:39]
    ds_read_b128 v[96:99], v1 offset:36864
    v_mfma_f32_16x16x32_bf16 v[52:55], v[116:119], v[136:139], v[52:55]
    ds_read_b128 v[100:103], v1 offset:38912
    v_mfma_f32_16x16x32_bf16 v[68:71], v[84:87], v[136:139], v[68:71]
    ds_read_b64_tr_b16 v[120:121], v153 offset:32768
    v_mfma_f32_16x16x32_bf16 v[8:11], v[104:107], v[140:143], v[8:11]
    ds_read_b64_tr_b16 v[122:123], v153 offset:33792
    v_mfma_f32_16x16x32_bf16 v[24:27], v[108:111], v[140:143], v[24:27]
    ds_read_b64_tr_b16 v[124:125], v154 offset:32768
    v_mfma_f32_16x16x32_bf16 v[40:43], v[112:115], v[140:143], v[40:43]
    ds_read_b64_tr_b16 v[126:127], v154 offset:33792
    v_mfma_f32_16x16x32_bf16 v[56:59], v[116:119], v[140:143], v[56:59]
    ds_read_b64_tr_b16 v[128:129], v155 offset:32768
    v_mfma_f32_16x16x32_bf16 v[72:75], v[84:87], v[140:143], v[72:75]
    ds_read_b64_tr_b16 v[130:131], v155 offset:33792
    v_mfma_f32_16x16x32_bf16 v[12:15], v[104:107], v[144:147], v[12:15]
    ds_read_b64_tr_b16 v[132:133], v156 offset:32768
    v_mfma_f32_16x16x32_bf16 v[28:31], v[108:111], v[144:147], v[28:31]
    ds_read_b64_tr_b16 v[134:135], v156 offset:33792
    v_mfma_f32_16x16x32_bf16 v[44:47], v[112:115], v[144:147], v[44:47]
    v_mfma_f32_16x16x32_bf16 v[60:63], v[116:119], v[144:147], v[60:63]
    v_mfma_f32_16x16x32_bf16 v[16:19], v[104:107], v[148:151], v[16:19]
    v_mfma_f32_16x16x32_bf16 v[32:35], v[108:111], v[148:151], v[32:35]
    v_mfma_f32_16x16x32_bf16 v[48:51], v[112:115], v[148:151], v[48:51]
    v_mfma_f32_16x16x32_bf16 v[64:67], v[116:119], v[148:151], v[64:67]
    s_waitcnt lgkmcnt(0)
    v_mfma_f32_16x16x32_bf16 v[4:7], v[88:91], v[120:123], v[4:7]
    ds_read_b128 v[104:107], v2 offset:32768
    v_mfma_f32_16x16x32_bf16 v[20:23], v[92:95], v[120:123], v[20:23]
    ds_read_b128 v[108:111], v2 offset:34816
    v_mfma_f32_16x16x32_bf16 v[36:39], v[96:99], v[120:123], v[36:39]
    ds_read_b128 v[112:115], v2 offset:36864
    v_mfma_f32_16x16x32_bf16 v[52:55], v[100:103], v[120:123], v[52:55]
    ds_read_b128 v[116:119], v2 offset:38912
    v_mfma_f32_16x16x32_bf16 v[68:71], v[84:87], v[120:123], v[68:71]
    ds_read_b64_tr_b16 v[136:137], v153 offset:40960
    v_mfma_f32_16x16x32_bf16 v[8:11], v[88:91], v[124:127], v[8:11]
    ds_read_b64_tr_b16 v[138:139], v153 offset:41984
    v_mfma_f32_16x16x32_bf16 v[24:27], v[92:95], v[124:127], v[24:27]
    ds_read_b64_tr_b16 v[140:141], v154 offset:40960
    v_mfma_f32_16x16x32_bf16 v[40:43], v[96:99], v[124:127], v[40:43]
    ds_read_b64_tr_b16 v[142:143], v154 offset:41984
    v_mfma_f32_16x16x32_bf16 v[56:59], v[100:103], v[124:127], v[56:59]
    ds_read_b64_tr_b16 v[144:145], v155 offset:40960
    v_mfma_f32_16x16x32_bf16 v[72:75], v[84:87], v[124:127], v[72:75]
    ds_read_b64_tr_b16 v[146:147], v155 offset:41984
    v_mfma_f32_16x16x32_bf16 v[12:15], v[88:91], v[128:131], v[12:15]
    ds_read_b64_tr_b16 v[148:149], v156 offset:40960
    v_mfma_f32_16x16x32_bf16 v[28:31], v[92:95], v[128:131], v[28:31]
    ds_read_b64_tr_b16 v[150:151], v156 offset:41984
    v_mfma_f32_16x16x32_bf16 v[44:47], v[96:99], v[128:131], v[44:47]
    v_mfma_f32_16x16x32_bf16 v[60:63], v[100:103], v[128:131], v[60:63]
    v_mfma_f32_16x16x32_bf16 v[16:19], v[88:91], v[132:135], v[16:19]
    v_mfma_f32_16x16x32_bf16 v[32:35], v[92:95], v[132:135], v[32:35]
    v_mfma_f32_16x16x32_bf16 v[48:51], v[96:99], v[132:135], v[48:51]
    v_mfma_f32_16x16x32_bf16 v[64:67], v[100:103], v[132:135], v[64:67]
    s_waitcnt lgkmcnt(0)
    s_barrier
    v_mfma_f32_16x16x32_bf16 v[4:7], v[104:107], v[136:139], v[4:7]
    ds_read_b128 v[88:91], v3 offset:0
    v_mfma_f32_16x16x32_bf16 v[20:23], v[108:111], v[136:139], v[20:23]
    ds_read_b128 v[92:95], v3 offset:2048
    v_mfma_f32_16x16x32_bf16 v[36:39], v[112:115], v[136:139], v[36:39]
    ds_read_b128 v[96:99], v3 offset:4096
    v_mfma_f32_16x16x32_bf16 v[52:55], v[116:119], v[136:139], v[52:55]
    ds_read_b128 v[100:103], v3 offset:6144
    v_mfma_f32_16x16x32_bf16 v[68:71], v[84:87], v[136:139], v[68:71]
    ds_read_b64_tr_b16 v[120:121], v157 offset:0
    v_mfma_f32_16x16x32_bf16 v[8:11], v[104:107], v[140:143], v[8:11]
    ds_read_b64_tr_b16 v[122:123], v157 offset:1024
    v_mfma_f32_16x16x32_bf16 v[24:27], v[108:111], v[140:143], v[24:27]
    ds_read_b64_tr_b16 v[124:125], v158 offset:0
    v_mfma_f32_16x16x32_bf16 v[40:43], v[112:115], v[140:143], v[40:43]
    ds_read_b64_tr_b16 v[126:127], v158 offset:1024
    v_mfma_f32_16x16x32_bf16 v[56:59], v[116:119], v[140:143], v[56:59]
    ds_read_b64_tr_b16 v[128:129], v159 offset:0
    v_mfma_f32_16x16x32_bf16 v[72:75], v[84:87], v[140:143], v[72:75]
    ds_read_b64_tr_b16 v[130:131], v159 offset:1024
    v_mfma_f32_16x16x32_bf16 v[12:15], v[104:107], v[144:147], v[12:15]
    ds_read_b64_tr_b16 v[132:133], v160 offset:0
    v_mfma_f32_16x16x32_bf16 v[28:31], v[108:111], v[144:147], v[28:31]
    ds_read_b64_tr_b16 v[134:135], v160 offset:1024
    v_mfma_f32_16x16x32_bf16 v[44:47], v[112:115], v[144:147], v[44:47]
    v_mfma_f32_16x16x32_bf16 v[60:63], v[116:119], v[144:147], v[60:63]
    v_mfma_f32_16x16x32_bf16 v[16:19], v[104:107], v[148:151], v[16:19]
    v_mfma_f32_16x16x32_bf16 v[32:35], v[108:111], v[148:151], v[32:35]
    v_mfma_f32_16x16x32_bf16 v[48:51], v[112:115], v[148:151], v[48:51]
    v_mfma_f32_16x16x32_bf16 v[64:67], v[116:119], v[148:151], v[64:67]
    s_waitcnt lgkmcnt(0)
    v_mfma_f32_16x16x32_bf16 v[4:7], v[88:91], v[120:123], v[4:7]
    ds_read_b128 v[104:107], v152 offset:0
    v_mfma_f32_16x16x32_bf16 v[20:23], v[92:95], v[120:123], v[20:23]
    ds_read_b128 v[108:111], v152 offset:2048
    v_mfma_f32_16x16x32_bf16 v[36:39], v[96:99], v[120:123], v[36:39]
    ds_read_b128 v[112:115], v152 offset:4096
    v_mfma_f32_16x16x32_bf16 v[52:55], v[100:103], v[120:123], v[52:55]
    ds_read_b128 v[116:119], v152 offset:6144
    v_mfma_f32_16x16x32_bf16 v[68:71], v[84:87], v[120:123], v[68:71]
    ds_read_b64_tr_b16 v[136:137], v157 offset:8192
    v_mfma_f32_16x16x32_bf16 v[8:11], v[88:91], v[124:127], v[8:11]
    ds_read_b64_tr_b16 v[138:139], v157 offset:9216
    v_mfma_f32_16x16x32_bf16 v[24:27], v[92:95], v[124:127], v[24:27]
    ds_read_b64_tr_b16 v[140:141], v158 offset:8192
    v_mfma_f32_16x16x32_bf16 v[40:43], v[96:99], v[124:127], v[40:43]
    ds_read_b64_tr_b16 v[142:143], v158 offset:9216
    v_mfma_f32_16x16x32_bf16 v[56:59], v[100:103], v[124:127], v[56:59]
    ds_read_b64_tr_b16 v[144:145], v159 offset:8192
    v_mfma_f32_16x16x32_bf16 v[72:75], v[84:87], v[124:127], v[72:75]
    ds_read_b64_tr_b16 v[146:147], v159 offset:9216
    v_mfma_f32_16x16x32_bf16 v[12:15], v[88:91], v[128:131], v[12:15]
    ds_read_b64_tr_b16 v[148:149], v160 offset:8192
    v_mfma_f32_16x16x32_bf16 v[28:31], v[92:95], v[128:131], v[28:31]
    ds_read_b64_tr_b16 v[150:151], v160 offset:9216
    v_mfma_f32_16x16x32_bf16 v[44:47], v[96:99], v[128:131], v[44:47]
    v_mfma_f32_16x16x32_bf16 v[60:63], v[100:103], v[128:131], v[60:63]
    v_mfma_f32_16x16x32_bf16 v[16:19], v[88:91], v[132:135], v[16:19]
    v_mfma_f32_16x16x32_bf16 v[32:35], v[92:95], v[132:135], v[32:35]
    v_mfma_f32_16x16x32_bf16 v[48:51], v[96:99], v[132:135], v[48:51]
    v_mfma_f32_16x16x32_bf16 v[64:67], v[100:103], v[132:135], v[64:67]
    s_waitcnt lgkmcnt(0)
    s_barrier
    v_mfma_f32_16x16x32_bf16 v[4:7], v[104:107], v[136:139], v[4:7]
    ds_read_b128 v[88:91], v3 offset:32768
    v_mfma_f32_16x16x32_bf16 v[20:23], v[108:111], v[136:139], v[20:23]
    ds_read_b128 v[92:95], v3 offset:34816
    v_mfma_f32_16x16x32_bf16 v[36:39], v[112:115], v[136:139], v[36:39]
    ds_read_b128 v[96:99], v3 offset:36864
    v_mfma_f32_16x16x32_bf16 v[52:55], v[116:119], v[136:139], v[52:55]
    ds_read_b128 v[100:103], v3 offset:38912
    v_mfma_f32_16x16x32_bf16 v[68:71], v[84:87], v[136:139], v[68:71]
    ds_read_b64_tr_b16 v[120:121], v157 offset:32768
    v_mfma_f32_16x16x32_bf16 v[8:11], v[104:107], v[140:143], v[8:11]
    ds_read_b64_tr_b16 v[122:123], v157 offset:33792
    v_mfma_f32_16x16x32_bf16 v[24:27], v[108:111], v[140:143], v[24:27]
    ds_read_b64_tr_b16 v[124:125], v158 offset:32768
    v_mfma_f32_16x16x32_bf16 v[40:43], v[112:115], v[140:143], v[40:43]
    ds_read_b64_tr_b16 v[126:127], v158 offset:33792
    v_mfma_f32_16x16x32_bf16 v[56:59], v[116:119], v[140:143], v[56:59]
    ds_read_b64_tr_b16 v[128:129], v159 offset:32768
    v_mfma_f32_16x16x32_bf16 v[72:75], v[84:87], v[140:143], v[72:75]
    ds_read_b64_tr_b16 v[130:131], v159 offset:33792
    v_mfma_f32_16x16x32_bf16 v[12:15], v[104:107], v[144:147], v[12:15]
    ds_read_b64_tr_b16 v[132:133], v160 offset:32768
    v_mfma_f32_16x16x32_bf16 v[28:31], v[108:111], v[144:147], v[28:31]
    ds_read_b64_tr_b16 v[134:135], v160 offset:33792
    v_mfma_f32_16x16x32_bf16 v[44:47], v[112:115], v[144:147], v[44:47]
    v_mfma_f32_16x16x32_bf16 v[60:63], v[116:119], v[144:147], v[60:63]
    v_mfma_f32_16x16x32_bf16 v[16:19], v[104:107], v[148:151], v[16:19]
    v_mfma_f32_16x16x32_bf16 v[32:35], v[108:111], v[148:151], v[32:35]
    v_mfma_f32_16x16x32_bf16 v[48:51], v[112:115], v[148:151], v[48:51]
    v_mfma_f32_16x16x32_bf16 v[64:67], v[116:119], v[148:151], v[64:67]
    s_waitcnt lgkmcnt(0)
    s_waitcnt vmcnt(0)
    s_lshl_b32 s54, s41, 7
    s_add_u32 s54, s54, s47
    s_lshl_b32 s54, s54, 2
    s_add_u32 s54, s54, 12288
    v_mov_b32 v161, s45
    v_mov_b32 v162, 0
    s_mov_b64 exec, 1
    buffer_store_dword v161, v162, s[24:27], s54 offen sc1
    s_mov_b64 exec, -1
    v_mfma_f32_16x16x32_bf16 v[4:7], v[88:91], v[120:123], v[4:7]
    ds_read_b128 v[104:107], v152 offset:32768
    v_mfma_f32_16x16x32_bf16 v[20:23], v[92:95], v[120:123], v[20:23]
    ds_read_b128 v[108:111], v152 offset:34816
    v_mfma_f32_16x16x32_bf16 v[36:39], v[96:99], v[120:123], v[36:39]
    ds_read_b128 v[112:115], v152 offset:36864
    v_mfma_f32_16x16x32_bf16 v[52:55], v[100:103], v[120:123], v[52:55]
    ds_read_b128 v[116:119], v152 offset:38912
    v_mfma_f32_16x16x32_bf16 v[68:71], v[84:87], v[120:123], v[68:71]
    ds_read_b64_tr_b16 v[136:137], v157 offset:40960
    v_mfma_f32_16x16x32_bf16 v[8:11], v[88:91], v[124:127], v[8:11]
    ds_read_b64_tr_b16 v[138:139], v157 offset:41984
    v_mfma_f32_16x16x32_bf16 v[24:27], v[92:95], v[124:127], v[24:27]
    ds_read_b64_tr_b16 v[140:141], v158 offset:40960
    v_mfma_f32_16x16x32_bf16 v[40:43], v[96:99], v[124:127], v[40:43]
    ds_read_b64_tr_b16 v[142:143], v158 offset:41984
    v_mfma_f32_16x16x32_bf16 v[56:59], v[100:103], v[124:127], v[56:59]
    ds_read_b64_tr_b16 v[144:145], v159 offset:40960
    v_mfma_f32_16x16x32_bf16 v[72:75], v[84:87], v[124:127], v[72:75]
    ds_read_b64_tr_b16 v[146:147], v159 offset:41984
    v_mfma_f32_16x16x32_bf16 v[12:15], v[88:91], v[128:131], v[12:15]
    ds_read_b64_tr_b16 v[148:149], v160 offset:40960
    v_mfma_f32_16x16x32_bf16 v[28:31], v[92:95], v[128:131], v[28:31]
    ds_read_b64_tr_b16 v[150:151], v160 offset:41984
    v_mfma_f32_16x16x32_bf16 v[44:47], v[96:99], v[128:131], v[44:47]
    v_mfma_f32_16x16x32_bf16 v[60:63], v[100:103], v[128:131], v[60:63]
    v_mfma_f32_16x16x32_bf16 v[16:19], v[88:91], v[132:135], v[16:19]
    v_mfma_f32_16x16x32_bf16 v[32:35], v[92:95], v[132:135], v[32:35]
    v_mfma_f32_16x16x32_bf16 v[48:51], v[96:99], v[132:135], v[48:51]
    v_mfma_f32_16x16x32_bf16 v[64:67], v[100:103], v[132:135], v[64:67]
    s_waitcnt lgkmcnt(0)
    s_barrier
    v_mfma_f32_16x16x32_bf16 v[4:7], v[104:107], v[136:139], v[4:7]
    ds_read_b128 v[88:91], v1 offset:0
    v_mfma_f32_16x16x32_bf16 v[20:23], v[108:111], v[136:139], v[20:23]
    ds_read_b128 v[92:95], v1 offset:2048
    v_mfma_f32_16x16x32_bf16 v[36:39], v[112:115], v[136:139], v[36:39]
    ds_read_b128 v[96:99], v1 offset:4096
    v_mfma_f32_16x16x32_bf16 v[52:55], v[116:119], v[136:139], v[52:55]
    ds_read_b128 v[100:103], v1 offset:6144
    v_mfma_f32_16x16x32_bf16 v[68:71], v[84:87], v[136:139], v[68:71]
    ds_read_b64_tr_b16 v[120:121], v153 offset:0
    v_mfma_f32_16x16x32_bf16 v[8:11], v[104:107], v[140:143], v[8:11]
    ds_read_b64_tr_b16 v[122:123], v153 offset:1024
    v_mfma_f32_16x16x32_bf16 v[24:27], v[108:111], v[140:143], v[24:27]
    ds_read_b64_tr_b16 v[124:125], v154 offset:0
    v_mfma_f32_16x16x32_bf16 v[40:43], v[112:115], v[140:143], v[40:43]
    ds_read_b64_tr_b16 v[126:127], v154 offset:1024
    v_mfma_f32_16x16x32_bf16 v[56:59], v[116:119], v[140:143], v[56:59]
    ds_read_b64_tr_b16 v[128:129], v155 offset:0
    v_mfma_f32_16x16x32_bf16 v[72:75], v[84:87], v[140:143], v[72:75]
    ds_read_b64_tr_b16 v[130:131], v155 offset:1024
    v_mfma_f32_16x16x32_bf16 v[12:15], v[104:107], v[144:147], v[12:15]
    ds_read_b64_tr_b16 v[132:133], v156 offset:0
    v_mfma_f32_16x16x32_bf16 v[28:31], v[108:111], v[144:147], v[28:31]
    ds_read_b64_tr_b16 v[134:135], v156 offset:1024
    v_mfma_f32_16x16x32_bf16 v[44:47], v[112:115], v[144:147], v[44:47]
    v_mfma_f32_16x16x32_bf16 v[60:63], v[116:119], v[144:147], v[60:63]
    v_mfma_f32_16x16x32_bf16 v[16:19], v[104:107], v[148:151], v[16:19]
    v_mfma_f32_16x16x32_bf16 v[32:35], v[108:111], v[148:151], v[32:35]
    v_mfma_f32_16x16x32_bf16 v[48:51], v[112:115], v[148:151], v[48:51]
    v_mfma_f32_16x16x32_bf16 v[64:67], v[116:119], v[148:151], v[64:67]
    s_waitcnt lgkmcnt(0)
    v_mfma_f32_16x16x32_bf16 v[4:7], v[88:91], v[120:123], v[4:7]
    ds_read_b128 v[104:107], v2 offset:0
    v_mfma_f32_16x16x32_bf16 v[20:23], v[92:95], v[120:123], v[20:23]
    ds_read_b128 v[108:111], v2 offset:2048
    v_mfma_f32_16x16x32_bf16 v[36:39], v[96:99], v[120:123], v[36:39]
    ds_read_b128 v[112:115], v2 offset:4096
    v_mfma_f32_16x16x32_bf16 v[52:55], v[100:103], v[120:123], v[52:55]
    ds_read_b128 v[116:119], v2 offset:6144
    v_mfma_f32_16x16x32_bf16 v[68:71], v[84:87], v[120:123], v[68:71]
    ds_read_b64_tr_b16 v[136:137], v153 offset:8192
    v_mfma_f32_16x16x32_bf16 v[8:11], v[88:91], v[124:127], v[8:11]
    ds_read_b64_tr_b16 v[138:139], v153 offset:9216
    v_mfma_f32_16x16x32_bf16 v[24:27], v[92:95], v[124:127], v[24:27]
    ds_read_b64_tr_b16 v[140:141], v154 offset:8192
    v_mfma_f32_16x16x32_bf16 v[40:43], v[96:99], v[124:127], v[40:43]
    ds_read_b64_tr_b16 v[142:143], v154 offset:9216
    v_mfma_f32_16x16x32_bf16 v[56:59], v[100:103], v[124:127], v[56:59]
    ds_read_b64_tr_b16 v[144:145], v155 offset:8192
    v_mfma_f32_16x16x32_bf16 v[72:75], v[84:87], v[124:127], v[72:75]
    ds_read_b64_tr_b16 v[146:147], v155 offset:9216
    v_mfma_f32_16x16x32_bf16 v[12:15], v[88:91], v[128:131], v[12:15]
    ds_read_b64_tr_b16 v[148:149], v156 offset:8192
    v_mfma_f32_16x16x32_bf16 v[28:31], v[92:95], v[128:131], v[28:31]
    ds_read_b64_tr_b16 v[150:151], v156 offset:9216
    v_mfma_f32_16x16x32_bf16 v[44:47], v[96:99], v[128:131], v[44:47]
    v_mfma_f32_16x16x32_bf16 v[60:63], v[100:103], v[128:131], v[60:63]
    v_mfma_f32_16x16x32_bf16 v[16:19], v[88:91], v[132:135], v[16:19]
    v_mfma_f32_16x16x32_bf16 v[32:35], v[92:95], v[132:135], v[32:35]
    v_mfma_f32_16x16x32_bf16 v[48:51], v[96:99], v[132:135], v[48:51]
    v_mfma_f32_16x16x32_bf16 v[64:67], v[100:103], v[132:135], v[64:67]
    s_waitcnt lgkmcnt(0)
    s_barrier
    v_mfma_f32_16x16x32_bf16 v[4:7], v[104:107], v[136:139], v[4:7]
    ds_read_b128 v[88:91], v1 offset:32768
    v_mfma_f32_16x16x32_bf16 v[20:23], v[108:111], v[136:139], v[20:23]
    ds_read_b128 v[92:95], v1 offset:34816
    v_mfma_f32_16x16x32_bf16 v[36:39], v[112:115], v[136:139], v[36:39]
    ds_read_b128 v[96:99], v1 offset:36864
    v_mfma_f32_16x16x32_bf16 v[52:55], v[116:119], v[136:139], v[52:55]
    ds_read_b128 v[100:103], v1 offset:38912
    v_mfma_f32_16x16x32_bf16 v[68:71], v[84:87], v[136:139], v[68:71]
    ds_read_b64_tr_b16 v[120:121], v153 offset:32768
    v_mfma_f32_16x16x32_bf16 v[8:11], v[104:107], v[140:143], v[8:11]
    ds_read_b64_tr_b16 v[122:123], v153 offset:33792
    v_mfma_f32_16x16x32_bf16 v[24:27], v[108:111], v[140:143], v[24:27]
    ds_read_b64_tr_b16 v[124:125], v154 offset:32768
    v_mfma_f32_16x16x32_bf16 v[40:43], v[112:115], v[140:143], v[40:43]
    ds_read_b64_tr_b16 v[126:127], v154 offset:33792
    v_mfma_f32_16x16x32_bf16 v[56:59], v[116:119], v[140:143], v[56:59]
    ds_read_b64_tr_b16 v[128:129], v155 offset:32768
    v_mfma_f32_16x16x32_bf16 v[72:75], v[84:87], v[140:143], v[72:75]
    ds_read_b64_tr_b16 v[130:131], v155 offset:33792
    v_mfma_f32_16x16x32_bf16 v[12:15], v[104:107], v[144:147], v[12:15]
    ds_read_b64_tr_b16 v[132:133], v156 offset:32768
    v_mfma_f32_16x16x32_bf16 v[28:31], v[108:111], v[144:147], v[28:31]
    ds_read_b64_tr_b16 v[134:135], v156 offset:33792
    v_mfma_f32_16x16x32_bf16 v[44:47], v[112:115], v[144:147], v[44:47]
    v_mfma_f32_16x16x32_bf16 v[60:63], v[116:119], v[144:147], v[60:63]
    v_mfma_f32_16x16x32_bf16 v[16:19], v[104:107], v[148:151], v[16:19]
    v_mfma_f32_16x16x32_bf16 v[32:35], v[108:111], v[148:151], v[32:35]
    v_mfma_f32_16x16x32_bf16 v[48:51], v[112:115], v[148:151], v[48:51]
    v_mfma_f32_16x16x32_bf16 v[64:67], v[116:119], v[148:151], v[64:67]
    s_waitcnt lgkmcnt(0)
    v_mfma_f32_16x16x32_bf16 v[4:7], v[88:91], v[120:123], v[4:7]
    ds_read_b128 v[104:107], v2 offset:32768
    v_mfma_f32_16x16x32_bf16 v[20:23], v[92:95], v[120:123], v[20:23]
    ds_read_b128 v[108:111], v2 offset:34816
    v_mfma_f32_16x16x32_bf16 v[36:39], v[96:99], v[120:123], v[36:39]
    ds_read_b128 v[112:115], v2 offset:36864
    v_mfma_f32_16x16x32_bf16 v[52:55], v[100:103], v[120:123], v[52:55]
    ds_read_b128 v[116:119], v2 offset:38912
    v_mfma_f32_16x16x32_bf16 v[68:71], v[84:87], v[120:123], v[68:71]
    ds_read_b64_tr_b16 v[136:137], v153 offset:40960
    v_mfma_f32_16x16x32_bf16 v[8:11], v[88:91], v[124:127], v[8:11]
    ds_read_b64_tr_b16 v[138:139], v153 offset:41984
    v_mfma_f32_16x16x32_bf16 v[24:27], v[92:95], v[124:127], v[24:27]
    ds_read_b64_tr_b16 v[140:141], v154 offset:40960
    v_mfma_f32_16x16x32_bf16 v[40:43], v[96:99], v[124:127], v[40:43]
    ds_read_b64_tr_b16 v[142:143], v154 offset:41984
    v_mfma_f32_16x16x32_bf16 v[56:59], v[100:103], v[124:127], v[56:59]
    ds_read_b64_tr_b16 v[144:145], v155 offset:40960
    v_mfma_f32_16x16x32_bf16 v[72:75], v[84:87], v[124:127], v[72:75]
    ds_read_b64_tr_b16 v[146:147], v155 offset:41984
    v_mfma_f32_16x16x32_bf16 v[12:15], v[88:91], v[128:131], v[12:15]
    ds_read_b64_tr_b16 v[148:149], v156 offset:40960
    v_mfma_f32_16x16x32_bf16 v[28:31], v[92:95], v[128:131], v[28:31]
    ds_read_b64_tr_b16 v[150:151], v156 offset:41984
    v_mfma_f32_16x16x32_bf16 v[44:47], v[96:99], v[128:131], v[44:47]
    v_mfma_f32_16x16x32_bf16 v[60:63], v[100:103], v[128:131], v[60:63]
    v_mfma_f32_16x16x32_bf16 v[16:19], v[88:91], v[132:135], v[16:19]
    v_mfma_f32_16x16x32_bf16 v[32:35], v[92:95], v[132:135], v[32:35]
    v_mfma_f32_16x16x32_bf16 v[48:51], v[96:99], v[132:135], v[48:51]
    v_mfma_f32_16x16x32_bf16 v[64:67], v[100:103], v[132:135], v[64:67]
    s_waitcnt lgkmcnt(0)
    s_barrier
    v_mfma_f32_16x16x32_bf16 v[4:7], v[104:107], v[136:139], v[4:7]
    ds_read_b128 v[88:91], v3 offset:0
    v_mfma_f32_16x16x32_bf16 v[20:23], v[108:111], v[136:139], v[20:23]
    ds_read_b128 v[92:95], v3 offset:2048
    v_mfma_f32_16x16x32_bf16 v[36:39], v[112:115], v[136:139], v[36:39]
    ds_read_b128 v[96:99], v3 offset:4096
    v_mfma_f32_16x16x32_bf16 v[52:55], v[116:119], v[136:139], v[52:55]
    ds_read_b128 v[100:103], v3 offset:6144
    v_mfma_f32_16x16x32_bf16 v[68:71], v[84:87], v[136:139], v[68:71]
    ds_read_b64_tr_b16 v[120:121], v157 offset:0
    v_mfma_f32_16x16x32_bf16 v[8:11], v[104:107], v[140:143], v[8:11]
    ds_read_b64_tr_b16 v[122:123], v157 offset:1024
    v_mfma_f32_16x16x32_bf16 v[24:27], v[108:111], v[140:143], v[24:27]
    ds_read_b64_tr_b16 v[124:125], v158 offset:0
    v_mfma_f32_16x16x32_bf16 v[40:43], v[112:115], v[140:143], v[40:43]
    ds_read_b64_tr_b16 v[126:127], v158 offset:1024
    v_mfma_f32_16x16x32_bf16 v[56:59], v[116:119], v[140:143], v[56:59]
    ds_read_b64_tr_b16 v[128:129], v159 offset:0
    v_mfma_f32_16x16x32_bf16 v[72:75], v[84:87], v[140:143], v[72:75]
    ds_read_b64_tr_b16 v[130:131], v159 offset:1024
    v_mfma_f32_16x16x32_bf16 v[12:15], v[104:107], v[144:147], v[12:15]
    ds_read_b64_tr_b16 v[132:133], v160 offset:0
    v_mfma_f32_16x16x32_bf16 v[28:31], v[108:111], v[144:147], v[28:31]
    ds_read_b64_tr_b16 v[134:135], v160 offset:1024
    v_mfma_f32_16x16x32_bf16 v[44:47], v[112:115], v[144:147], v[44:47]
    v_mfma_f32_16x16x32_bf16 v[60:63], v[116:119], v[144:147], v[60:63]
    v_mfma_f32_16x16x32_bf16 v[16:19], v[104:107], v[148:151], v[16:19]
    v_mfma_f32_16x16x32_bf16 v[32:35], v[108:111], v[148:151], v[32:35]
    v_mfma_f32_16x16x32_bf16 v[48:51], v[112:115], v[148:151], v[48:51]
    v_mfma_f32_16x16x32_bf16 v[64:67], v[116:119], v[148:151], v[64:67]
    s_waitcnt lgkmcnt(0)
    v_mfma_f32_16x16x32_bf16 v[4:7], v[88:91], v[120:123], v[4:7]
    ds_read_b128 v[104:107], v152 offset:0
    v_mfma_f32_16x16x32_bf16 v[20:23], v[92:95], v[120:123], v[20:23]
    ds_read_b128 v[108:111], v152 offset:2048
    v_mfma_f32_16x16x32_bf16 v[36:39], v[96:99], v[120:123], v[36:39]
    ds_read_b128 v[112:115], v152 offset:4096
    v_mfma_f32_16x16x32_bf16 v[52:55], v[100:103], v[120:123], v[52:55]
    ds_read_b128 v[116:119], v152 offset:6144
    v_mfma_f32_16x16x32_bf16 v[68:71], v[84:87], v[120:123], v[68:71]
    ds_read_b64_tr_b16 v[136:137], v157 offset:8192
    v_mfma_f32_16x16x32_bf16 v[8:11], v[88:91], v[124:127], v[8:11]
    ds_read_b64_tr_b16 v[138:139], v157 offset:9216
    v_mfma_f32_16x16x32_bf16 v[24:27], v[92:95], v[124:127], v[24:27]
    ds_read_b64_tr_b16 v[140:141], v158 offset:8192
    v_mfma_f32_16x16x32_bf16 v[40:43], v[96:99], v[124:127], v[40:43]
    ds_read_b64_tr_b16 v[142:143], v158 offset:9216
    v_mfma_f32_16x16x32_bf16 v[56:59], v[100:103], v[124:127], v[56:59]
    ds_read_b64_tr_b16 v[144:145], v159 offset:8192
    v_mfma_f32_16x16x32_bf16 v[72:75], v[84:87], v[124:127], v[72:75]
    ds_read_b64_tr_b16 v[146:147], v159 offset:9216
    v_mfma_f32_16x16x32_bf16 v[12:15], v[88:91], v[128:131], v[12:15]
    ds_read_b64_tr_b16 v[148:149], v160 offset:8192
    v_mfma_f32_16x16x32_bf16 v[28:31], v[92:95], v[128:131], v[28:31]
    ds_read_b64_tr_b16 v[150:151], v160 offset:9216
    v_mfma_f32_16x16x32_bf16 v[44:47], v[96:99], v[128:131], v[44:47]
    v_mfma_f32_16x16x32_bf16 v[60:63], v[100:103], v[128:131], v[60:63]
    v_mfma_f32_16x16x32_bf16 v[16:19], v[88:91], v[132:135], v[16:19]
    v_mfma_f32_16x16x32_bf16 v[32:35], v[92:95], v[132:135], v[32:35]
    v_mfma_f32_16x16x32_bf16 v[48:51], v[96:99], v[132:135], v[48:51]
    v_mfma_f32_16x16x32_bf16 v[64:67], v[100:103], v[132:135], v[64:67]
    s_waitcnt lgkmcnt(0)
    s_barrier
    v_mfma_f32_16x16x32_bf16 v[4:7], v[104:107], v[136:139], v[4:7]
    ds_read_b128 v[88:91], v3 offset:32768
    v_mfma_f32_16x16x32_bf16 v[20:23], v[108:111], v[136:139], v[20:23]
    ds_read_b128 v[92:95], v3 offset:34816
    v_mfma_f32_16x16x32_bf16 v[36:39], v[112:115], v[136:139], v[36:39]
    ds_read_b128 v[96:99], v3 offset:36864
    v_mfma_f32_16x16x32_bf16 v[52:55], v[116:119], v[136:139], v[52:55]
    ds_read_b128 v[100:103], v3 offset:38912
    v_mfma_f32_16x16x32_bf16 v[68:71], v[84:87], v[136:139], v[68:71]
    ds_read_b64_tr_b16 v[120:121], v157 offset:32768
    v_mfma_f32_16x16x32_bf16 v[8:11], v[104:107], v[140:143], v[8:11]
    ds_read_b64_tr_b16 v[122:123], v157 offset:33792
    v_mfma_f32_16x16x32_bf16 v[24:27], v[108:111], v[140:143], v[24:27]
    ds_read_b64_tr_b16 v[124:125], v158 offset:32768
    v_mfma_f32_16x16x32_bf16 v[40:43], v[112:115], v[140:143], v[40:43]
    ds_read_b64_tr_b16 v[126:127], v158 offset:33792
    v_mfma_f32_16x16x32_bf16 v[56:59], v[116:119], v[140:143], v[56:59]
    ds_read_b64_tr_b16 v[128:129], v159 offset:32768
    v_mfma_f32_16x16x32_bf16 v[72:75], v[84:87], v[140:143], v[72:75]
    ds_read_b64_tr_b16 v[130:131], v159 offset:33792
    v_mfma_f32_16x16x32_bf16 v[12:15], v[104:107], v[144:147], v[12:15]
    ds_read_b64_tr_b16 v[132:133], v160 offset:32768
    v_mfma_f32_16x16x32_bf16 v[28:31], v[108:111], v[144:147], v[28:31]
    ds_read_b64_tr_b16 v[134:135], v160 offset:33792
    v_mfma_f32_16x16x32_bf16 v[44:47], v[112:115], v[144:147], v[44:47]
    v_mfma_f32_16x16x32_bf16 v[60:63], v[116:119], v[144:147], v[60:63]
    v_mfma_f32_16x16x32_bf16 v[16:19], v[104:107], v[148:151], v[16:19]
    v_mfma_f32_16x16x32_bf16 v[32:35], v[108:111], v[148:151], v[32:35]
    v_mfma_f32_16x16x32_bf16 v[48:51], v[112:115], v[148:151], v[48:51]
    v_mfma_f32_16x16x32_bf16 v[64:67], v[116:119], v[148:151], v[64:67]
    s_waitcnt lgkmcnt(0)
    v_mfma_f32_16x16x32_bf16 v[4:7], v[88:91], v[120:123], v[4:7]
    ds_read_b128 v[104:107], v152 offset:32768
    v_mfma_f32_16x16x32_bf16 v[20:23], v[92:95], v[120:123], v[20:23]
    ds_read_b128 v[108:111], v152 offset:34816
    v_mfma_f32_16x16x32_bf16 v[36:39], v[96:99], v[120:123], v[36:39]
    ds_read_b128 v[112:115], v152 offset:36864
    v_mfma_f32_16x16x32_bf16 v[52:55], v[100:103], v[120:123], v[52:55]
    ds_read_b128 v[116:119], v152 offset:38912
    v_mfma_f32_16x16x32_bf16 v[68:71], v[84:87], v[120:123], v[68:71]
    ds_read_b64_tr_b16 v[136:137], v157 offset:40960
    v_mfma_f32_16x16x32_bf16 v[8:11], v[88:91], v[124:127], v[8:11]
    ds_read_b64_tr_b16 v[138:139], v157 offset:41984
    v_mfma_f32_16x16x32_bf16 v[24:27], v[92:95], v[124:127], v[24:27]
    ds_read_b64_tr_b16 v[140:141], v158 offset:40960
    v_mfma_f32_16x16x32_bf16 v[40:43], v[96:99], v[124:127], v[40:43]
    ds_read_b64_tr_b16 v[142:143], v158 offset:41984
    v_mfma_f32_16x16x32_bf16 v[56:59], v[100:103], v[124:127], v[56:59]
    ds_read_b64_tr_b16 v[144:145], v159 offset:40960
    v_mfma_f32_16x16x32_bf16 v[72:75], v[84:87], v[124:127], v[72:75]
    ds_read_b64_tr_b16 v[146:147], v159 offset:41984
    v_mfma_f32_16x16x32_bf16 v[12:15], v[88:91], v[128:131], v[12:15]
    ds_read_b64_tr_b16 v[148:149], v160 offset:40960
    v_mfma_f32_16x16x32_bf16 v[28:31], v[92:95], v[128:131], v[28:31]
    ds_read_b64_tr_b16 v[150:151], v160 offset:41984
    v_mfma_f32_16x16x32_bf16 v[44:47], v[96:99], v[128:131], v[44:47]
    v_mfma_f32_16x16x32_bf16 v[60:63], v[100:103], v[128:131], v[60:63]
    v_mfma_f32_16x16x32_bf16 v[16:19], v[88:91], v[132:135], v[16:19]
    v_mfma_f32_16x16x32_bf16 v[32:35], v[92:95], v[132:135], v[32:35]
    v_mfma_f32_16x16x32_bf16 v[48:51], v[96:99], v[132:135], v[48:51]
    v_mfma_f32_16x16x32_bf16 v[64:67], v[100:103], v[132:135], v[64:67]
    s_waitcnt lgkmcnt(0)
    s_barrier
    v_mfma_f32_16x16x32_bf16 v[4:7], v[104:107], v[136:139], v[4:7]
    ds_read_b128 v[88:91], v1 offset:0
    v_mfma_f32_16x16x32_bf16 v[20:23], v[108:111], v[136:139], v[20:23]
    ds_read_b128 v[92:95], v1 offset:2048
    v_mfma_f32_16x16x32_bf16 v[36:39], v[112:115], v[136:139], v[36:39]
    ds_read_b128 v[96:99], v1 offset:4096
    v_mfma_f32_16x16x32_bf16 v[52:55], v[116:119], v[136:139], v[52:55]
    ds_read_b128 v[100:103], v1 offset:6144
    v_mfma_f32_16x16x32_bf16 v[68:71], v[84:87], v[136:139], v[68:71]
    ds_read_b64_tr_b16 v[120:121], v153 offset:0
    v_mfma_f32_16x16x32_bf16 v[8:11], v[104:107], v[140:143], v[8:11]
    ds_read_b64_tr_b16 v[122:123], v153 offset:1024
    v_mfma_f32_16x16x32_bf16 v[24:27], v[108:111], v[140:143], v[24:27]
    ds_read_b64_tr_b16 v[124:125], v154 offset:0
    v_mfma_f32_16x16x32_bf16 v[40:43], v[112:115], v[140:143], v[40:43]
    ds_read_b64_tr_b16 v[126:127], v154 offset:1024
    v_mfma_f32_16x16x32_bf16 v[56:59], v[116:119], v[140:143], v[56:59]
    ds_read_b64_tr_b16 v[128:129], v155 offset:0
    v_mfma_f32_16x16x32_bf16 v[72:75], v[84:87], v[140:143], v[72:75]
    ds_read_b64_tr_b16 v[130:131], v155 offset:1024
    v_mfma_f32_16x16x32_bf16 v[12:15], v[104:107], v[144:147], v[12:15]
    ds_read_b64_tr_b16 v[132:133], v156 offset:0
    v_mfma_f32_16x16x32_bf16 v[28:31], v[108:111], v[144:147], v[28:31]
    ds_read_b64_tr_b16 v[134:135], v156 offset:1024
    v_mfma_f32_16x16x32_bf16 v[44:47], v[112:115], v[144:147], v[44:47]
    v_mfma_f32_16x16x32_bf16 v[60:63], v[116:119], v[144:147], v[60:63]
    v_mfma_f32_16x16x32_bf16 v[16:19], v[104:107], v[148:151], v[16:19]
    v_mfma_f32_16x16x32_bf16 v[32:35], v[108:111], v[148:151], v[32:35]
    v_mfma_f32_16x16x32_bf16 v[48:51], v[112:115], v[148:151], v[48:51]
    v_mfma_f32_16x16x32_bf16 v[64:67], v[116:119], v[148:151], v[64:67]
    s_waitcnt lgkmcnt(0)
    v_mfma_f32_16x16x32_bf16 v[4:7], v[88:91], v[120:123], v[4:7]
    ds_read_b128 v[104:107], v2 offset:0
    v_mfma_f32_16x16x32_bf16 v[20:23], v[92:95], v[120:123], v[20:23]
    ds_read_b128 v[108:111], v2 offset:2048
    v_mfma_f32_16x16x32_bf16 v[36:39], v[96:99], v[120:123], v[36:39]
    ds_read_b128 v[112:115], v2 offset:4096
    v_mfma_f32_16x16x32_bf16 v[52:55], v[100:103], v[120:123], v[52:55]
    ds_read_b128 v[116:119], v2 offset:6144
    v_mfma_f32_16x16x32_bf16 v[68:71], v[84:87], v[120:123], v[68:71]
    ds_read_b64_tr_b16 v[136:137], v153 offset:8192
    v_mfma_f32_16x16x32_bf16 v[8:11], v[88:91], v[124:127], v[8:11]
    ds_read_b64_tr_b16 v[138:139], v153 offset:9216
    v_mfma_f32_16x16x32_bf16 v[24:27], v[92:95], v[124:127], v[24:27]
    ds_read_b64_tr_b16 v[140:141], v154 offset:8192
    v_mfma_f32_16x16x32_bf16 v[40:43], v[96:99], v[124:127], v[40:43]
    ds_read_b64_tr_b16 v[142:143], v154 offset:9216
    v_mfma_f32_16x16x32_bf16 v[56:59], v[100:103], v[124:127], v[56:59]
    ds_read_b64_tr_b16 v[144:145], v155 offset:8192
    v_mfma_f32_16x16x32_bf16 v[72:75], v[84:87], v[124:127], v[72:75]
    ds_read_b64_tr_b16 v[146:147], v155 offset:9216
    v_mfma_f32_16x16x32_bf16 v[12:15], v[88:91], v[128:131], v[12:15]
    ds_read_b64_tr_b16 v[148:149], v156 offset:8192
    v_mfma_f32_16x16x32_bf16 v[28:31], v[92:95], v[128:131], v[28:31]
    ds_read_b64_tr_b16 v[150:151], v156 offset:9216
    v_mfma_f32_16x16x32_bf16 v[44:47], v[96:99], v[128:131], v[44:47]
    v_mfma_f32_16x16x32_bf16 v[60:63], v[100:103], v[128:131], v[60:63]
    v_mfma_f32_16x16x32_bf16 v[16:19], v[88:91], v[132:135], v[16:19]
    v_mfma_f32_16x16x32_bf16 v[32:35], v[92:95], v[132:135], v[32:35]
    v_mfma_f32_16x16x32_bf16 v[48:51], v[96:99], v[132:135], v[48:51]
    v_mfma_f32_16x16x32_bf16 v[64:67], v[100:103], v[132:135], v[64:67]
    s_waitcnt lgkmcnt(0)
    s_barrier
    v_mfma_f32_16x16x32_bf16 v[4:7], v[104:107], v[136:139], v[4:7]
    ds_read_b128 v[88:91], v1 offset:32768
    v_mfma_f32_16x16x32_bf16 v[20:23], v[108:111], v[136:139], v[20:23]
    ds_read_b128 v[92:95], v1 offset:34816
    v_mfma_f32_16x16x32_bf16 v[36:39], v[112:115], v[136:139], v[36:39]
    ds_read_b128 v[96:99], v1 offset:36864
    v_mfma_f32_16x16x32_bf16 v[52:55], v[116:119], v[136:139], v[52:55]
    ds_read_b128 v[100:103], v1 offset:38912
    v_mfma_f32_16x16x32_bf16 v[68:71], v[84:87], v[136:139], v[68:71]
    ds_read_b64_tr_b16 v[120:121], v153 offset:32768
    v_mfma_f32_16x16x32_bf16 v[8:11], v[104:107], v[140:143], v[8:11]
    ds_read_b64_tr_b16 v[122:123], v153 offset:33792
    v_mfma_f32_16x16x32_bf16 v[24:27], v[108:111], v[140:143], v[24:27]
    ds_read_b64_tr_b16 v[124:125], v154 offset:32768
    v_mfma_f32_16x16x32_bf16 v[40:43], v[112:115], v[140:143], v[40:43]
    ds_read_b64_tr_b16 v[126:127], v154 offset:33792
    v_mfma_f32_16x16x32_bf16 v[56:59], v[116:119], v[140:143], v[56:59]
    ds_read_b64_tr_b16 v[128:129], v155 offset:32768
    v_mfma_f32_16x16x32_bf16 v[72:75], v[84:87], v[140:143], v[72:75]
    ds_read_b64_tr_b16 v[130:131], v155 offset:33792
    v_mfma_f32_16x16x32_bf16 v[12:15], v[104:107], v[144:147], v[12:15]
    ds_read_b64_tr_b16 v[132:133], v156 offset:32768
    v_mfma_f32_16x16x32_bf16 v[28:31], v[108:111], v[144:147], v[28:31]
    ds_read_b64_tr_b16 v[134:135], v156 offset:33792
    v_mfma_f32_16x16x32_bf16 v[44:47], v[112:115], v[144:147], v[44:47]
    v_mfma_f32_16x16x32_bf16 v[60:63], v[116:119], v[144:147], v[60:63]
    v_mfma_f32_16x16x32_bf16 v[16:19], v[104:107], v[148:151], v[16:19]
    v_mfma_f32_16x16x32_bf16 v[32:35], v[108:111], v[148:151], v[32:35]
    v_mfma_f32_16x16x32_bf16 v[48:51], v[112:115], v[148:151], v[48:51]
    v_mfma_f32_16x16x32_bf16 v[64:67], v[116:119], v[148:151], v[64:67]
    s_waitcnt lgkmcnt(0)
    v_mfma_f32_16x16x32_bf16 v[4:7], v[88:91], v[120:123], v[4:7]
    ds_read_b128 v[104:107], v2 offset:32768
    v_mfma_f32_16x16x32_bf16 v[20:23], v[92:95], v[120:123], v[20:23]
    ds_read_b128 v[108:111], v2 offset:34816
    v_mfma_f32_16x16x32_bf16 v[36:39], v[96:99], v[120:123], v[36:39]
    ds_read_b128 v[112:115], v2 offset:36864
    v_mfma_f32_16x16x32_bf16 v[52:55], v[100:103], v[120:123], v[52:55]
    ds_read_b128 v[116:119], v2 offset:38912
    v_mfma_f32_16x16x32_bf16 v[68:71], v[84:87], v[120:123], v[68:71]
    ds_read_b64_tr_b16 v[136:137], v153 offset:40960
    v_mfma_f32_16x16x32_bf16 v[8:11], v[88:91], v[124:127], v[8:11]
    ds_read_b64_tr_b16 v[138:139], v153 offset:41984
    v_mfma_f32_16x16x32_bf16 v[24:27], v[92:95], v[124:127], v[24:27]
    ds_read_b64_tr_b16 v[140:141], v154 offset:40960
    v_mfma_f32_16x16x32_bf16 v[40:43], v[96:99], v[124:127], v[40:43]
    ds_read_b64_tr_b16 v[142:143], v154 offset:41984
    v_mfma_f32_16x16x32_bf16 v[56:59], v[100:103], v[124:127], v[56:59]
    ds_read_b64_tr_b16 v[144:145], v155 offset:40960
    v_mfma_f32_16x16x32_bf16 v[72:75], v[84:87], v[124:127], v[72:75]
    ds_read_b64_tr_b16 v[146:147], v155 offset:41984
    v_mfma_f32_16x16x32_bf16 v[12:15], v[88:91], v[128:131], v[12:15]
    ds_read_b64_tr_b16 v[148:149], v156 offset:40960
    v_mfma_f32_16x16x32_bf16 v[28:31], v[92:95], v[128:131], v[28:31]
    ds_read_b64_tr_b16 v[150:151], v156 offset:41984
    v_mfma_f32_16x16x32_bf16 v[44:47], v[96:99], v[128:131], v[44:47]
    v_mfma_f32_16x16x32_bf16 v[60:63], v[100:103], v[128:131], v[60:63]
    v_mfma_f32_16x16x32_bf16 v[16:19], v[88:91], v[132:135], v[16:19]
    v_mfma_f32_16x16x32_bf16 v[32:35], v[92:95], v[132:135], v[32:35]
    v_mfma_f32_16x16x32_bf16 v[48:51], v[96:99], v[132:135], v[48:51]
    v_mfma_f32_16x16x32_bf16 v[64:67], v[100:103], v[132:135], v[64:67]
    s_waitcnt lgkmcnt(0)
    v_mfma_f32_16x16x32_bf16 v[4:7], v[104:107], v[136:139], v[4:7]
    v_mfma_f32_16x16x32_bf16 v[20:23], v[108:111], v[136:139], v[20:23]
    v_mfma_f32_16x16x32_bf16 v[36:39], v[112:115], v[136:139], v[36:39]
    v_mfma_f32_16x16x32_bf16 v[52:55], v[116:119], v[136:139], v[52:55]
    v_mfma_f32_16x16x32_bf16 v[68:71], v[84:87], v[136:139], v[68:71]
    v_mfma_f32_16x16x32_bf16 v[8:11], v[104:107], v[140:143], v[8:11]
    v_mfma_f32_16x16x32_bf16 v[24:27], v[108:111], v[140:143], v[24:27]
    v_mfma_f32_16x16x32_bf16 v[40:43], v[112:115], v[140:143], v[40:43]
    v_mfma_f32_16x16x32_bf16 v[56:59], v[116:119], v[140:143], v[56:59]
    v_mfma_f32_16x16x32_bf16 v[72:75], v[84:87], v[140:143], v[72:75]
    v_mfma_f32_16x16x32_bf16 v[12:15], v[104:107], v[144:147], v[12:15]
    v_mfma_f32_16x16x32_bf16 v[28:31], v[108:111], v[144:147], v[28:31]
    v_mfma_f32_16x16x32_bf16 v[44:47], v[112:115], v[144:147], v[44:47]
    v_mfma_f32_16x16x32_bf16 v[60:63], v[116:119], v[144:147], v[60:63]
    v_mfma_f32_16x16x32_bf16 v[16:19], v[104:107], v[148:151], v[16:19]
    v_mfma_f32_16x16x32_bf16 v[32:35], v[108:111], v[148:151], v[32:35]
    v_mfma_f32_16x16x32_bf16 v[48:51], v[112:115], v[148:151], v[48:51]
    v_mfma_f32_16x16x32_bf16 v[64:67], v[116:119], v[148:151], v[64:67]
    s_lshl_b32 s50, s49, 8
    s_add_u32 s50, s50, 131072
    v_and_b32 v162, 15, v0
    v_lshl_add_u32 v166, v162, 2, s50
    s_lshl_b32 s51, s60, 6
    v_add_u32 v168, s51, v166
    s_lshl_b32 s51, s61, 6
    v_add_u32 v169, s51, v166
    s_lshl_b32 s51, s62, 6
    v_add_u32 v170, s51, v166
    s_lshl_b32 s51, s63, 6
    v_add_u32 v171, s51, v166
    ds_write_b32 v168, v68
    ds_write_b32 v169, v72
    s_waitcnt lgkmcnt(0)
    s_barrier
    ds_read_b32 v76, v170
    ds_read_b32 v80, v171
    v_lshrrev_b32 v162, 4, v0
    s_lshl_b32 s50, s48, 9
    s_add_u32 s50, s50, 162816
    v_lshl_add_u32 v161, v162, 5, s50
    ds_read_b128 v[172:175], v161 offset:0
    ds_read_b128 v[176:179], v161 offset:16
    ds_read_b128 v[180:183], v161 offset:128
    ds_read_b128 v[184:187], v161 offset:144
    ds_read_b128 v[188:191], v161 offset:256
    ds_read_b128 v[192:195], v161 offset:272
    ds_read_b128 v[196:199], v161 offset:384
    ds_read_b128 v[200:203], v161 offset:400
    s_sub_u32 s50, s44, 10
    s_lshl_b32 s50, s50, 7
    s_lshl_b32 s52, s49, 6
    s_add_u32 s50, s50, s52
    v_and_b32 v161, 15, v0
    v_add_u32 v161, s50, v161
    s_mov_b32 s52, 81920
    s_lshl_b32 s53, s60, 4
    v_add_u32 v163, s53, v161
    v_mul_u32_u24 v164, 3277, v163
    v_lshrrev_b32 v164, 16, v164
    v_mul_u32_u24 v165, 20, v164
    v_sub_u32 v163, v163, v165
    v_lshlrev_b32 v167, 8, v162
    v_lshlrev_b32 v208, 6, v162
    v_add_u32 v208, 768, v208
    v_cmp_gt_u32 vcc, 16, v163
    s_nop 1
    v_cndmask_b32 v167, v208, v167, vcc
    v_lshl_add_u32 v167, v163, 4, v167
    v_mad_u32_u24 v204, v164, s52, v167
    s_lshl_b32 s53, s61, 4
    v_add_u32 v163, s53, v161
    v_mul_u32_u24 v164, 3277, v163
    v_lshrrev_b32 v164, 16, v164
    v_mul_u32_u24 v165, 20, v164
    v_sub_u32 v163, v163, v165
    v_lshlrev_b32 v167, 8, v162
    v_lshlrev_b32 v208, 6, v162
    v_add_u32 v208, 768, v208
    v_cmp_gt_u32 vcc, 16, v163
    s_nop 1
    v_cndmask_b32 v167, v208, v167, vcc
    v_lshl_add_u32 v167, v163, 4, v167
    v_mad_u32_u24 v205, v164, s52, v167
    s_lshl_b32 s53, s62, 4
    v_add_u32 v163, s53, v161
    v_mul_u32_u24 v164, 3277, v163
    v_lshrrev_b32 v164, 16, v164
    v_mul_u32_u24 v165, 20, v164
    v_sub_u32 v163, v163, v165
    v_lshlrev_b32 v167, 8, v162
    v_lshlrev_b32 v208, 6, v162
    v_add_u32 v208, 768, v208
    v_cmp_gt_u32 vcc, 16, v163
    s_nop 1
    v_cndmask_b32 v167, v208, v167, vcc
    v_lshl_add_u32 v167, v163, 4, v167
    v_mad_u32_u24 v206, v164, s52, v167
    s_lshl_b32 s53, s63, 4
    v_add_u32 v163, s53, v161
    v_mul_u32_u24 v164, 3277, v163
    v_lshrrev_b32 v164, 16, v164
    v_mul_u32_u24 v165, 20, v164
    v_sub_u32 v163, v163, v165
    v_lshlrev_b32 v167, 8, v162
    v_lshlrev_b32 v208, 6, v162
    v_add_u32 v208, 768, v208
    v_cmp_gt_u32 vcc, 16, v163
    s_nop 1
    v_cndmask_b32 v167, v208, v167, vcc
    v_lshl_add_u32 v167, v163, 4, v167
    v_mad_u32_u24 v207, v164, s52, v167
    s_lshl_b32 s50, s43, 2
    s_lshl_b32 s52, s48, 1
    s_add_u32 s50, s50, s52
    s_mul_i32 s50, s50, 1280
    s_add_u32 s50, s50, 5308416
    s_waitcnt lgkmcnt(0)
    v_mul_f32 v4, v4, v172
    v_mul_f32 v5, v5, v174
    v_mul_f32 v6, v6, v176
    v_mul_f32 v7, v7, v178
    v_fmac_f32 v4, v68, v173
    v_fmac_f32 v5, v68, v175
    v_fmac_f32 v6, v68, v177
    v_fmac_f32 v7, v68, v179
    v_cvt_pk_bf16_f32 v212, v4, v5
    v_cvt_pk_bf16_f32 v213, v6, v7
    v_mul_f32 v20, v20, v180
    v_mul_f32 v21, v21, v182
    v_mul_f32 v22, v22, v184
    v_mul_f32 v23, v23, v186
    v_fmac_f32 v20, v68, v181
    v_fmac_f32 v21, v68, v183
    v_fmac_f32 v22, v68, v185
    v_fmac_f32 v23, v68, v187
    v_cvt_pk_bf16_f32 v214, v20, v21
    v_cvt_pk_bf16_f32 v215, v22, v23
    buffer_store_dwordx4 v[212:215], v204, s[24:27], s50 offen offset:0 sc1
    v_mul_f32 v36, v36, v188
    v_mul_f32 v37, v37, v190
    v_mul_f32 v38, v38, v192
    v_mul_f32 v39, v39, v194
    v_fmac_f32 v36, v68, v189
    v_fmac_f32 v37, v68, v191
    v_fmac_f32 v38, v68, v193
    v_fmac_f32 v39, v68, v195
    v_cvt_pk_bf16_f32 v216, v36, v37
    v_cvt_pk_bf16_f32 v217, v38, v39
    v_mul_f32 v52, v52, v196
    v_mul_f32 v53, v53, v198
    v_mul_f32 v54, v54, v200
    v_mul_f32 v55, v55, v202
    v_fmac_f32 v52, v68, v197
    v_fmac_f32 v53, v68, v199
    v_fmac_f32 v54, v68, v201
    v_fmac_f32 v55, v68, v203
    v_cvt_pk_bf16_f32 v218, v52, v53
    v_cvt_pk_bf16_f32 v219, v54, v55
    buffer_store_dwordx4 v[216:219], v204, s[24:27], s50 offen offset:1280 sc1
    v_mul_f32 v8, v8, v172
    v_mul_f32 v9, v9, v174
    v_mul_f32 v10, v10, v176
    v_mul_f32 v11, v11, v178
    v_fmac_f32 v8, v72, v173
    v_fmac_f32 v9, v72, v175
    v_fmac_f32 v10, v72, v177
    v_fmac_f32 v11, v72, v179
    v_cvt_pk_bf16_f32 v212, v8, v9
    v_cvt_pk_bf16_f32 v213, v10, v11
    v_mul_f32 v24, v24, v180
    v_mul_f32 v25, v25, v182
    v_mul_f32 v26, v26, v184
    v_mul_f32 v27, v27, v186
    v_fmac_f32 v24, v72, v181
    v_fmac_f32 v25, v72, v183
    v_fmac_f32 v26, v72, v185
    v_fmac_f32 v27, v72, v187
    v_cvt_pk_bf16_f32 v214, v24, v25
    v_cvt_pk_bf16_f32 v215, v26, v27
    buffer_store_dwordx4 v[212:215], v205, s[24:27], s50 offen offset:0 sc1
    v_mul_f32 v40, v40, v188
    v_mul_f32 v41, v41, v190
    v_mul_f32 v42, v42, v192
    v_mul_f32 v43, v43, v194
    v_fmac_f32 v40, v72, v189
    v_fmac_f32 v41, v72, v191
    v_fmac_f32 v42, v72, v193
    v_fmac_f32 v43, v72, v195
    v_cvt_pk_bf16_f32 v216, v40, v41
    v_cvt_pk_bf16_f32 v217, v42, v43
    v_mul_f32 v56, v56, v196
    v_mul_f32 v57, v57, v198
    v_mul_f32 v58, v58, v200
    v_mul_f32 v59, v59, v202
    v_fmac_f32 v56, v72, v197
    v_fmac_f32 v57, v72, v199
    v_fmac_f32 v58, v72, v201
    v_fmac_f32 v59, v72, v203
    v_cvt_pk_bf16_f32 v218, v56, v57
    v_cvt_pk_bf16_f32 v219, v58, v59
    buffer_store_dwordx4 v[216:219], v205, s[24:27], s50 offen offset:1280 sc1
    v_mul_f32 v12, v12, v172
    v_mul_f32 v13, v13, v174
    v_mul_f32 v14, v14, v176
    v_mul_f32 v15, v15, v178
    v_fmac_f32 v12, v76, v173
    v_fmac_f32 v13, v76, v175
    v_fmac_f32 v14, v76, v177
    v_fmac_f32 v15, v76, v179
    v_cvt_pk_bf16_f32 v212, v12, v13
    v_cvt_pk_bf16_f32 v213, v14, v15
    v_mul_f32 v28, v28, v180
    v_mul_f32 v29, v29, v182
    v_mul_f32 v30, v30, v184
    v_mul_f32 v31, v31, v186
    v_fmac_f32 v28, v76, v181
    v_fmac_f32 v29, v76, v183
    v_fmac_f32 v30, v76, v185
    v_fmac_f32 v31, v76, v187
    v_cvt_pk_bf16_f32 v214, v28, v29
    v_cvt_pk_bf16_f32 v215, v30, v31
    buffer_store_dwordx4 v[212:215], v206, s[24:27], s50 offen offset:0 sc1
    v_mul_f32 v44, v44, v188
    v_mul_f32 v45, v45, v190
    v_mul_f32 v46, v46, v192
    v_mul_f32 v47, v47, v194
    v_fmac_f32 v44, v76, v189
    v_fmac_f32 v45, v76, v191
    v_fmac_f32 v46, v76, v193
    v_fmac_f32 v47, v76, v195
    v_cvt_pk_bf16_f32 v216, v44, v45
    v_cvt_pk_bf16_f32 v217, v46, v47
    v_mul_f32 v60, v60, v196
    v_mul_f32 v61, v61, v198
    v_mul_f32 v62, v62, v200
    v_mul_f32 v63, v63, v202
    v_fmac_f32 v60, v76, v197
    v_fmac_f32 v61, v76, v199
    v_fmac_f32 v62, v76, v201
    v_fmac_f32 v63, v76, v203
    v_cvt_pk_bf16_f32 v218, v60, v61
    v_cvt_pk_bf16_f32 v219, v62, v63
    buffer_store_dwordx4 v[216:219], v206, s[24:27], s50 offen offset:1280 sc1
    v_mul_f32 v16, v16, v172
    v_mul_f32 v17, v17, v174
    v_mul_f32 v18, v18, v176
    v_mul_f32 v19, v19, v178
    v_fmac_f32 v16, v80, v173
    v_fmac_f32 v17, v80, v175
    v_fmac_f32 v18, v80, v177
    v_fmac_f32 v19, v80, v179
    v_cvt_pk_bf16_f32 v212, v16, v17
    v_cvt_pk_bf16_f32 v213, v18, v19
    v_mul_f32 v32, v32, v180
    v_mul_f32 v33, v33, v182
    v_mul_f32 v34, v34, v184
    v_mul_f32 v35, v35, v186
    v_fmac_f32 v32, v80, v181
    v_fmac_f32 v33, v80, v183
    v_fmac_f32 v34, v80, v185
    v_fmac_f32 v35, v80, v187
    v_cvt_pk_bf16_f32 v214, v32, v33
    v_cvt_pk_bf16_f32 v215, v34, v35
    buffer_store_dwordx4 v[212:215], v207, s[24:27], s50 offen offset:0 sc1
    v_mul_f32 v48, v48, v188
    v_mul_f32 v49, v49, v190
    v_mul_f32 v50, v50, v192
    v_mul_f32 v51, v51, v194
    v_fmac_f32 v48, v80, v189
    v_fmac_f32 v49, v80, v191
    v_fmac_f32 v50, v80, v193
    v_fmac_f32 v51, v80, v195
    v_cvt_pk_bf16_f32 v216, v48, v49
    v_cvt_pk_bf16_f32 v217, v50, v51
    v_mul_f32 v64, v64, v196
    v_mul_f32 v65, v65, v198
    v_mul_f32 v66, v66, v200
    v_mul_f32 v67, v67, v202
    v_fmac_f32 v64, v80, v197
    v_fmac_f32 v65, v80, v199
    v_fmac_f32 v66, v80, v201
    v_fmac_f32 v67, v80, v203
    v_cvt_pk_bf16_f32 v218, v64, v65
    v_cvt_pk_bf16_f32 v219, v66, v67
    buffer_store_dwordx4 v[216:219], v207, s[24:27], s50 offen offset:1280 sc1
    s_waitcnt vmcnt(0)
    s_barrier
    s_branch L_s1_done
L_s1_l:
    s_cmp_eq_u32 s44, 15
    s_cbranch_scc1 L_s1_spare
    v_lshrrev_b32 v5, 3, v0
    v_mul_u32_u24 v5, 0x500, v5
    v_lshrrev_b32 v6, 4, v0
    v_and_b32 v7, 7, v0
    v_add_u32 v8, 0, v6
    v_xor_b32 v8, v7, v8
    v_lshl_add_u32 v1, v8, 4, v5
    v_add_u32 v8, 4, v6
    v_xor_b32 v8, v7, v8
    v_lshl_add_u32 v2, v8, 4, v5
    v_mul_u32_u24 v5, 0xf00, v6
    v_and_b32 v7, 15, v0
    v_or_b32 v8, 0, v6
    v_lshlrev_b32 v8, 1, v8
    v_xor_b32 v8, v7, v8
    v_lshl_add_u32 v3, v8, 4, v5
    v_or_b32 v8, 4, v6
    v_lshlrev_b32 v8, 1, v8
    v_xor_b32 v8, v7, v8
    v_lshl_add_u32 v4, v8, 4, v5
    s_lshl_b32 s48, s43, 7
    s_lshl_b32 s52, s46, 5
    s_add_u32 s48, s48, s52
    s_mul_i32 s48, s48, 1280
    s_mul_i32 s49, s46, 61440
    s_lshl_b32 s52, s44, 8
    s_add_u32 s49, s49, s52
    s_lshl_b32 s50, s46, 12
    s_add_u32 s51, s50, 16384
    s_mul_i32 s60, s41, 10
    s_lshr_b32 s60, s60, 3
    s_mul_i32 s61, s60, 245760
    s_lshl_b32 s60, s60, 7
    s_add_u32 s62, s48, s60
    s_add_u32 s63, s49, s61
    s_add_u32 m0, s50, 0
    s_add_u32 s52, s62, 0
    buffer_load_dwordx4 v1, s[4:7], s52 offen lds
    s_add_u32 m0, s50, 1024
    s_add_u32 s52, s62, 10240
    buffer_load_dwordx4 v2, s[4:7], s52 offen lds
    s_add_u32 m0, s50, 2048
    s_add_u32 s52, s62, 20480
    buffer_load_dwordx4 v1, s[4:7], s52 offen lds
    s_add_u32 m0, s50, 3072
    s_add_u32 s52, s62, 30720
    buffer_load_dwordx4 v2, s[4:7], s52 offen lds
    s_add_u32 m0, s51, 0
    s_add_u32 s52, s63, 0
    buffer_load_dwordx4 v3, s[8:11], s52 offen lds
    s_add_u32 m0, s51, 1024
    s_add_u32 s52, s63, 15360
    buffer_load_dwordx4 v3, s[8:11], s52 offen lds
    s_add_u32 m0, s51, 2048
    s_add_u32 s52, s63, 30720
    buffer_load_dwordx4 v4, s[8:11], s52 offen lds
    s_add_u32 m0, s51, 3072
    s_add_u32 s52, s63, 46080
    buffer_load_dwordx4 v4, s[8:11], s52 offen lds
    s_add_u32 s60, s60, 128
    s_add_u32 s61, s61, 245760
    s_cmp_eq_u32 s60, 1280
    s_cselect_b32 s60, 0, s60
    s_cselect_b32 s61, 0, s61
    s_add_u32 s62, s48, s60
    s_add_u32 s63, s49, s61
    s_add_u32 m0, s50, 32768
    s_add_u32 s52, s62, 0
    buffer_load_dwordx4 v1, s[4:7], s52 offen lds
    s_add_u32 m0, s50, 33792
    s_add_u32 s52, s62, 10240
    buffer_load_dwordx4 v2, s[4:7], s52 offen lds
    s_add_u32 m0, s50, 34816
    s_add_u32 s52, s62, 20480
    buffer_load_dwordx4 v1, s[4:7], s52 offen lds
    s_add_u32 m0, s50, 35840
    s_add_u32 s52, s62, 30720
    buffer_load_dwordx4 v2, s[4:7], s52 offen lds
    s_add_u32 m0, s51, 32768
    s_add_u32 s52, s63, 0
    buffer_load_dwordx4 v3, s[8:11], s52 offen lds
    s_add_u32 m0, s51, 33792
    s_add_u32 s52, s63, 15360
    buffer_load_dwordx4 v3, s[8:11], s52 offen lds
    s_add_u32 m0, s51, 34816
    s_add_u32 s52, s63, 30720
    buffer_load_dwordx4 v4, s[8:11], s52 offen lds
    s_add_u32 m0, s51, 35840
    s_add_u32 s52, s63, 46080
    buffer_load_dwordx4 v4, s[8:11], s52 offen lds
    s_add_u32 s60, s60, 128
    s_add_u32 s61, s61, 245760
    s_cmp_eq_u32 s60, 1280
    s_cselect_b32 s60, 0, s60
    s_cselect_b32 s61, 0, s61
    s_waitcnt vmcnt(8)
    s_barrier
    s_add_u32 s62, s48, s60
    s_add_u32 s63, s49, s61
    s_add_u32 m0, s50, 65536
    s_add_u32 s52, s62, 0
    buffer_load_dwordx4 v1, s[4:7], s52 offen lds
    s_add_u32 m0, s50, 66560
    s_add_u32 s52, s62, 10240
    buffer_load_dwordx4 v2, s[4:7], s52 offen lds
    s_add_u32 m0, s50, 67584
    s_add_u32 s52, s62, 20480
    buffer_load_dwordx4 v1, s[4:7], s52 offen lds
    s_add_u32 m0, s50, 68608
    s_add_u32 s52, s62, 30720
    buffer_load_dwordx4 v2, s[4:7], s52 offen lds
    s_add_u32 m0, s51, 65536
    s_add_u32 s52, s63, 0
    buffer_load_dwordx4 v3, s[8:11], s52 offen lds
    s_add_u32 m0, s51, 66560
    s_add_u32 s52, s63, 15360
    buffer_load_dwordx4 v3, s[8:11], s52 offen lds
    s_add_u32 m0, s51, 67584
    s_add_u32 s52, s63, 30720
    buffer_load_dwordx4 v4, s[8:11], s52 offen lds
    s_add_u32 m0, s51, 68608
    s_add_u32 s52, s63, 46080
    buffer_load_dwordx4 v4, s[8:11], s52 offen lds
    s_add_u32 s60, s60, 128
    s_add_u32 s61, s61, 245760
    s_cmp_eq_u32 s60, 1280
    s_cselect_b32 s60, 0, s60
    s_cselect_b32 s61, 0, s61
    s_add_u32 s62, s48, s60
    s_add_u32 s63, s49, s61
    s_add_u32 m0, s50, 98304
    s_add_u32 s52, s62, 0
    buffer_load_dwordx4 v1, s[4:7], s52 offen lds
    s_add_u32 m0, s50, 99328
    s_add_u32 s52, s62, 10240
    buffer_load_dwordx4 v2, s[4:7], s52 offen lds
    s_add_u32 m0, s50, 100352
    s_add_u32 s52, s62, 20480
    buffer_load_dwordx4 v1, s[4:7], s52 offen lds
    s_add_u32 m0, s50, 101376
    s_add_u32 s52, s62, 30720
    buffer_load_dwordx4 v2, s[4:7], s52 offen lds
    s_add_u32 m0, s51, 98304
    s_add_u32 s52, s63, 0
    buffer_load_dwordx4 v3, s[8:11], s52 offen lds
    s_add_u32 m0, s51, 99328
    s_add_u32 s52, s63, 15360
    buffer_load_dwordx4 v3, s[8:11], s52 offen lds
    s_add_u32 m0, s51, 100352
    s_add_u32 s52, s63, 30720
    buffer_load_dwordx4 v4, s[8:11], s52 offen lds
    s_add_u32 m0, s51, 101376
    s_add_u32 s52, s63, 46080
    buffer_load_dwordx4 v4, s[8:11], s52 offen lds
    s_add_u32 s60, s60, 128
    s_add_u32 s61, s61, 245760
    s_cmp_eq_u32 s60, 1280
    s_cselect_b32 s60, 0, s60
    s_cselect_b32 s61, 0, s61
    s_waitcnt vmcnt(16)
    s_barrier
    s_add_u32 s62, s48, s60
    s_add_u32 s63, s49, s61
    s_add_u32 m0, s50, 0
    s_add_u32 s52, s62, 0
    buffer_load_dwordx4 v1, s[4:7], s52 offen lds
    s_add_u32 m0, s50, 1024
    s_add_u32 s52, s62, 10240
    buffer_load_dwordx4 v2, s[4:7], s52 offen lds
    s_add_u32 m0, s50, 2048
    s_add_u32 s52, s62, 20480
    buffer_load_dwordx4 v1, s[4:7], s52 offen lds
    s_add_u32 m0, s50, 3072
    s_add_u32 s52, s62, 30720
    buffer_load_dwordx4 v2, s[4:7], s52 offen lds
    s_add_u32 m0, s51, 0
    s_add_u32 s52, s63, 0
    buffer_load_dwordx4 v3, s[8:11], s52 offen lds
    s_add_u32 m0, s51, 1024
    s_add_u32 s52, s63, 15360
    buffer_load_dwordx4 v3, s[8:11], s52 offen lds
    s_add_u32 m0, s51, 2048
    s_add_u32 s52, s63, 30720
    buffer_load_dwordx4 v4, s[8:11], s52 offen lds
    s_add_u32 m0, s51, 3072
    s_add_u32 s52, s63, 46080
    buffer_load_dwordx4 v4, s[8:11], s52 offen lds
    s_add_u32 s60, s60, 128
    s_add_u32 s61, s61, 245760
    s_cmp_eq_u32 s60, 1280
    s_cselect_b32 s60, 0, s60
    s_cselect_b32 s61, 0, s61
    s_waitcnt vmcnt(16)
    s_barrier
    s_add_u32 s62, s48, s60
    s_add_u32 s63, s49, s61
    s_add_u32 m0, s50, 32768
    s_add_u32 s52, s62, 0
    buffer_load_dwordx4 v1, s[4:7], s52 offen lds
    s_add_u32 m0, s50, 33792
    s_add_u32 s52, s62, 10240
    buffer_load_dwordx4 v2, s[4:7], s52 offen lds
    s_add_u32 m0, s50, 34816
    s_add_u32 s52, s62, 20480
    buffer_load_dwordx4 v1, s[4:7], s52 offen lds
    s_add_u32 m0, s50, 35840
    s_add_u32 s52, s62, 30720
    buffer_load_dwordx4 v2, s[4:7], s52 offen lds
    s_add_u32 m0, s51, 32768
    s_add_u32 s52, s63, 0
    buffer_load_dwordx4 v3, s[8:11], s52 offen lds
    s_add_u32 m0, s51, 33792
    s_add_u32 s52, s63, 15360
    buffer_load_dwordx4 v3, s[8:11], s52 offen lds
    s_add_u32 m0, s51, 34816
    s_add_u32 s52, s63, 30720
    buffer_load_dwordx4 v4, s[8:11], s52 offen lds
    s_add_u32 m0, s51, 35840
    s_add_u32 s52, s63, 46080
    buffer_load_dwordx4 v4, s[8:11], s52 offen lds
    s_add_u32 s60, s60, 128
    s_add_u32 s61, s61, 245760
    s_cmp_eq_u32 s60, 1280
    s_cselect_b32 s60, 0, s60
    s_cselect_b32 s61, 0, s61
    s_waitcnt vmcnt(16)
    s_barrier
    s_add_u32 s62, s48, s60
    s_add_u32 s63, s49, s61
    s_add_u32 m0, s50, 65536
    s_add_u32 s52, s62, 0
    buffer_load_dwordx4 v1, s[4:7], s52 offen lds
    s_add_u32 m0, s50, 66560
    s_add_u32 s52, s62, 10240
    buffer_load_dwordx4 v2, s[4:7], s52 offen lds
    s_add_u32 m0, s50, 67584
    s_add_u32 s52, s62, 20480
    buffer_load_dwordx4 v1, s[4:7], s52 offen lds
    s_add_u32 m0, s50, 68608
    s_add_u32 s52, s62, 30720
    buffer_load_dwordx4 v2, s[4:7], s52 offen lds
    s_add_u32 m0, s51, 65536
    s_add_u32 s52, s63, 0
    buffer_load_dwordx4 v3, s[8:11], s52 offen lds
    s_add_u32 m0, s51, 66560
    s_add_u32 s52, s63, 15360
    buffer_load_dwordx4 v3, s[8:11], s52 offen lds
    s_add_u32 m0, s51, 67584
    s_add_u32 s52, s63, 30720
    buffer_load_dwordx4 v4, s[8:11], s52 offen lds
    s_add_u32 m0, s51, 68608
    s_add_u32 s52, s63, 46080
    buffer_load_dwordx4 v4, s[8:11], s52 offen lds
    s_add_u32 s60, s60, 128
    s_add_u32 s61, s61, 245760
    s_cmp_eq_u32 s60, 1280
    s_cselect_b32 s60, 0, s60
    s_cselect_b32 s61, 0, s61
    s_waitcnt vmcnt(16)
    s_barrier
    s_add_u32 s62, s48, s60
    s_add_u32 s63, s49, s61
    s_add_u32 m0, s50, 98304
    s_add_u32 s52, s62, 0
    buffer_load_dwordx4 v1, s[4:7], s52 offen lds
    s_add_u32 m0, s50, 99328
    s_add_u32 s52, s62, 10240
    buffer_load_dwordx4 v2, s[4:7], s52 offen lds
    s_add_u32 m0, s50, 100352
    s_add_u32 s52, s62, 20480
    buffer_load_dwordx4 v1, s[4:7], s52 offen lds
    s_add_u32 m0, s50, 101376
    s_add_u32 s52, s62, 30720
    buffer_load_dwordx4 v2, s[4:7], s52 offen lds
    s_add_u32 m0, s51, 98304
    s_add_u32 s52, s63, 0
    buffer_load_dwordx4 v3, s[8:11], s52 offen lds
    s_add_u32 m0, s51, 99328
    s_add_u32 s52, s63, 15360
    buffer_load_dwordx4 v3, s[8:11], s52 offen lds
    s_add_u32 m0, s51, 100352
    s_add_u32 s52, s63, 30720
    buffer_load_dwordx4 v4, s[8:11], s52 offen lds
    s_add_u32 m0, s51, 101376
    s_add_u32 s52, s63, 46080
    buffer_load_dwordx4 v4, s[8:11], s52 offen lds
    s_add_u32 s60, s60, 128
    s_add_u32 s61, s61, 245760
    s_cmp_eq_u32 s60, 1280
    s_cselect_b32 s60, 0, s60
    s_cselect_b32 s61, 0, s61
    s_waitcnt vmcnt(16)
    s_barrier
    s_add_u32 s62, s48, s60
    s_add_u32 s63, s49, s61
    s_add_u32 m0, s50, 0
    s_add_u32 s52, s62, 0
    buffer_load_dwordx4 v1, s[4:7], s52 offen lds
    s_add_u32 m0, s50, 1024
    s_add_u32 s52, s62, 10240
    buffer_load_dwordx4 v2, s[4:7], s52 offen lds
    s_add_u32 m0, s50, 2048
    s_add_u32 s52, s62, 20480
    buffer_load_dwordx4 v1, s[4:7], s52 offen lds
    s_add_u32 m0, s50, 3072
    s_add_u32 s52, s62, 30720
    buffer_load_dwordx4 v2, s[4:7], s52 offen lds
    s_add_u32 m0, s51, 0
    s_add_u32 s52, s63, 0
    buffer_load_dwordx4 v3, s[8:11], s52 offen lds
    s_add_u32 m0, s51, 1024
    s_add_u32 s52, s63, 15360
    buffer_load_dwordx4 v3, s[8:11], s52 offen lds
    s_add_u32 m0, s51, 2048
    s_add_u32 s52, s63, 30720
    buffer_load_dwordx4 v4, s[8:11], s52 offen lds
    s_add_u32 m0, s51, 3072
    s_add_u32 s52, s63, 46080
    buffer_load_dwordx4 v4, s[8:11], s52 offen lds
    s_add_u32 s60, s60, 128
    s_add_u32 s61, s61, 245760
    s_cmp_eq_u32 s60, 1280
    s_cselect_b32 s60, 0, s60
    s_cselect_b32 s61, 0, s61
    s_waitcnt vmcnt(16)
    s_barrier
    s_add_u32 s62, s48, s60
    s_add_u32 s63, s49, s61
    s_add_u32 m0, s50, 32768
    s_add_u32 s52, s62, 0
    buffer_load_dwordx4 v1, s[4:7], s52 offen lds
    s_add_u32 m0, s50, 33792
    s_add_u32 s52, s62, 10240
    buffer_load_dwordx4 v2, s[4:7], s52 offen lds
    s_add_u32 m0, s50, 34816
    s_add_u32 s52, s62, 20480
    buffer_load_dwordx4 v1, s[4:7], s52 offen lds
    s_add_u32 m0, s50, 35840
    s_add_u32 s52, s62, 30720
    buffer_load_dwordx4 v2, s[4:7], s52 offen lds
    s_add_u32 m0, s51, 32768
    s_add_u32 s52, s63, 0
    buffer_load_dwordx4 v3, s[8:11], s52 offen lds
    s_add_u32 m0, s51, 33792
    s_add_u32 s52, s63, 15360
    buffer_load_dwordx4 v3, s[8:11], s52 offen lds
    s_add_u32 m0, s51, 34816
    s_add_u32 s52, s63, 30720
    buffer_load_dwordx4 v4, s[8:11], s52 offen lds
    s_add_u32 m0, s51, 35840
    s_add_u32 s52, s63, 46080
    buffer_load_dwordx4 v4, s[8:11], s52 offen lds
    s_add_u32 s60, s60, 128
    s_add_u32 s61, s61, 245760
    s_cmp_eq_u32 s60, 1280
    s_cselect_b32 s60, 0, s60
    s_cselect_b32 s61, 0, s61
    s_waitcnt vmcnt(16)
    s_barrier
    s_waitcnt lgkmcnt(0)
    s_mul_i32 s45, s72, 0x9E3779B1
    s_add_u32 s45, s45, 1
    s_cmp_lg_u32 s40, 7
    s_cbranch_scc1 L_nw_2
    s_lshl_b32 s54, s41, 5
    s_add_u32 s54, s54, s42
    s_lshl_b32 s54, s54, 2
    s_add_u32 s54, s54, 24576
    s_add_u32 s55, s45, s3
    v_mov_b32 v5, s55
    v_mov_b32 v6, 0
    s_mov_b64 exec, 1
    buffer_store_dword v5, v6, s[24:27], s54 offen sc1
    s_mov_b64 exec, -1
L_nw_2:
    s_cmp_lg_u32 s40, 4
    s_cbranch_scc1 L_nw_3
    s_and_b32 s52, s43, 1
    s_lshl_b32 s52, s52, 6
    s_lshl_b32 s62, s41, 7
    s_add_u32 s52, s52, s62
    s_lshl_b32 s52, s52, 2
    s_add_u32 s52, s52, 12288
    v_lshl_add_u32 v5, v0, 2, s52
    s_mov_b32 s56, 0
    s_nop 0
L_poll_4:
    buffer_load_dword v6, v5, s[24:27], 0 offen sc1
    s_waitcnt vmcnt(0)
    v_xor_b32 v6, s45, v6
    v_cmp_ne_u32 vcc, 0, v6
    s_nop 2
    s_cmp_eq_u64 vcc, 0
    s_nop 0
    s_cbranch_scc1 L_polldone_5
    s_add_u32 s56, s56, 1
    s_cmp_lt_u32 s56, 131072
    s_cbranch_scc0 L_polldone_5
    s_branch L_poll_4
L_polldone_5:
    v_lshlrev_b32 v5, 4, v0
    s_lshl_b32 s52, s43, 10
    s_add_u32 s52, s52, 22413312
    s_mov_b32 m0, 162816
    s_nop 0
    buffer_load_dwordx4 v5, s[24:27], s52 offen sc1 lds
L_nw_3:
    s_waitcnt vmcnt(8)
    s_barrier
    s_mov_b32 s53, s47
    s_mul_i32 s53, s53, 6912
    v_lshlrev_b32 v7, 7, v0
    s_mov_b32 exec_hi, 0x3fffff
    buffer_load_dword v250, v7, s[12:15], s53 offen
    s_mov_b64 exec, -1
    s_waitcnt vmcnt(0)
    s_barrier
    s_waitcnt vmcnt(0)
    s_barrier
    s_barrier
    s_branch L_s1_done
L_s1_spare_c:
    v_lshrrev_b32 v1, 5, v0
    v_mul_u32_u24 v1, 0x500, v1
    v_and_b32 v32, 31, v0
    v_lshl_add_u32 v1, v32, 3, v1
    s_lshl_b32 s48, s41, 8
    s_lshl_b32 s49, s47, 1
    s_add_u32 s48, s48, s49
    s_mul_i32 s49, s48, 1280
    buffer_load_dwordx2 v[2:3], v1, s[4:7], s49 offen offset:0
    buffer_load_dwordx2 v[4:5], v1, s[4:7], s49 offen offset:256
    buffer_load_dwordx2 v[6:7], v1, s[4:7], s49 offen offset:512
    buffer_load_dwordx2 v[8:9], v1, s[4:7], s49 offen offset:768
    buffer_load_dwordx2 v[10:11], v1, s[4:7], s49 offen offset:1024
    s_waitcnt vmcnt(0)
    v_lshlrev_b32 v12, 16, v2
    v_and_b32 v13, 0xffff0000, v2
    v_lshlrev_b32 v14, 16, v3
    v_and_b32 v15, 0xffff0000, v3
    v_lshlrev_b32 v16, 16, v4
    v_and_b32 v17, 0xffff0000, v4
    v_lshlrev_b32 v18, 16, v5
    v_and_b32 v19, 0xffff0000, v5
    v_lshlrev_b32 v20, 16, v6
    v_and_b32 v21, 0xffff0000, v6
    v_lshlrev_b32 v22, 16, v7
    v_and_b32 v23, 0xffff0000, v7
    v_lshlrev_b32 v24, 16, v8
    v_and_b32 v25, 0xffff0000, v8
    v_lshlrev_b32 v26, 16, v9
    v_and_b32 v27, 0xffff0000, v9
    v_lshlrev_b32 v28, 16, v10
    v_and_b32 v29, 0xffff0000, v10
    v_lshlrev_b32 v30, 16, v11
    v_and_b32 v31, 0xffff0000, v11
    v_add_f32 v33, v12, v13
    v_add_f32 v33, v33, v14
    v_add_f32 v33, v33, v15
    v_add_f32 v33, v33, v16
    v_add_f32 v33, v33, v17
    v_add_f32 v33, v33, v18
    v_add_f32 v33, v33, v19
    v_add_f32 v33, v33, v20
    v_add_f32 v33, v33, v21
    v_add_f32 v33, v33, v22
    v_add_f32 v33, v33, v23
    v_add_f32 v33, v33, v24
    v_add_f32 v33, v33, v25
    v_add_f32 v33, v33, v26
    v_add_f32 v33, v33, v27
    v_add_f32 v33, v33, v28
    v_add_f32 v33, v33, v29
    v_add_f32 v33, v33, v30
    v_add_f32 v33, v33, v31
    s_nop 1
    v_add_f32_dpp v33, v33, v33 row_ror:8 row_mask:0xf bank_mask:0xf
    s_nop 1
    v_add_f32_dpp v33, v33, v33 row_ror:4 row_mask:0xf bank_mask:0xf
    s_nop 1
    v_add_f32_dpp v33, v33, v33 row_ror:2 row_mask:0xf bank_mask:0xf
    s_nop 1
    v_add_f32_dpp v33, v33, v33 row_ror:1 row_mask:0xf bank_mask:0xf
    v_mov_b32 v1, v33
    s_nop 1
    v_permlane16_swap_b32 v1, v33
    v_add_f32 v33, v33, v1
    v_mul_f32 v33, 0x3acccccd, v33
    v_sub_f32 v12, v12, v33
    v_mul_f32 v34, v12, v12
    v_sub_f32 v13, v13, v33
    v_fmac_f32 v34, v13, v13
    v_sub_f32 v14, v14, v33
    v_fmac_f32 v34, v14, v14
    v_sub_f32 v15, v15, v33
    v_fmac_f32 v34, v15, v15
    v_sub_f32 v16, v16, v33
    v_fmac_f32 v34, v16, v16
    v_sub_f32 v17, v17, v33
    v_fmac_f32 v34, v17, v17
    v_sub_f32 v18, v18, v33
    v_fmac_f32 v34, v18, v18
    v_sub_f32 v19, v19, v33
    v_fmac_f32 v34, v19, v19
    v_sub_f32 v20, v20, v33
    v_fmac_f32 v34, v20, v20
    v_sub_f32 v21, v21, v33
    v_fmac_f32 v34, v21, v21
    v_sub_f32 v22, v22, v33
    v_fmac_f32 v34, v22, v22
    v_sub_f32 v23, v23, v33
    v_fmac_f32 v34, v23, v23
    v_sub_f32 v24, v24, v33
    v_fmac_f32 v34, v24, v24
    v_sub_f32 v25, v25, v33
    v_fmac_f32 v34, v25, v25
    v_sub_f32 v26, v26, v33
    v_fmac_f32 v34, v26, v26
    v_sub_f32 v27, v27, v33
    v_fmac_f32 v34, v27, v27
    v_sub_f32 v28, v28, v33
    v_fmac_f32 v34, v28, v28
    v_sub_f32 v29, v29, v33
    v_fmac_f32 v34, v29, v29
    v_sub_f32 v30, v30, v33
    v_fmac_f32 v34, v30, v30
    v_sub_f32 v31, v31, v33
    v_fmac_f32 v34, v31, v31
    s_nop 1
    v_add_f32_dpp v34, v34, v34 row_ror:8 row_mask:0xf bank_mask:0xf
    s_nop 1
    v_add_f32_dpp v34, v34, v34 row_ror:4 row_mask:0xf bank_mask:0xf
    s_nop 1
    v_add_f32_dpp v34, v34, v34 row_ror:2 row_mask:0xf bank_mask:0xf
    s_nop 1
    v_add_f32_dpp v34, v34, v34 row_ror:1 row_mask:0xf bank_mask:0xf
    v_mov_b32 v1, v34
    s_nop 1
    v_permlane16_swap_b32 v1, v34
    v_add_f32 v34, v34, v1
    v_mov_b32 v32, 0x3727c5ac
    v_fmac_f32 v32, 0x3acccccd, v34
    v_rsq_f32 v36, v32
    s_nop 0
    v_mul_f32 v37, v33, v36
    v_sub_f32 v37, 0, v37
    v_lshrrev_b32 v1, 5, v0
    v_lshlrev_b32 v1, 3, v1
    v_and_b32 v32, 31, v0
    v_mov_b32 v33, 0x7f000000
    v_cmp_eq_u32 vcc, 0, v32
    s_nop 1
    v_cndmask_b32 v1, v33, v1, vcc
    s_lshl_b32 s48, s48, 3
    s_add_u32 s48, s48, 22413312
    buffer_store_dwordx2 v[36:37], v1, s[24:27], s48 offen sc1
L_s1_spare:
    s_lshl_b32 s60, s43, 3
    s_add_u32 s60, s60, s40
    v_lshrrev_b32 v41, 3, v0
    v_mul_u32_u24 v41, 3072, v41
    v_and_b32 v40, 7, v0
    v_lshl_add_u32 v40, v40, 4, v41
    v_lshlrev_b32 v43, 4, v0
    s_lshl_b32 s48, s40, 14
    v_lshrrev_b32 v41, 4, v0
    v_lshlrev_b32 v41, 2, v41
    v_bfe_u32 v42, v0, 2, 2
    v_add_u32 v41, v41, v42
    v_lshlrev_b32 v41, 7, v41
    v_and_b32 v42, 3, v0
    v_lshl_add_u32 v41, v42, 3, v41
    v_add_u32 v44, s48, v41
    s_cmp_lg_u32 s40, 6
    s_nop 0
    s_cbranch_scc1 L_nw_6
    v_lshlrev_b32 v41, 18, v0
    s_mov_b32 s49, 0
    buffer_load_dword v30, v41, s[24:27], s49 offen sc1
    s_mov_b32 s49, 16777216
    buffer_load_dword v31, v41, s[24:27], s49 offen sc1
    v_lshlrev_b32 v41, 16, v0
    buffer_load_dword v29, v41, s[28:31], 0 offen sc1
    buffer_load_dword v28, v41, s[20:23], 0 offen
    buffer_load_dword v27, v41, s[12:15], 0 offen
    s_waitcnt vmcnt(0)
L_nw_6:
    s_add_u32 s61, s60, 0
    s_mul_i32 s62, s61, 2731
    s_lshr_b32 s62, s62, 16
    s_mul_i32 s49, s62, 24
    s_sub_u32 s63, s61, s49
    s_mul_i32 s49, s62, 98304
    s_lshl_b32 s50, s63, 7
    s_add_u32 s49, s49, s50
    s_add_u32 m0, s48, 0
    s_add_u32 s50, s49, 0
    buffer_load_dwordx4 v40, s[16:19], s50 offen lds
    s_add_u32 m0, s48, 1024
    s_add_u32 s50, s49, 24576
    buffer_load_dwordx4 v40, s[16:19], s50 offen lds
    s_add_u32 m0, s48, 2048
    s_add_u32 s50, s49, 49152
    buffer_load_dwordx4 v40, s[16:19], s50 offen lds
    s_add_u32 m0, s48, 3072
    s_add_u32 s50, s49, 73728
    buffer_load_dwordx4 v40, s[16:19], s50 offen lds
    s_add_u32 s61, s60, 128
    s_mul_i32 s62, s61, 2731
    s_lshr_b32 s62, s62, 16
    s_mul_i32 s49, s62, 24
    s_sub_u32 s63, s61, s49
    s_mul_i32 s49, s62, 98304
    s_lshl_b32 s50, s63, 7
    s_add_u32 s49, s49, s50
    s_add_u32 m0, s48, 4096
    s_add_u32 s50, s49, 0
    buffer_load_dwordx4 v40, s[16:19], s50 offen lds
    s_add_u32 m0, s48, 5120
    s_add_u32 s50, s49, 24576
    buffer_load_dwordx4 v40, s[16:19], s50 offen lds
    s_add_u32 m0, s48, 6144
    s_add_u32 s50, s49, 49152
    buffer_load_dwordx4 v40, s[16:19], s50 offen lds
    s_add_u32 m0, s48, 7168
    s_add_u32 s50, s49, 73728
    buffer_load_dwordx4 v40, s[16:19], s50 offen lds
    s_add_u32 s61, s60, 256
    s_mul_i32 s62, s61, 2731
    s_lshr_b32 s62, s62, 16
    s_mul_i32 s49, s62, 24
    s_sub_u32 s63, s61, s49
    s_mul_i32 s49, s62, 98304
    s_lshl_b32 s50, s63, 7
    s_add_u32 s49, s49, s50
    s_add_u32 m0, s48, 8192
    s_add_u32 s50, s49, 0
    buffer_load_dwordx4 v40, s[16:19], s50 offen lds
    s_add_u32 m0, s48, 9216
    s_add_u32 s50, s49, 24576
    buffer_load_dwordx4 v40, s[16:19], s50 offen lds
    s_add_u32 m0, s48, 10240
    s_add_u32 s50, s49, 49152
    buffer_load_dwordx4 v40, s[16:19], s50 offen lds
    s_add_u32 m0, s48, 11264
    s_add_u32 s50, s49, 73728
    buffer_load_dwordx4 v40, s[16:19], s50 offen lds
    s_add_u32 s61, s60, 384
    s_mul_i32 s62, s61, 2731
    s_lshr_b32 s62, s62, 16
    s_mul_i32 s49, s62, 24
    s_sub_u32 s63, s61, s49
    s_mul_i32 s49, s62, 98304
    s_lshl_b32 s50, s63, 7
    s_add_u32 s49, s49, s50
    s_add_u32 m0, s48, 12288
    s_add_u32 s50, s49, 0
    buffer_load_dwordx4 v40, s[16:19], s50 offen lds
    s_add_u32 m0, s48, 13312
    s_add_u32 s50, s49, 24576
    buffer_load_dwordx4 v40, s[16:19], s50 offen lds
    s_add_u32 m0, s48, 14336
    s_add_u32 s50, s49, 49152
    buffer_load_dwordx4 v40, s[16:19], s50 offen lds
    s_add_u32 m0, s48, 15360
    s_add_u32 s50, s49, 73728
    buffer_load_dwordx4 v40, s[16:19], s50 offen lds
    s_waitcnt lgkmcnt(0)
    s_mul_i32 s45, s72, 0x9E3779B1
    s_add_u32 s45, s45, 1
    s_cmp_lg_u32 s40, 7
    s_cbranch_scc1 L_nw_7
    s_lshl_b32 s54, s43, 4
    s_add_u32 s54, s54, s44
    s_lshl_b32 s54, s54, 2
    s_add_u32 s54, s54, 0
    s_add_u32 s55, s45, s3
    v_mov_b32 v1, s55
    v_mov_b32 v2, 0
    s_mov_b64 exec, 1
    buffer_store_dword v1, v2, s[24:27], s54 offen sc1
    s_mov_b64 exec, -1
    s_lshl_b32 s54, s41, 5
    s_add_u32 s54, s54, s42
    s_lshl_b32 s54, s54, 2
    s_add_u32 s54, s54, 24576
    s_add_u32 s55, s45, s3
    v_mov_b32 v5, s55
    v_mov_b32 v6, 0
    s_mov_b64 exec, 1
    buffer_store_dword v5, v6, s[24:27], s54 offen sc1
    s_mov_b64 exec, -1
L_nw_7:
    s_waitcnt vmcnt(12)
    s_add_u32 s61, s60, 0
    s_mul_i32 s62, s61, 2731
    s_lshr_b32 s62, s62, 16
    s_mul_i32 s49, s62, 24
    s_sub_u32 s63, s61, s49
    ds_read_b64_tr_b16 v[48:49], v44 offset:0
    ds_read_b64_tr_b16 v[50:51], v44 offset:2048
    ds_read_b64_tr_b16 v[52:53], v44 offset:32
    ds_read_b64_tr_b16 v[54:55], v44 offset:2080
    ds_read_b64_tr_b16 v[56:57], v44 offset:64
    ds_read_b64_tr_b16 v[58:59], v44 offset:2112
    ds_read_b64_tr_b16 v[60:61], v44 offset:96
    ds_read_b64_tr_b16 v[62:63], v44 offset:2144
    s_mov_b32 s53, 22478848
    s_cmp_ge_u32 s61, 480
    s_cselect_b32 s53, 0x7f000000, s53
    s_waitcnt lgkmcnt(0)
    s_lshl_b32 s54, s63, 2
    s_add_u32 s54, s54, 0
    s_mul_i32 s51, s54, 342
    s_lshr_b32 s51, s51, 10
    s_mul_i32 s52, s51, 3
    s_sub_u32 s52, s54, s52
    s_mul_i32 s51, s51, 20
    s_add_u32 s51, s51, s62
    s_mul_i32 s51, s51, 3
    s_add_u32 s51, s51, s52
    s_lshl_b32 s51, s51, 10
    s_add_u32 s51, s51, s53
    buffer_store_dwordx4 v[48:51], v43, s[24:27], s51 offen sc1
    s_lshl_b32 s54, s63, 2
    s_add_u32 s54, s54, 1
    s_mul_i32 s51, s54, 342
    s_lshr_b32 s51, s51, 10
    s_mul_i32 s52, s51, 3
    s_sub_u32 s52, s54, s52
    s_mul_i32 s51, s51, 20
    s_add_u32 s51, s51, s62
    s_mul_i32 s51, s51, 3
    s_add_u32 s51, s51, s52
    s_lshl_b32 s51, s51, 10
    s_add_u32 s51, s51, s53
    buffer_store_dwordx4 v[52:55], v43, s[24:27], s51 offen sc1
    s_lshl_b32 s54, s63, 2
    s_add_u32 s54, s54, 2
    s_mul_i32 s51, s54, 342
    s_lshr_b32 s51, s51, 10
    s_mul_i32 s52, s51, 3
    s_sub_u32 s52, s54, s52
    s_mul_i32 s51, s51, 20
    s_add_u32 s51, s51, s62
    s_mul_i32 s51, s51, 3
    s_add_u32 s51, s51, s52
    s_lshl_b32 s51, s51, 10
    s_add_u32 s51, s51, s53
    buffer_store_dwordx4 v[56:59], v43, s[24:27], s51 offen sc1
    s_lshl_b32 s54, s63, 2
    s_add_u32 s54, s54, 3
    s_mul_i32 s51, s54, 342
    s_lshr_b32 s51, s51, 10
    s_mul_i32 s52, s51, 3
    s_sub_u32 s52, s54, s52
    s_mul_i32 s51, s51, 20
    s_add_u32 s51, s51, s62
    s_mul_i32 s51, s51, 3
    s_add_u32 s51, s51, s52
    s_lshl_b32 s51, s51, 10
    s_add_u32 s51, s51, s53
    buffer_store_dwordx4 v[60:63], v43, s[24:27], s51 offen sc1
    s_cmp_ge_u32 s40, 4
    s_nop 0
    s_cbranch_scc1 L_spfls_8
    s_lshl_b32 s54, s41, 7
    s_add_u32 s54, s54, s47
    s_lshl_b32 s54, s54, 2
    s_add_u32 s54, s54, 12288
    v_mov_b32 v1, s45
    v_mov_b32 v2, 0
    s_mov_b64 exec, 1
    buffer_store_dword v1, v2, s[24:27], s54 offen sc1
    s_mov_b64 exec, -1
L_spfls_8:
    s_waitcnt vmcnt(12)
    s_add_u32 s61, s60, 128
    s_mul_i32 s62, s61, 2731
    s_lshr_b32 s62, s62, 16
    s_mul_i32 s49, s62, 24
    s_sub_u32 s63, s61, s49
    ds_read_b64_tr_b16 v[64:65], v44 offset:4096
    ds_read_b64_tr_b16 v[66:67], v44 offset:6144
    ds_read_b64_tr_b16 v[68:69], v44 offset:4128
    ds_read_b64_tr_b16 v[70:71], v44 offset:6176
    ds_read_b64_tr_b16 v[72:73], v44 offset:4160
    ds_read_b64_tr_b16 v[74:75], v44 offset:6208
    ds_read_b64_tr_b16 v[76:77], v44 offset:4192
    ds_read_b64_tr_b16 v[78:79], v44 offset:6240
    s_mov_b32 s53, 22478848
    s_cmp_ge_u32 s61, 480
    s_cselect_b32 s53, 0x7f000000, s53
    s_waitcnt lgkmcnt(0)
    s_lshl_b32 s54, s63, 2
    s_add_u32 s54, s54, 0
    s_mul_i32 s51, s54, 342
    s_lshr_b32 s51, s51, 10
    s_mul_i32 s52, s51, 3
    s_sub_u32 s52, s54, s52
    s_mul_i32 s51, s51, 20
    s_add_u32 s51, s51, s62
    s_mul_i32 s51, s51, 3
    s_add_u32 s51, s51, s52
    s_lshl_b32 s51, s51, 10
    s_add_u32 s51, s51, s53
    buffer_store_dwordx4 v[64:67], v43, s[24:27], s51 offen sc1
    s_lshl_b32 s54, s63, 2
    s_add_u32 s54, s54, 1
    s_mul_i32 s51, s54, 342
    s_lshr_b32 s51, s51, 10
    s_mul_i32 s52, s51, 3
    s_sub_u32 s52, s54, s52
    s_mul_i32 s51, s51, 20
    s_add_u32 s51, s51, s62
    s_mul_i32 s51, s51, 3
    s_add_u32 s51, s51, s52
    s_lshl_b32 s51, s51, 10
    s_add_u32 s51, s51, s53
    buffer_store_dwordx4 v[68:71], v43, s[24:27], s51 offen sc1
    s_lshl_b32 s54, s63, 2
    s_add_u32 s54, s54, 2
    s_mul_i32 s51, s54, 342
    s_lshr_b32 s51, s51, 10
    s_mul_i32 s52, s51, 3
    s_sub_u32 s52, s54, s52
    s_mul_i32 s51, s51, 20
    s_add_u32 s51, s51, s62
    s_mul_i32 s51, s51, 3
    s_add_u32 s51, s51, s52
    s_lshl_b32 s51, s51, 10
    s_add_u32 s51, s51, s53
    buffer_store_dwordx4 v[72:75], v43, s[24:27], s51 offen sc1
    s_lshl_b32 s54, s63, 2
    s_add_u32 s54, s54, 3
    s_mul_i32 s51, s54, 342
    s_lshr_b32 s51, s51, 10
    s_mul_i32 s52, s51, 3
    s_sub_u32 s52, s54, s52
    s_mul_i32 s51, s51, 20
    s_add_u32 s51, s51, s62
    s_mul_i32 s51, s51, 3
    s_add_u32 s51, s51, s52
    s_lshl_b32 s51, s51, 10
    s_add_u32 s51, s51, s53
    buffer_store_dwordx4 v[76:79], v43, s[24:27], s51 offen sc1
    s_waitcnt vmcnt(12)
    s_add_u32 s61, s60, 256
    s_mul_i32 s62, s61, 2731
    s_lshr_b32 s62, s62, 16
    s_mul_i32 s49, s62, 24
    s_sub_u32 s63, s61, s49
    ds_read_b64_tr_b16 v[48:49], v44 offset:8192
    ds_read_b64_tr_b16 v[50:51], v44 offset:10240
    ds_read_b64_tr_b16 v[52:53], v44 offset:8224
    ds_read_b64_tr_b16 v[54:55], v44 offset:10272
    ds_read_b64_tr_b16 v[56:57], v44 offset:8256
    ds_read_b64_tr_b16 v[58:59], v44 offset:10304
    ds_read_b64_tr_b16 v[60:61], v44 offset:8288
    ds_read_b64_tr_b16 v[62:63], v44 offset:10336
    s_mov_b32 s53, 22478848
    s_cmp_ge_u32 s61, 480
    s_cselect_b32 s53, 0x7f000000, s53
    s_waitcnt lgkmcnt(0)
    s_lshl_b32 s54, s63, 2
    s_add_u32 s54, s54, 0
    s_mul_i32 s51, s54, 342
    s_lshr_b32 s51, s51, 10
    s_mul_i32 s52, s51, 3
    s_sub_u32 s52, s54, s52
    s_mul_i32 s51, s51, 20
    s_add_u32 s51, s51, s62
    s_mul_i32 s51, s51, 3
    s_add_u32 s51, s51, s52
    s_lshl_b32 s51, s51, 10
    s_add_u32 s51, s51, s53
    buffer_store_dwordx4 v[48:51], v43, s[24:27], s51 offen sc1
    s_lshl_b32 s54, s63, 2
    s_add_u32 s54, s54, 1
    s_mul_i32 s51, s54, 342
    s_lshr_b32 s51, s51, 10
    s_mul_i32 s52, s51, 3
    s_sub_u32 s52, s54, s52
    s_mul_i32 s51, s51, 20
    s_add_u32 s51, s51, s62
    s_mul_i32 s51, s51, 3
    s_add_u32 s51, s51, s52
    s_lshl_b32 s51, s51, 10
    s_add_u32 s51, s51, s53
    buffer_store_dwordx4 v[52:55], v43, s[24:27], s51 offen sc1
    s_lshl_b32 s54, s63, 2
    s_add_u32 s54, s54, 2
    s_mul_i32 s51, s54, 342
    s_lshr_b32 s51, s51, 10
    s_mul_i32 s52, s51, 3
    s_sub_u32 s52, s54, s52
    s_mul_i32 s51, s51, 20
    s_add_u32 s51, s51, s62
    s_mul_i32 s51, s51, 3
    s_add_u32 s51, s51, s52
    s_lshl_b32 s51, s51, 10
    s_add_u32 s51, s51, s53
    buffer_store_dwordx4 v[56:59], v43, s[24:27], s51 offen sc1
    s_lshl_b32 s54, s63, 2
    s_add_u32 s54, s54, 3
    s_mul_i32 s51, s54, 342
    s_lshr_b32 s51, s51, 10
    s_mul_i32 s52, s51, 3
    s_sub_u32 s52, s54, s52
    s_mul_i32 s51, s51, 20
    s_add_u32 s51, s51, s62
    s_mul_i32 s51, s51, 3
    s_add_u32 s51, s51, s52
    s_lshl_b32 s51, s51, 10
    s_add_u32 s51, s51, s53
    buffer_store_dwordx4 v[60:63], v43, s[24:27], s51 offen sc1
    s_waitcnt vmcnt(12)
    s_add_u32 s61, s60, 384
    s_mul_i32 s62, s61, 2731
    s_lshr_b32 s62, s62, 16
    s_mul_i32 s49, s62, 24
    s_sub_u32 s63, s61, s49
    ds_read_b64_tr_b16 v[64:65], v44 offset:12288
    ds_read_b64_tr_b16 v[66:67], v44 offset:14336
    ds_read_b64_tr_b16 v[68:69], v44 offset:12320
    ds_read_b64_tr_b16 v[70:71], v44 offset:14368
    ds_read_b64_tr_b16 v[72:73], v44 offset:12352
    ds_read_b64_tr_b16 v[74:75], v44 offset:14400
    ds_read_b64_tr_b16 v[76:77], v44 offset:12384
    ds_read_b64_tr_b16 v[78:79], v44 offset:14432
    s_mov_b32 s53, 22478848
    s_cmp_ge_u32 s61, 480
    s_cselect_b32 s53, 0x7f000000, s53
    s_waitcnt lgkmcnt(0)
    s_lshl_b32 s54, s63, 2
    s_add_u32 s54, s54, 0
    s_mul_i32 s51, s54, 342
    s_lshr_b32 s51, s51, 10
    s_mul_i32 s52, s51, 3
    s_sub_u32 s52, s54, s52
    s_mul_i32 s51, s51, 20
    s_add_u32 s51, s51, s62
    s_mul_i32 s51, s51, 3
    s_add_u32 s51, s51, s52
    s_lshl_b32 s51, s51, 10
    s_add_u32 s51, s51, s53
    buffer_store_dwordx4 v[64:67], v43, s[24:27], s51 offen sc1
    s_lshl_b32 s54, s63, 2
    s_add_u32 s54, s54, 1
    s_mul_i32 s51, s54, 342
    s_lshr_b32 s51, s51, 10
    s_mul_i32 s52, s51, 3
    s_sub_u32 s52, s54, s52
    s_mul_i32 s51, s51, 20
    s_add_u32 s51, s51, s62
    s_mul_i32 s51, s51, 3
    s_add_u32 s51, s51, s52
    s_lshl_b32 s51, s51, 10
    s_add_u32 s51, s51, s53
    buffer_store_dwordx4 v[68:71], v43, s[24:27], s51 offen sc1
    s_lshl_b32 s54, s63, 2
    s_add_u32 s54, s54, 2
    s_mul_i32 s51, s54, 342
    s_lshr_b32 s51, s51, 10
    s_mul_i32 s52, s51, 3
    s_sub_u32 s52, s54, s52
    s_mul_i32 s51, s51, 20
    s_add_u32 s51, s51, s62
    s_mul_i32 s51, s51, 3
    s_add_u32 s51, s51, s52
    s_lshl_b32 s51, s51, 10
    s_add_u32 s51, s51, s53
    buffer_store_dwordx4 v[72:75], v43, s[24:27], s51 offen sc1
    s_lshl_b32 s54, s63, 2
    s_add_u32 s54, s54, 3
    s_mul_i32 s51, s54, 342
    s_lshr_b32 s51, s51, 10
    s_mul_i32 s52, s51, 3
    s_sub_u32 s52, s54, s52
    s_mul_i32 s51, s51, 20
    s_add_u32 s51, s51, s62
    s_mul_i32 s51, s51, 3
    s_add_u32 s51, s51, s52
    s_lshl_b32 s51, s51, 10
    s_add_u32 s51, s51, s53
    buffer_store_dwordx4 v[76:79], v43, s[24:27], s51 offen sc1
    s_waitcnt vmcnt(0)
    s_barrier
    s_cmp_lg_u32 s40, 0
    s_cbranch_scc1 L_nw_9
    s_lshl_b32 s54, s43, 2
    s_add_u32 s54, s54, 16384
    v_mov_b32 v1, s45
    v_mov_b32 v2, 0
    s_mov_b64 exec, 1
    buffer_store_dword v1, v2, s[24:27], s54 offen sc1
    s_mov_b64 exec, -1
L_nw_9:
    s_branch L_s1_end
L_s1_done:
    s_cmp_lg_u32 s40, 0
    s_cbranch_scc1 L_nw_10
    s_lshl_b32 s54, s43, 4
    s_add_u32 s54, s54, s44
    s_lshl_b32 s54, s54, 2
    s_add_u32 s54, s54, 0
    s_add_u32 s55, s45, s3
    v_mov_b32 v1, s55
    v_mov_b32 v2, 0
    s_mov_b64 exec, 1
    buffer_store_dword v1, v2, s[24:27], s54 offen sc1
    s_mov_b64 exec, -1
L_nw_10:
L_s1_end:
    s_lshr_b32 s48, s42, 4
    s_lshl_b32 s43, s41, 1
    s_add_u32 s43, s43, s48
    s_and_b32 s44, s42, 15
    s_lshr_b32 s48, s42, 3
    s_lshl_b32 s48, s48, 6
    s_lshl_b32 s58, s41, 8
    s_add_u32 s58, s58, s48
    s_and_b32 s59, s42, 7
    s_cmp_ge_u32 s40, 4
    s_cbranch_scc1 L_rest_loader
    s_cmp_lg_u32 s40, 0
    s_cbranch_scc1 L_nw_11
    v_min_u32 v1, 13, v0
    v_and_b32 v2, 1, v1
    v_lshrrev_b32 v1, 1, v1
    s_mul_i32 s48, s44, 40
    s_lshr_b32 s49, s48, 7
    s_add_u32 s48, s48, 39
    s_lshr_b32 s48, s48, 7
    s_sub_u32 s48, s48, s49
    v_mul_u32_u24 v2, s48, v2
    v_add_u32 v2, s49, v2
    v_add_u32 v3, 2, v1
    v_mul_u32_u24 v3, 86, v3
    v_lshrrev_b32 v3, 8, v3
    v_mul_u32_u24 v4, 5, v3
    v_add_u32 v2, v2, v4
    v_mul_u32_u24 v4, 3, v3
    v_sub_u32 v4, v1, v4
    v_add_u32 v4, 2, v4
    v_cmp_eq_u32 vcc, 0, v3
    s_nop 1
    v_cndmask_b32 v4, v4, 0, vcc
    v_sub_u32 v4, s43, v4
    v_max_i32 v4, 0, v4
    v_lshl_add_u32 v2, v4, 4, v2
    v_lshlrev_b32 v2, 2, v2
    v_add_u32 v2, 0, v2
    s_lshl_b32 s48, s41, 7
    s_add_u32 s48, s48, 24448
    v_lshl_add_u32 v4, v0, 2, s48
    v_cmp_le_u32 vcc, 32, v0
    s_nop 1
    v_cndmask_b32 v2, v2, v4, vcc
    s_mov_b32 s56, 0
    s_nop 0
L_poll_12:
    buffer_load_dword v3, v2, s[24:27], 0 offen sc1
    s_waitcnt vmcnt(0)
    v_subrev_u32 v3, s45, v3
    v_cmp_le_u32 vcc, 8, v3
    s_nop 2
    s_cmp_eq_u64 vcc, 0
    s_nop 0
    s_cbranch_scc1 L_polldone_13
    s_add_u32 s56, s56, 1
    s_cmp_lt_u32 s56, 131072
    s_cbranch_scc0 L_polldone_13
    s_branch L_poll_12
L_polldone_13:
    v_cmp_ne_u32 vcc, s3, v3
    s_nop 2
    s_cmp_eq_u32 vcc_hi, 0
    s_cselect_b32 s48, 1, 0
    v_mov_b32 v4, s48
    v_mov_b32 v5, 0
    ds_write_b32 v5, v4 offset:0
    s_waitcnt lgkmcnt(0)
L_nw_11:
    s_barrier
    v_mov_b32 v5, 0
    ds_read_b32 v4, v5 offset:0
    s_waitcnt lgkmcnt(0)
    v_readfirstlane_b32 s100, v4
    s_barrier
    v_lshrrev_b32 v2, 4, v0
    v_and_b32 v3, 15, v0
    v_lshlrev_b32 v4, 8, v2
    v_lshl_add_u32 v4, v3, 3, v4
    v_mov_b32 v5, 0x7f000000
    v_cmp_gt_u32 vcc, 3, v2
    s_nop 1
    v_cndmask_b32 v6, v5, v4, vcc
    v_add_u32 v4, 128, v4
    v_cmp_gt_u32 vcc, 2, v2
    s_nop 1
    v_cndmask_b32 v7, v5, v4, vcc
    s_lshl_b32 s50, s44, 1
    s_mul_i32 s50, s50, 81920
    s_lshl_b32 s51, s43, 3
    s_lshl_b32 s52, s40, 1
    s_add_u32 s51, s51, s52
    s_mul_i32 s73, s51, 20480
    s_mul_i32 s51, s51, 640
    s_add_u32 s50, s50, s51
    s_add_u32 s50, s50, 65536
    buffer_load_dwordx2 v[8:9], v6, s[24:27], s50 offen offset:0 sc1
    buffer_load_dwordx2 v[10:11], v7, s[24:27], s50 offen offset:0 sc1
    buffer_load_dwordx2 v[12:13], v6, s[24:27], s50 offen offset:640 sc1
    buffer_load_dwordx2 v[14:15], v7, s[24:27], s50 offen offset:640 sc1
    s_add_u32 s50, s50, 81920
    buffer_load_dwordx2 v[16:17], v6, s[24:27], s50 offen offset:0 sc1
    buffer_load_dwordx2 v[18:19], v7, s[24:27], s50 offen offset:0 sc1
    buffer_load_dwordx2 v[20:21], v6, s[24:27], s50 offen offset:640 sc1
    buffer_load_dwordx2 v[22:23], v7, s[24:27], s50 offen offset:640 sc1
    v_lshl_add_u32 v4, v2, 2, 0
    v_cmp_le_u32 s[60:61], v4, v3
    v_lshl_add_u32 v4, v2, 2, 1
    v_cmp_le_u32 s[62:63], v4, v3
    v_lshl_add_u32 v4, v2, 2, 2
    v_cmp_le_u32 s[64:65], v4, v3
    v_lshl_add_u32 v4, v2, 2, 3
    v_cmp_le_u32 s[66:67], v4, v3
    s_mul_i32 s50, s40, 1280
    v_lshlrev_b32 v4, 8, v2
    v_lshl_add_u32 v4, v3, 3, v4
    v_add_u32 v24, s50, v4
    s_add_u32 s50, s50, 15360
    v_lshl_add_u32 v25, v0, 4, s50
    v_lshlrev_b32 v4, 6, v2
    v_and_b32 v5, 3, v3
    v_lshl_add_u32 v4, v5, 4, v4
    s_add_u32 s50, s50, 1024
    v_add_u32 v26, s50, v4
    v_mov_b32 v27, 0xf149f2ca
    v_mov_b32 v196, s57
    v_mov_b32 v197, s57
    v_mov_b32 v198, s57
    v_mov_b32 v199, s57
    v_mov_b32 v204, s57
    v_mov_b32 v205, s57
    v_mov_b32 v206, s57
    v_mov_b32 v207, s57
    s_mov_b32 s70, 0x000f000f
    s_mov_b32 s71, 0x000f000f
    s_lshl_b32 s50, s43, 2
    s_add_u32 s50, s50, s40
    s_waitcnt vmcnt(0) lgkmcnt(0)
    s_barrier
    ds_read_b64 v[172:173], v24 offset:0
    ds_read_b64 v[174:175], v24 offset:128
    ds_read_b64 v[176:177], v24 offset:640
    ds_read_b64 v[178:179], v24 offset:768
    ds_read_b64 v[180:181], v24 offset:1280
    ds_read_b64 v[182:183], v24 offset:1408
    ds_read_b64 v[184:185], v24 offset:1920
    ds_read_b64 v[186:187], v24 offset:2048
    s_cmp_ge_u32 s50, 8
    s_cselect_b32 s51, 0, 0xf149f2ca
    v_mov_b32 v188, s51
    v_mov_b32 v189, s51
    v_mov_b32 v190, s51
    v_mov_b32 v191, s51
    s_waitcnt lgkmcnt(6)
    s_nop 0
    v_mfma_f32_16x16x32_bf16 v[28:31], v[172:175], v[8:11], v[188:191]
    ds_read_b64 v[172:173], v24 offset:2560
    ds_read_b64 v[174:175], v24 offset:2688
    s_waitcnt lgkmcnt(6)
    v_mfma_f32_16x16x32_bf16 v[32:35], v[176:179], v[8:11], v[188:191]
    v_mfma_f32_16x16x32_bf16 v[104:107], v[176:179], v[12:15], v[188:191]
    ds_read_b64 v[176:177], v24 offset:3200
    ds_read_b64 v[178:179], v24 offset:3328
    s_cmp_ge_u32 s50, 7
    s_cselect_b32 s51, 0, 0xf149f2ca
    v_mov_b32 v188, s51
    v_mov_b32 v189, s51
    v_mov_b32 v190, s51
    v_mov_b32 v191, s51
    s_waitcnt lgkmcnt(6)
    s_nop 0
    v_mfma_f32_16x16x32_bf16 v[36:39], v[180:183], v[8:11], v[188:191]
    v_mfma_f32_16x16x32_bf16 v[108:111], v[180:183], v[12:15], v[188:191]
    ds_read_b64 v[180:181], v24 offset:3840
    ds_read_b64 v[182:183], v24 offset:3968
    s_waitcnt lgkmcnt(6)
    v_mfma_f32_16x16x32_bf16 v[40:43], v[184:187], v[8:11], v[188:191]
    v_mfma_f32_16x16x32_bf16 v[112:115], v[184:187], v[12:15], v[188:191]
    ds_read_b64 v[184:185], v24 offset:4480
    ds_read_b64 v[186:187], v24 offset:4608
    s_cmp_ge_u32 s50, 6
    s_cselect_b32 s51, 0, 0xf149f2ca
    v_mov_b32 v188, s51
    v_mov_b32 v189, s51
    v_mov_b32 v190, s51
    v_mov_b32 v191, s51
    s_waitcnt lgkmcnt(6)
    s_nop 0
    v_mfma_f32_16x16x32_bf16 v[44:47], v[172:175], v[8:11], v[188:191]
    v_mfma_f32_16x16x32_bf16 v[116:119], v[172:175], v[12:15], v[188:191]
    ds_read_b64 v[172:173], v24 offset:5120
    ds_read_b64 v[174:175], v24 offset:5248
    s_waitcnt lgkmcnt(6)
    v_mfma_f32_16x16x32_bf16 v[48:51], v[176:179], v[8:11], v[188:191]
    v_mfma_f32_16x16x32_bf16 v[120:123], v[176:179], v[12:15], v[188:191]
    ds_read_b64 v[176:177], v24 offset:5760
    ds_read_b64 v[178:179], v24 offset:5888
    s_cmp_ge_u32 s50, 5
    s_cselect_b32 s51, 0, 0xf149f2ca
    v_mov_b32 v188, s51
    v_mov_b32 v189, s51
    v_mov_b32 v190, s51
    v_mov_b32 v191, s51
    s_waitcnt lgkmcnt(6)
    s_nop 0
    v_mfma_f32_16x16x32_bf16 v[52:55], v[180:183], v[8:11], v[188:191]
    v_mfma_f32_16x16x32_bf16 v[124:127], v[180:183], v[12:15], v[188:191]
    ds_read_b64 v[180:181], v24 offset:6400
    ds_read_b64 v[182:183], v24 offset:6528
    s_waitcnt lgkmcnt(6)
    v_mfma_f32_16x16x32_bf16 v[56:59], v[184:187], v[8:11], v[188:191]
    v_mfma_f32_16x16x32_bf16 v[128:131], v[184:187], v[12:15], v[188:191]
    ds_read_b64 v[184:185], v24 offset:7040
    ds_read_b64 v[186:187], v24 offset:7168
    s_cmp_ge_u32 s50, 4
    s_cselect_b32 s51, 0, 0xf149f2ca
    v_mov_b32 v188, s51
    v_mov_b32 v189, s51
    v_mov_b32 v190, s51
    v_mov_b32 v191, s51
    s_waitcnt lgkmcnt(6)
    s_nop 0
    v_mfma_f32_16x16x32_bf16 v[60:63], v[172:175], v[8:11], v[188:191]
    v_mfma_f32_16x16x32_bf16 v[132:135], v[172:175], v[12:15], v[188:191]
    ds_read_b64 v[172:173], v24 offset:7680
    ds_read_b64 v[174:175], v24 offset:7808
    s_waitcnt lgkmcnt(6)
    v_mfma_f32_16x16x32_bf16 v[64:67], v[176:179], v[8:11], v[188:191]
    v_mfma_f32_16x16x32_bf16 v[136:139], v[176:179], v[12:15], v[188:191]
    ds_read_b64 v[176:177], v24 offset:8320
    ds_read_b64 v[178:179], v24 offset:8448
    s_cmp_ge_u32 s50, 3
    s_cselect_b32 s51, 0, 0xf149f2ca
    v_mov_b32 v188, s51
    v_mov_b32 v189, s51
    v_mov_b32 v190, s51
    v_mov_b32 v191, s51
    s_waitcnt lgkmcnt(6)
    s_nop 0
    v_mfma_f32_16x16x32_bf16 v[68:71], v[180:183], v[8:11], v[188:191]
    v_mfma_f32_16x16x32_bf16 v[140:143], v[180:183], v[12:15], v[188:191]
    ds_read_b64 v[180:181], v24 offset:8960
    ds_read_b64 v[182:183], v24 offset:9088
    s_waitcnt lgkmcnt(6)
    v_mfma_f32_16x16x32_bf16 v[72:75], v[184:187], v[8:11], v[188:191]
    v_mfma_f32_16x16x32_bf16 v[144:147], v[184:187], v[12:15], v[188:191]
    ds_read_b64 v[184:185], v24 offset:9600
    ds_read_b64 v[186:187], v24 offset:9728
    s_cmp_ge_u32 s50, 2
    s_cselect_b32 s51, 0, 0xf149f2ca
    v_mov_b32 v188, s51
    v_mov_b32 v189, s51
    v_mov_b32 v190, s51
    v_mov_b32 v191, s51
    s_waitcnt lgkmcnt(6)
    s_nop 0
    v_mfma_f32_16x16x32_bf16 v[76:79], v[172:175], v[8:11], v[188:191]
    v_mfma_f32_16x16x32_bf16 v[148:151], v[172:175], v[12:15], v[188:191]
    ds_read_b64 v[172:173], v24 offset:10240
    ds_read_b64 v[174:175], v24 offset:10368
    s_waitcnt lgkmcnt(6)
    v_mfma_f32_16x16x32_bf16 v[80:83], v[176:179], v[8:11], v[188:191]
    v_mfma_f32_16x16x32_bf16 v[152:155], v[176:179], v[12:15], v[188:191]
    ds_read_b64 v[176:177], v24 offset:10880
    ds_read_b64 v[178:179], v24 offset:11008
    s_cmp_ge_u32 s50, 1
    s_cselect_b32 s51, 0, 0xf149f2ca
    v_mov_b32 v188, s51
    v_mov_b32 v189, s51
    v_mov_b32 v190, s51
    v_mov_b32 v191, s51
    s_waitcnt lgkmcnt(6)
    s_nop 0
    v_mfma_f32_16x16x32_bf16 v[84:87], v[180:183], v[8:11], v[188:191]
    v_mfma_f32_16x16x32_bf16 v[156:159], v[180:183], v[12:15], v[188:191]
    s_waitcnt lgkmcnt(4)
    v_mfma_f32_16x16x32_bf16 v[88:91], v[184:187], v[8:11], v[188:191]
    v_mfma_f32_16x16x32_bf16 v[160:163], v[184:187], v[12:15], v[188:191]
    s_cmp_ge_u32 s50, 0
    s_cselect_b32 s51, 0, 0xf149f2ca
    s_nop 0
    v_mov_b32 v188, s51
    v_mov_b32 v189, s51
    v_mov_b32 v190, s51
    v_mov_b32 v191, s51
    s_waitcnt lgkmcnt(2)
    s_nop 0
    v_mfma_f32_16x16x32_bf16 v[92:95], v[172:175], v[8:11], v[188:191]
    v_mfma_f32_16x16x32_bf16 v[164:167], v[172:175], v[12:15], v[188:191]
    s_waitcnt lgkmcnt(0)
    v_mfma_f32_16x16x32_bf16 v[168:171], v[176:179], v[12:15], v[188:191]
    ds_read_b128 v[192:195], v25 offset:0
    s_mov_b64 exec, s[70:71]
    ds_read_b128 v[196:199], v26 offset:0
    s_mov_b64 exec, -1
    v_cndmask_b32 v28, v28, v27, s[60:61]
    v_cndmask_b32 v92, v27, v92, s[60:61]
    v_cndmask_b32 v29, v29, v27, s[62:63]
    v_cndmask_b32 v93, v27, v93, s[62:63]
    v_cndmask_b32 v30, v30, v27, s[64:65]
    v_cndmask_b32 v94, v27, v94, s[64:65]
    v_cndmask_b32 v31, v31, v27, s[66:67]
    v_cndmask_b32 v95, v27, v95, s[66:67]
    v_max3_f32 v208, v28, v29, v30
    v_max3_f32 v1, v31, v32, v33
    v_max3_f32 v208, v208, v34, v35
    v_max3_f32 v1, v1, v36, v37
    v_max3_f32 v208, v208, v38, v39
    v_max3_f32 v1, v1, v40, v41
    v_max3_f32 v208, v208, v42, v43
    v_max3_f32 v1, v1, v44, v45
    v_max3_f32 v208, v208, v46, v47
    v_max3_f32 v1, v1, v48, v49
    v_max3_f32 v208, v208, v50, v51
    v_max3_f32 v1, v1, v52, v53
    v_max3_f32 v208, v208, v54, v55
    v_max3_f32 v1, v1, v56, v57
    v_max3_f32 v208, v208, v58, v59
    v_max3_f32 v1, v1, v60, v61
    v_max3_f32 v208, v208, v62, v63
    v_max3_f32 v1, v1, v64, v65
    v_max3_f32 v208, v208, v66, v67
    v_max3_f32 v1, v1, v68, v69
    v_max3_f32 v208, v208, v70, v71
    v_max3_f32 v1, v1, v72, v73
    v_max3_f32 v208, v208, v74, v75
    v_max3_f32 v1, v1, v76, v77
    v_max3_f32 v208, v208, v78, v79
    v_max3_f32 v1, v1, v80, v81
    v_max3_f32 v208, v208, v82, v83
    v_max3_f32 v1, v1, v84, v85
    v_max3_f32 v208, v208, v86, v87
    v_max3_f32 v1, v1, v88, v89
    v_max3_f32 v208, v208, v90, v91
    v_max3_f32 v1, v1, v92, v93
    v_max3_f32 v208, v208, v94, v95
    v_max_f32 v208, v208, v1
    v_mov_b32 v1, v208
    s_nop 1
    v_permlane32_swap_b32 v1, v208
    v_max_f32 v208, v208, v1
    v_mov_b32 v1, v208
    s_nop 1
    v_permlane16_swap_b32 v1, v208
    v_max_f32 v208, v208, v1
    v_cndmask_b32 v104, v104, v27, s[60:61]
    v_cndmask_b32 v168, v27, v168, s[60:61]
    v_cndmask_b32 v105, v105, v27, s[62:63]
    v_cndmask_b32 v169, v27, v169, s[62:63]
    v_cndmask_b32 v106, v106, v27, s[64:65]
    v_cndmask_b32 v170, v27, v170, s[64:65]
    v_cndmask_b32 v107, v107, v27, s[66:67]
    v_cndmask_b32 v171, v27, v171, s[66:67]
    v_max3_f32 v210, v104, v105, v106
    v_max3_f32 v1, v107, v108, v109
    v_max3_f32 v210, v210, v110, v111
    v_max3_f32 v1, v1, v112, v113
    v_max3_f32 v210, v210, v114, v115
    v_max3_f32 v1, v1, v116, v117
    v_max3_f32 v210, v210, v118, v119
    v_max3_f32 v1, v1, v120, v121
    v_max3_f32 v210, v210, v122, v123
    v_max3_f32 v1, v1, v124, v125
    v_max3_f32 v210, v210, v126, v127
    v_max3_f32 v1, v1, v128, v129
    v_max3_f32 v210, v210, v130, v131
    v_max3_f32 v1, v1, v132, v133
    v_max3_f32 v210, v210, v134, v135
    v_max3_f32 v1, v1, v136, v137
    v_max3_f32 v210, v210, v138, v139
    v_max3_f32 v1, v1, v140, v141
    v_max3_f32 v210, v210, v142, v143
    v_max3_f32 v1, v1, v144, v145
    v_max3_f32 v210, v210, v146, v147
    v_max3_f32 v1, v1, v148, v149
    v_max3_f32 v210, v210, v150, v151
    v_max3_f32 v1, v1, v152, v153
    v_max3_f32 v210, v210, v154, v155
    v_max3_f32 v1, v1, v156, v157
    v_max3_f32 v210, v210, v158, v159
    v_max3_f32 v1, v1, v160, v161
    v_max3_f32 v210, v210, v162, v163
    v_max3_f32 v1, v1, v164, v165
    v_max3_f32 v210, v210, v166, v167
    v_max3_f32 v1, v1, v168, v169
    v_max3_f32 v210, v210, v170, v171
    v_max_f32 v210, v210, v1
    v_mov_b32 v1, v210
    s_nop 1
    v_permlane32_swap_b32 v1, v210
    v_max_f32 v210, v210, v1
    v_mov_b32 v1, v210
    s_nop 1
    v_permlane16_swap_b32 v1, v210
    v_max_f32 v210, v210, v1
    v_pk_add_f32 v[28:29], v[28:29], v[208:209] op_sel_hi:[1,0] neg_lo:[0,1] neg_hi:[0,1]
    v_pk_add_f32 v[30:31], v[30:31], v[208:209] op_sel_hi:[1,0] neg_lo:[0,1] neg_hi:[0,1]
    v_exp_f32 v28, v28
    v_exp_f32 v29, v29
    v_exp_f32 v30, v30
    v_exp_f32 v31, v31
    v_pk_add_f32 v[32:33], v[32:33], v[208:209] op_sel_hi:[1,0] neg_lo:[0,1] neg_hi:[0,1]
    v_pk_add_f32 v[34:35], v[34:35], v[208:209] op_sel_hi:[1,0] neg_lo:[0,1] neg_hi:[0,1]
    v_exp_f32 v32, v32
    v_exp_f32 v33, v33
    v_exp_f32 v34, v34
    v_exp_f32 v35, v35
    v_cvt_pk_bf16_f32 v28, v28, v29
    v_cvt_pk_bf16_f32 v29, v30, v31
    v_cvt_pk_bf16_f32 v30, v32, v33
    v_cvt_pk_bf16_f32 v31, v34, v35
    v_pk_add_f32 v[104:105], v[104:105], v[210:211] op_sel_hi:[1,0] neg_lo:[0,1] neg_hi:[0,1]
    v_pk_add_f32 v[106:107], v[106:107], v[210:211] op_sel_hi:[1,0] neg_lo:[0,1] neg_hi:[0,1]
    v_exp_f32 v104, v104
    v_exp_f32 v105, v105
    v_exp_f32 v106, v106
    v_exp_f32 v107, v107
    v_mov_b32 v100, 0
    v_mov_b32 v101, 0
    v_cvt_pk_bf16_f32 v102, v104, v105
    v_cvt_pk_bf16_f32 v103, v106, v107
    ds_read_b128 v[200:203], v25 offset:1280
    s_mov_b64 exec, s[70:71]
    ds_read_b128 v[204:207], v26 offset:1280
    s_mov_b64 exec, -1
    s_waitcnt lgkmcnt(2)
    v_mfma_f32_16x16x32_bf16 v[212:215], v[192:195], v[28:31], 0
    v_mfma_f32_16x16x32_bf16 v[216:219], v[196:199], v[28:31], 0
    v_mfma_f32_16x16x32_bf16 v[220:223], v[192:195], v[100:103], 0
    v_mfma_f32_16x16x32_bf16 v[224:227], v[196:199], v[100:103], 0
    v_pk_add_f32 v[36:37], v[36:37], v[208:209] op_sel_hi:[1,0] neg_lo:[0,1] neg_hi:[0,1]
    v_pk_add_f32 v[38:39], v[38:39], v[208:209] op_sel_hi:[1,0] neg_lo:[0,1] neg_hi:[0,1]
    v_exp_f32 v36, v36
    v_exp_f32 v37, v37
    v_exp_f32 v38, v38
    v_exp_f32 v39, v39
    v_pk_add_f32 v[40:41], v[40:41], v[208:209] op_sel_hi:[1,0] neg_lo:[0,1] neg_hi:[0,1]
    v_pk_add_f32 v[42:43], v[42:43], v[208:209] op_sel_hi:[1,0] neg_lo:[0,1] neg_hi:[0,1]
    v_exp_f32 v40, v40
    v_exp_f32 v41, v41
    v_exp_f32 v42, v42
    v_exp_f32 v43, v43
    v_cvt_pk_bf16_f32 v36, v36, v37
    v_cvt_pk_bf16_f32 v37, v38, v39
    v_cvt_pk_bf16_f32 v38, v40, v41
    v_cvt_pk_bf16_f32 v39, v42, v43
    v_pk_add_f32 v[108:109], v[108:109], v[210:211] op_sel_hi:[1,0] neg_lo:[0,1] neg_hi:[0,1]
    v_pk_add_f32 v[110:111], v[110:111], v[210:211] op_sel_hi:[1,0] neg_lo:[0,1] neg_hi:[0,1]
    v_exp_f32 v108, v108
    v_exp_f32 v109, v109
    v_exp_f32 v110, v110
    v_exp_f32 v111, v111
    v_pk_add_f32 v[112:113], v[112:113], v[210:211] op_sel_hi:[1,0] neg_lo:[0,1] neg_hi:[0,1]
    v_pk_add_f32 v[114:115], v[114:115], v[210:211] op_sel_hi:[1,0] neg_lo:[0,1] neg_hi:[0,1]
    v_exp_f32 v112, v112
    v_exp_f32 v113, v113
    v_exp_f32 v114, v114
    v_exp_f32 v115, v115
    v_cvt_pk_bf16_f32 v108, v108, v109
    v_cvt_pk_bf16_f32 v109, v110, v111
    v_cvt_pk_bf16_f32 v110, v112, v113
    v_cvt_pk_bf16_f32 v111, v114, v115
    ds_read_b128 v[192:195], v25 offset:2560
    s_mov_b64 exec, s[70:71]
    ds_read_b128 v[196:199], v26 offset:2560
    s_mov_b64 exec, -1
    s_waitcnt lgkmcnt(2)
    v_mfma_f32_16x16x32_bf16 v[212:215], v[200:203], v[36:39], v[212:215]
    v_mfma_f32_16x16x32_bf16 v[216:219], v[204:207], v[36:39], v[216:219]
    v_mfma_f32_16x16x32_bf16 v[220:223], v[200:203], v[108:111], v[220:223]
    v_mfma_f32_16x16x32_bf16 v[224:227], v[204:207], v[108:111], v[224:227]
    v_pk_add_f32 v[44:45], v[44:45], v[208:209] op_sel_hi:[1,0] neg_lo:[0,1] neg_hi:[0,1]
    v_pk_add_f32 v[46:47], v[46:47], v[208:209] op_sel_hi:[1,0] neg_lo:[0,1] neg_hi:[0,1]
    v_exp_f32 v44, v44
    v_exp_f32 v45, v45
    v_exp_f32 v46, v46
    v_exp_f32 v47, v47
    v_pk_add_f32 v[48:49], v[48:49], v[208:209] op_sel_hi:[1,0] neg_lo:[0,1] neg_hi:[0,1]
    v_pk_add_f32 v[50:51], v[50:51], v[208:209] op_sel_hi:[1,0] neg_lo:[0,1] neg_hi:[0,1]
    v_exp_f32 v48, v48
    v_exp_f32 v49, v49
    v_exp_f32 v50, v50
    v_exp_f32 v51, v51
    v_cvt_pk_bf16_f32 v44, v44, v45
    v_cvt_pk_bf16_f32 v45, v46, v47
    v_cvt_pk_bf16_f32 v46, v48, v49
    v_cvt_pk_bf16_f32 v47, v50, v51
    v_pk_add_f32 v[116:117], v[116:117], v[210:211] op_sel_hi:[1,0] neg_lo:[0,1] neg_hi:[0,1]
    v_pk_add_f32 v[118:119], v[118:119], v[210:211] op_sel_hi:[1,0] neg_lo:[0,1] neg_hi:[0,1]
    v_exp_f32 v116, v116
    v_exp_f32 v117, v117
    v_exp_f32 v118, v118
    v_exp_f32 v119, v119
    v_pk_add_f32 v[120:121], v[120:121], v[210:211] op_sel_hi:[1,0] neg_lo:[0,1] neg_hi:[0,1]
    v_pk_add_f32 v[122:123], v[122:123], v[210:211] op_sel_hi:[1,0] neg_lo:[0,1] neg_hi:[0,1]
    v_exp_f32 v120, v120
    v_exp_f32 v121, v121
    v_exp_f32 v122, v122
    v_exp_f32 v123, v123
    v_cvt_pk_bf16_f32 v116, v116, v117
    v_cvt_pk_bf16_f32 v117, v118, v119
    v_cvt_pk_bf16_f32 v118, v120, v121
    v_cvt_pk_bf16_f32 v119, v122, v123
    ds_read_b128 v[200:203], v25 offset:3840
    s_mov_b64 exec, s[70:71]
    ds_read_b128 v[204:207], v26 offset:3840
    s_mov_b64 exec, -1
    s_waitcnt lgkmcnt(2)
    v_mfma_f32_16x16x32_bf16 v[212:215], v[192:195], v[44:47], v[212:215]
    v_mfma_f32_16x16x32_bf16 v[216:219], v[196:199], v[44:47], v[216:219]
    v_mfma_f32_16x16x32_bf16 v[220:223], v[192:195], v[116:119], v[220:223]
    v_mfma_f32_16x16x32_bf16 v[224:227], v[196:199], v[116:119], v[224:227]
    v_pk_add_f32 v[52:53], v[52:53], v[208:209] op_sel_hi:[1,0] neg_lo:[0,1] neg_hi:[0,1]
    v_pk_add_f32 v[54:55], v[54:55], v[208:209] op_sel_hi:[1,0] neg_lo:[0,1] neg_hi:[0,1]
    v_exp_f32 v52, v52
    v_exp_f32 v53, v53
    v_exp_f32 v54, v54
    v_exp_f32 v55, v55
    v_pk_add_f32 v[56:57], v[56:57], v[208:209] op_sel_hi:[1,0] neg_lo:[0,1] neg_hi:[0,1]
    v_pk_add_f32 v[58:59], v[58:59], v[208:209] op_sel_hi:[1,0] neg_lo:[0,1] neg_hi:[0,1]
    v_exp_f32 v56, v56
    v_exp_f32 v57, v57
    v_exp_f32 v58, v58
    v_exp_f32 v59, v59
    v_cvt_pk_bf16_f32 v52, v52, v53
    v_cvt_pk_bf16_f32 v53, v54, v55
    v_cvt_pk_bf16_f32 v54, v56, v57
    v_cvt_pk_bf16_f32 v55, v58, v59
    v_pk_add_f32 v[124:125], v[124:125], v[210:211] op_sel_hi:[1,0] neg_lo:[0,1] neg_hi:[0,1]
    v_pk_add_f32 v[126:127], v[126:127], v[210:211] op_sel_hi:[1,0] neg_lo:[0,1] neg_hi:[0,1]
    v_exp_f32 v124, v124
    v_exp_f32 v125, v125
    v_exp_f32 v126, v126
    v_exp_f32 v127, v127
    v_pk_add_f32 v[128:129], v[128:129], v[210:211] op_sel_hi:[1,0] neg_lo:[0,1] neg_hi:[0,1]
    v_pk_add_f32 v[130:131], v[130:131], v[210:211] op_sel_hi:[1,0] neg_lo:[0,1] neg_hi:[0,1]
    v_exp_f32 v128, v128
    v_exp_f32 v129, v129
    v_exp_f32 v130, v130
    v_exp_f32 v131, v131
    v_cvt_pk_bf16_f32 v124, v124, v125
    v_cvt_pk_bf16_f32 v125, v126, v127
    v_cvt_pk_bf16_f32 v126, v128, v129
    v_cvt_pk_bf16_f32 v127, v130, v131
    ds_read_b128 v[192:195], v25 offset:5120
    s_mov_b64 exec, s[70:71]
    ds_read_b128 v[196:199], v26 offset:5120
    s_mov_b64 exec, -1
    s_waitcnt lgkmcnt(2)
    v_mfma_f32_16x16x32_bf16 v[212:215], v[200:203], v[52:55], v[212:215]
    v_mfma_f32_16x16x32_bf16 v[216:219], v[204:207], v[52:55], v[216:219]
    v_mfma_f32_16x16x32_bf16 v[220:223], v[200:203], v[124:127], v[220:223]
    v_mfma_f32_16x16x32_bf16 v[224:227], v[204:207], v[124:127], v[224:227]
    v_pk_add_f32 v[60:61], v[60:61], v[208:209] op_sel_hi:[1,0] neg_lo:[0,1] neg_hi:[0,1]
    v_pk_add_f32 v[62:63], v[62:63], v[208:209] op_sel_hi:[1,0] neg_lo:[0,1] neg_hi:[0,1]
    v_exp_f32 v60, v60
    v_exp_f32 v61, v61
    v_exp_f32 v62, v62
    v_exp_f32 v63, v63
    v_pk_add_f32 v[64:65], v[64:65], v[208:209] op_sel_hi:[1,0] neg_lo:[0,1] neg_hi:[0,1]
    v_pk_add_f32 v[66:67], v[66:67], v[208:209] op_sel_hi:[1,0] neg_lo:[0,1] neg_hi:[0,1]
    v_exp_f32 v64, v64
    v_exp_f32 v65, v65
    v_exp_f32 v66, v66
    v_exp_f32 v67, v67
    v_cvt_pk_bf16_f32 v60, v60, v61
    v_cvt_pk_bf16_f32 v61, v62, v63
    v_cvt_pk_bf16_f32 v62, v64, v65
    v_cvt_pk_bf16_f32 v63, v66, v67
    v_pk_add_f32 v[132:133], v[132:133], v[210:211] op_sel_hi:[1,0] neg_lo:[0,1] neg_hi:[0,1]
    v_pk_add_f32 v[134:135], v[134:135], v[210:211] op_sel_hi:[1,0] neg_lo:[0,1] neg_hi:[0,1]
    v_exp_f32 v132, v132
    v_exp_f32 v133, v133
    v_exp_f32 v134, v134
    v_exp_f32 v135, v135
    v_pk_add_f32 v[136:137], v[136:137], v[210:211] op_sel_hi:[1,0] neg_lo:[0,1] neg_hi:[0,1]
    v_pk_add_f32 v[138:139], v[138:139], v[210:211] op_sel_hi:[1,0] neg_lo:[0,1] neg_hi:[0,1]
    v_exp_f32 v136, v136
    v_exp_f32 v137, v137
    v_exp_f32 v138, v138
    v_exp_f32 v139, v139
    v_cvt_pk_bf16_f32 v132, v132, v133
    v_cvt_pk_bf16_f32 v133, v134, v135
    v_cvt_pk_bf16_f32 v134, v136, v137
    v_cvt_pk_bf16_f32 v135, v138, v139
    ds_read_b128 v[200:203], v25 offset:6400
    s_mov_b64 exec, s[70:71]
    ds_read_b128 v[204:207], v26 offset:6400
    s_mov_b64 exec, -1
    s_waitcnt lgkmcnt(2)
    v_mfma_f32_16x16x32_bf16 v[212:215], v[192:195], v[60:63], v[212:215]
    v_mfma_f32_16x16x32_bf16 v[216:219], v[196:199], v[60:63], v[216:219]
    v_mfma_f32_16x16x32_bf16 v[220:223], v[192:195], v[132:135], v[220:223]
    v_mfma_f32_16x16x32_bf16 v[224:227], v[196:199], v[132:135], v[224:227]
    v_pk_add_f32 v[68:69], v[68:69], v[208:209] op_sel_hi:[1,0] neg_lo:[0,1] neg_hi:[0,1]
    v_pk_add_f32 v[70:71], v[70:71], v[208:209] op_sel_hi:[1,0] neg_lo:[0,1] neg_hi:[0,1]
    v_exp_f32 v68, v68
    v_exp_f32 v69, v69
    v_exp_f32 v70, v70
    v_exp_f32 v71, v71
    v_pk_add_f32 v[72:73], v[72:73], v[208:209] op_sel_hi:[1,0] neg_lo:[0,1] neg_hi:[0,1]
    v_pk_add_f32 v[74:75], v[74:75], v[208:209] op_sel_hi:[1,0] neg_lo:[0,1] neg_hi:[0,1]
    v_exp_f32 v72, v72
    v_exp_f32 v73, v73
    v_exp_f32 v74, v74
    v_exp_f32 v75, v75
    v_cvt_pk_bf16_f32 v68, v68, v69
    v_cvt_pk_bf16_f32 v69, v70, v71
    v_cvt_pk_bf16_f32 v70, v72, v73
    v_cvt_pk_bf16_f32 v71, v74, v75
    v_pk_add_f32 v[140:141], v[140:141], v[210:211] op_sel_hi:[1,0] neg_lo:[0,1] neg_hi:[0,1]
    v_pk_add_f32 v[142:143], v[142:143], v[210:211] op_sel_hi:[1,0] neg_lo:[0,1] neg_hi:[0,1]
    v_exp_f32 v140, v140
    v_exp_f32 v141, v141
    v_exp_f32 v142, v142
    v_exp_f32 v143, v143
    v_pk_add_f32 v[144:145], v[144:145], v[210:211] op_sel_hi:[1,0] neg_lo:[0,1] neg_hi:[0,1]
    v_pk_add_f32 v[146:147], v[146:147], v[210:211] op_sel_hi:[1,0] neg_lo:[0,1] neg_hi:[0,1]
    v_exp_f32 v144, v144
    v_exp_f32 v145, v145
    v_exp_f32 v146, v146
    v_exp_f32 v147, v147
    v_cvt_pk_bf16_f32 v140, v140, v141
    v_cvt_pk_bf16_f32 v141, v142, v143
    v_cvt_pk_bf16_f32 v142, v144, v145
    v_cvt_pk_bf16_f32 v143, v146, v147
    ds_read_b128 v[192:195], v25 offset:7680
    s_mov_b64 exec, s[70:71]
    ds_read_b128 v[196:199], v26 offset:7680
    s_mov_b64 exec, -1
    s_waitcnt lgkmcnt(2)
    v_mfma_f32_16x16x32_bf16 v[212:215], v[200:203], v[68:71], v[212:215]
    v_mfma_f32_16x16x32_bf16 v[216:219], v[204:207], v[68:71], v[216:219]
    v_mfma_f32_16x16x32_bf16 v[220:223], v[200:203], v[140:143], v[220:223]
    v_mfma_f32_16x16x32_bf16 v[224:227], v[204:207], v[140:143], v[224:227]
    v_pk_add_f32 v[76:77], v[76:77], v[208:209] op_sel_hi:[1,0] neg_lo:[0,1] neg_hi:[0,1]
    v_pk_add_f32 v[78:79], v[78:79], v[208:209] op_sel_hi:[1,0] neg_lo:[0,1] neg_hi:[0,1]
    v_exp_f32 v76, v76
    v_exp_f32 v77, v77
    v_exp_f32 v78, v78
    v_exp_f32 v79, v79
    v_pk_add_f32 v[80:81], v[80:81], v[208:209] op_sel_hi:[1,0] neg_lo:[0,1] neg_hi:[0,1]
    v_pk_add_f32 v[82:83], v[82:83], v[208:209] op_sel_hi:[1,0] neg_lo:[0,1] neg_hi:[0,1]
    v_exp_f32 v80, v80
    v_exp_f32 v81, v81
    v_exp_f32 v82, v82
    v_exp_f32 v83, v83
    v_cvt_pk_bf16_f32 v76, v76, v77
    v_cvt_pk_bf16_f32 v77, v78, v79
    v_cvt_pk_bf16_f32 v78, v80, v81
    v_cvt_pk_bf16_f32 v79, v82, v83
    v_pk_add_f32 v[148:149], v[148:149], v[210:211] op_sel_hi:[1,0] neg_lo:[0,1] neg_hi:[0,1]
    v_pk_add_f32 v[150:151], v[150:151], v[210:211] op_sel_hi:[1,0] neg_lo:[0,1] neg_hi:[0,1]
    v_exp_f32 v148, v148
    v_exp_f32 v149, v149
    v_exp_f32 v150, v150
    v_exp_f32 v151, v151
    v_pk_add_f32 v[152:153], v[152:153], v[210:211] op_sel_hi:[1,0] neg_lo:[0,1] neg_hi:[0,1]
    v_pk_add_f32 v[154:155], v[154:155], v[210:211] op_sel_hi:[1,0] neg_lo:[0,1] neg_hi:[0,1]
    v_exp_f32 v152, v152
    v_exp_f32 v153, v153
    v_exp_f32 v154, v154
    v_exp_f32 v155, v155
    v_cvt_pk_bf16_f32 v148, v148, v149
    v_cvt_pk_bf16_f32 v149, v150, v151
    v_cvt_pk_bf16_f32 v150, v152, v153
    v_cvt_pk_bf16_f32 v151, v154, v155
    ds_read_b128 v[200:203], v25 offset:8960
    s_mov_b64 exec, s[70:71]
    ds_read_b128 v[204:207], v26 offset:8960
    s_mov_b64 exec, -1
    s_waitcnt lgkmcnt(2)
    v_mfma_f32_16x16x32_bf16 v[212:215], v[192:195], v[76:79], v[212:215]
    v_mfma_f32_16x16x32_bf16 v[216:219], v[196:199], v[76:79], v[216:219]
    v_mfma_f32_16x16x32_bf16 v[220:223], v[192:195], v[148:151], v[220:223]
    v_mfma_f32_16x16x32_bf16 v[224:227], v[196:199], v[148:151], v[224:227]
    v_pk_add_f32 v[84:85], v[84:85], v[208:209] op_sel_hi:[1,0] neg_lo:[0,1] neg_hi:[0,1]
    v_pk_add_f32 v[86:87], v[86:87], v[208:209] op_sel_hi:[1,0] neg_lo:[0,1] neg_hi:[0,1]
    v_exp_f32 v84, v84
    v_exp_f32 v85, v85
    v_exp_f32 v86, v86
    v_exp_f32 v87, v87
    v_pk_add_f32 v[88:89], v[88:89], v[208:209] op_sel_hi:[1,0] neg_lo:[0,1] neg_hi:[0,1]
    v_pk_add_f32 v[90:91], v[90:91], v[208:209] op_sel_hi:[1,0] neg_lo:[0,1] neg_hi:[0,1]
    v_exp_f32 v88, v88
    v_exp_f32 v89, v89
    v_exp_f32 v90, v90
    v_exp_f32 v91, v91
    v_cvt_pk_bf16_f32 v84, v84, v85
    v_cvt_pk_bf16_f32 v85, v86, v87
    v_cvt_pk_bf16_f32 v86, v88, v89
    v_cvt_pk_bf16_f32 v87, v90, v91
    v_pk_add_f32 v[156:157], v[156:157], v[210:211] op_sel_hi:[1,0] neg_lo:[0,1] neg_hi:[0,1]
    v_pk_add_f32 v[158:159], v[158:159], v[210:211] op_sel_hi:[1,0] neg_lo:[0,1] neg_hi:[0,1]
    v_exp_f32 v156, v156
    v_exp_f32 v157, v157
    v_exp_f32 v158, v158
    v_exp_f32 v159, v159
    v_pk_add_f32 v[160:161], v[160:161], v[210:211] op_sel_hi:[1,0] neg_lo:[0,1] neg_hi:[0,1]
    v_pk_add_f32 v[162:163], v[162:163], v[210:211] op_sel_hi:[1,0] neg_lo:[0,1] neg_hi:[0,1]
    v_exp_f32 v160, v160
    v_exp_f32 v161, v161
    v_exp_f32 v162, v162
    v_exp_f32 v163, v163
    v_cvt_pk_bf16_f32 v156, v156, v157
    v_cvt_pk_bf16_f32 v157, v158, v159
    v_cvt_pk_bf16_f32 v158, v160, v161
    v_cvt_pk_bf16_f32 v159, v162, v163
    ds_read_b128 v[192:195], v25 offset:10240
    s_mov_b64 exec, s[70:71]
    ds_read_b128 v[196:199], v26 offset:10240
    s_mov_b64 exec, -1
    s_waitcnt lgkmcnt(2)
    v_mfma_f32_16x16x32_bf16 v[212:215], v[200:203], v[84:87], v[212:215]
    v_mfma_f32_16x16x32_bf16 v[216:219], v[204:207], v[84:87], v[216:219]
    v_mfma_f32_16x16x32_bf16 v[220:223], v[200:203], v[156:159], v[220:223]
    v_mfma_f32_16x16x32_bf16 v[224:227], v[204:207], v[156:159], v[224:227]
    v_pk_add_f32 v[92:93], v[92:93], v[208:209] op_sel_hi:[1,0] neg_lo:[0,1] neg_hi:[0,1]
    v_pk_add_f32 v[94:95], v[94:95], v[208:209] op_sel_hi:[1,0] neg_lo:[0,1] neg_hi:[0,1]
    v_exp_f32 v92, v92
    v_exp_f32 v93, v93
    v_exp_f32 v94, v94
    v_exp_f32 v95, v95
    v_cvt_pk_bf16_f32 v92, v92, v93
    v_cvt_pk_bf16_f32 v93, v94, v95
    v_mov_b32 v94, 0
    v_mov_b32 v95, 0
    v_pk_add_f32 v[164:165], v[164:165], v[210:211] op_sel_hi:[1,0] neg_lo:[0,1] neg_hi:[0,1]
    v_pk_add_f32 v[166:167], v[166:167], v[210:211] op_sel_hi:[1,0] neg_lo:[0,1] neg_hi:[0,1]
    v_exp_f32 v164, v164
    v_exp_f32 v165, v165
    v_exp_f32 v166, v166
    v_exp_f32 v167, v167
    v_pk_add_f32 v[168:169], v[168:169], v[210:211] op_sel_hi:[1,0] neg_lo:[0,1] neg_hi:[0,1]
    v_pk_add_f32 v[170:171], v[170:171], v[210:211] op_sel_hi:[1,0] neg_lo:[0,1] neg_hi:[0,1]
    v_exp_f32 v168, v168
    v_exp_f32 v169, v169
    v_exp_f32 v170, v170
    v_exp_f32 v171, v171
    v_cvt_pk_bf16_f32 v164, v164, v165
    v_cvt_pk_bf16_f32 v165, v166, v167
    v_cvt_pk_bf16_f32 v166, v168, v169
    v_cvt_pk_bf16_f32 v167, v170, v171
    s_waitcnt lgkmcnt(0)
    v_mfma_f32_16x16x32_bf16 v[212:215], v[192:195], v[92:95], v[212:215]
    v_mfma_f32_16x16x32_bf16 v[216:219], v[196:199], v[92:95], v[216:219]
    v_mfma_f32_16x16x32_bf16 v[220:223], v[192:195], v[164:167], v[220:223]
    v_mfma_f32_16x16x32_bf16 v[224:227], v[196:199], v[164:167], v[224:227]
    s_nop 5
    v_mov_b32 v1, v216
    v_mov_b32 v4, v216
    s_nop 1
    v_permlane16_swap_b32 v1, v4
    v_rcp_f32 v5, v4
    s_nop 0
    v_mul_f32 v212, v212, v5
    v_mul_f32 v216, v216, v5
    v_mul_f32 v213, v213, v5
    v_mul_f32 v217, v217, v5
    v_mul_f32 v214, v214, v5
    v_mul_f32 v218, v218, v5
    v_mul_f32 v215, v215, v5
    v_mul_f32 v219, v219, v5
    v_cvt_pk_bf16_f32 v228, v212, v213
    v_cvt_pk_bf16_f32 v229, v214, v215
    v_cvt_pk_bf16_f32 v232, v216, v217
    v_cvt_pk_bf16_f32 v233, v218, v219
    v_mov_b32 v1, v224
    v_mov_b32 v4, v224
    s_nop 1
    v_permlane16_swap_b32 v1, v4
    v_rcp_f32 v5, v4
    s_nop 0
    v_mul_f32 v220, v220, v5
    v_mul_f32 v224, v224, v5
    v_mul_f32 v221, v221, v5
    v_mul_f32 v225, v225, v5
    v_mul_f32 v222, v222, v5
    v_mul_f32 v226, v226, v5
    v_mul_f32 v223, v223, v5
    v_mul_f32 v227, v227, v5
    v_cvt_pk_bf16_f32 v236, v220, v221
    v_cvt_pk_bf16_f32 v237, v222, v223
    v_cvt_pk_bf16_f32 v240, v224, v225
    v_cvt_pk_bf16_f32 v241, v226, v227
    ds_read_b64 v[172:173], v24 offset:30720
    ds_read_b64 v[174:175], v24 offset:30848
    ds_read_b64 v[176:177], v24 offset:31360
    ds_read_b64 v[178:179], v24 offset:31488
    ds_read_b64 v[180:181], v24 offset:32000
    ds_read_b64 v[182:183], v24 offset:32128
    ds_read_b64 v[184:185], v24 offset:32640
    ds_read_b64 v[186:187], v24 offset:32768
    s_cmp_ge_u32 s50, 8
    s_cselect_b32 s51, 0, 0xf149f2ca
    v_mov_b32 v188, s51
    v_mov_b32 v189, s51
    v_mov_b32 v190, s51
    v_mov_b32 v191, s51
    s_waitcnt lgkmcnt(6)
    s_nop 0
    v_mfma_f32_16x16x32_bf16 v[28:31], v[172:175], v[16:19], v[188:191]
    ds_read_b64 v[172:173], v24 offset:33280
    ds_read_b64 v[174:175], v24 offset:33408
    s_waitcnt lgkmcnt(6)
    v_mfma_f32_16x16x32_bf16 v[32:35], v[176:179], v[16:19], v[188:191]
    v_mfma_f32_16x16x32_bf16 v[104:107], v[176:179], v[20:23], v[188:191]
    ds_read_b64 v[176:177], v24 offset:33920
    ds_read_b64 v[178:179], v24 offset:34048
    s_cmp_ge_u32 s50, 7
    s_cselect_b32 s51, 0, 0xf149f2ca
    v_mov_b32 v188, s51
    v_mov_b32 v189, s51
    v_mov_b32 v190, s51
    v_mov_b32 v191, s51
    s_waitcnt lgkmcnt(6)
    s_nop 0
    v_mfma_f32_16x16x32_bf16 v[36:39], v[180:183], v[16:19], v[188:191]
    v_mfma_f32_16x16x32_bf16 v[108:111], v[180:183], v[20:23], v[188:191]
    ds_read_b64 v[180:181], v24 offset:34560
    ds_read_b64 v[182:183], v24 offset:34688
    s_waitcnt lgkmcnt(6)
    v_mfma_f32_16x16x32_bf16 v[40:43], v[184:187], v[16:19], v[188:191]
    v_mfma_f32_16x16x32_bf16 v[112:115], v[184:187], v[20:23], v[188:191]
    ds_read_b64 v[184:185], v24 offset:35200
    ds_read_b64 v[186:187], v24 offset:35328
    s_cmp_ge_u32 s50, 6
    s_cselect_b32 s51, 0, 0xf149f2ca
    v_mov_b32 v188, s51
    v_mov_b32 v189, s51
    v_mov_b32 v190, s51
    v_mov_b32 v191, s51
    s_waitcnt lgkmcnt(6)
    s_nop 0
    v_mfma_f32_16x16x32_bf16 v[44:47], v[172:175], v[16:19], v[188:191]
    v_mfma_f32_16x16x32_bf16 v[116:119], v[172:175], v[20:23], v[188:191]
    ds_read_b64 v[172:173], v24 offset:35840
    ds_read_b64 v[174:175], v24 offset:35968
    s_waitcnt lgkmcnt(6)
    v_mfma_f32_16x16x32_bf16 v[48:51], v[176:179], v[16:19], v[188:191]
    v_mfma_f32_16x16x32_bf16 v[120:123], v[176:179], v[20:23], v[188:191]
    ds_read_b64 v[176:177], v24 offset:36480
    ds_read_b64 v[178:179], v24 offset:36608
    s_cmp_ge_u32 s50, 5
    s_cselect_b32 s51, 0, 0xf149f2ca
    v_mov_b32 v188, s51
    v_mov_b32 v189, s51
    v_mov_b32 v190, s51
    v_mov_b32 v191, s51
    s_waitcnt lgkmcnt(6)
    s_nop 0
    v_mfma_f32_16x16x32_bf16 v[52:55], v[180:183], v[16:19], v[188:191]
    v_mfma_f32_16x16x32_bf16 v[124:127], v[180:183], v[20:23], v[188:191]
    ds_read_b64 v[180:181], v24 offset:37120
    ds_read_b64 v[182:183], v24 offset:37248
    s_waitcnt lgkmcnt(6)
    v_mfma_f32_16x16x32_bf16 v[56:59], v[184:187], v[16:19], v[188:191]
    v_mfma_f32_16x16x32_bf16 v[128:131], v[184:187], v[20:23], v[188:191]
    ds_read_b64 v[184:185], v24 offset:37760
    ds_read_b64 v[186:187], v24 offset:37888
    s_cmp_ge_u32 s50, 4
    s_cselect_b32 s51, 0, 0xf149f2ca
    v_mov_b32 v188, s51
    v_mov_b32 v189, s51
    v_mov_b32 v190, s51
    v_mov_b32 v191, s51
    s_waitcnt lgkmcnt(6)
    s_nop 0
    v_mfma_f32_16x16x32_bf16 v[60:63], v[172:175], v[16:19], v[188:191]
    v_mfma_f32_16x16x32_bf16 v[132:135], v[172:175], v[20:23], v[188:191]
    ds_read_b64 v[172:173], v24 offset:38400
    ds_read_b64 v[174:175], v24 offset:38528
    s_waitcnt lgkmcnt(6)
    v_mfma_f32_16x16x32_bf16 v[64:67], v[176:179], v[16:19], v[188:191]
    v_mfma_f32_16x16x32_bf16 v[136:139], v[176:179], v[20:23], v[188:191]
    ds_read_b64 v[176:177], v24 offset:39040
    ds_read_b64 v[178:179], v24 offset:39168
    s_cmp_ge_u32 s50, 3
    s_cselect_b32 s51, 0, 0xf149f2ca
    v_mov_b32 v188, s51
    v_mov_b32 v189, s51
    v_mov_b32 v190, s51
    v_mov_b32 v191, s51
    s_waitcnt lgkmcnt(6)
    s_nop 0
    v_mfma_f32_16x16x32_bf16 v[68:71], v[180:183], v[16:19], v[188:191]
    v_mfma_f32_16x16x32_bf16 v[140:143], v[180:183], v[20:23], v[188:191]
    ds_read_b64 v[180:181], v24 offset:39680
    ds_read_b64 v[182:183], v24 offset:39808
    s_waitcnt lgkmcnt(6)
    v_mfma_f32_16x16x32_bf16 v[72:75], v[184:187], v[16:19], v[188:191]
    v_mfma_f32_16x16x32_bf16 v[144:147], v[184:187], v[20:23], v[188:191]
    ds_read_b64 v[184:185], v24 offset:40320
    ds_read_b64 v[186:187], v24 offset:40448
    s_cmp_ge_u32 s50, 2
    s_cselect_b32 s51, 0, 0xf149f2ca
    v_mov_b32 v188, s51
    v_mov_b32 v189, s51
    v_mov_b32 v190, s51
    v_mov_b32 v191, s51
    s_waitcnt lgkmcnt(6)
    s_nop 0
    v_mfma_f32_16x16x32_bf16 v[76:79], v[172:175], v[16:19], v[188:191]
    v_mfma_f32_16x16x32_bf16 v[148:151], v[172:175], v[20:23], v[188:191]
    ds_read_b64 v[172:173], v24 offset:40960
    ds_read_b64 v[174:175], v24 offset:41088
    s_waitcnt lgkmcnt(6)
    v_mfma_f32_16x16x32_bf16 v[80:83], v[176:179], v[16:19], v[188:191]
    v_mfma_f32_16x16x32_bf16 v[152:155], v[176:179], v[20:23], v[188:191]
    ds_read_b64 v[176:177], v24 offset:41600
    ds_read_b64 v[178:179], v24 offset:41728
    s_cmp_ge_u32 s50, 1
    s_cselect_b32 s51, 0, 0xf149f2ca
    v_mov_b32 v188, s51
    v_mov_b32 v189, s51
    v_mov_b32 v190, s51
    v_mov_b32 v191, s51
    s_waitcnt lgkmcnt(6)
    s_nop 0
    v_mfma_f32_16x16x32_bf16 v[84:87], v[180:183], v[16:19], v[188:191]
    v_mfma_f32_16x16x32_bf16 v[156:159], v[180:183], v[20:23], v[188:191]
    s_waitcnt lgkmcnt(4)
    v_mfma_f32_16x16x32_bf16 v[88:91], v[184:187], v[16:19], v[188:191]
    v_mfma_f32_16x16x32_bf16 v[160:163], v[184:187], v[20:23], v[188:191]
    s_cmp_ge_u32 s50, 0
    s_cselect_b32 s51, 0, 0xf149f2ca
    s_nop 0
    v_mov_b32 v188, s51
    v_mov_b32 v189, s51
    v_mov_b32 v190, s51
    v_mov_b32 v191, s51
    s_waitcnt lgkmcnt(2)
    s_nop 0
    v_mfma_f32_16x16x32_bf16 v[92:95], v[172:175], v[16:19], v[188:191]
    v_mfma_f32_16x16x32_bf16 v[164:167], v[172:175], v[20:23], v[188:191]
    s_waitcnt lgkmcnt(0)
    v_mfma_f32_16x16x32_bf16 v[168:171], v[176:179], v[20:23], v[188:191]
    ds_read_b128 v[192:195], v25 offset:30720
    s_mov_b64 exec, s[70:71]
    ds_read_b128 v[196:199], v26 offset:30720
    s_mov_b64 exec, -1
    v_cndmask_b32 v28, v28, v27, s[60:61]
    v_cndmask_b32 v92, v27, v92, s[60:61]
    v_cndmask_b32 v29, v29, v27, s[62:63]
    v_cndmask_b32 v93, v27, v93, s[62:63]
    v_cndmask_b32 v30, v30, v27, s[64:65]
    v_cndmask_b32 v94, v27, v94, s[64:65]
    v_cndmask_b32 v31, v31, v27, s[66:67]
    v_cndmask_b32 v95, v27, v95, s[66:67]
    v_max3_f32 v208, v28, v29, v30
    v_max3_f32 v1, v31, v32, v33
    v_max3_f32 v208, v208, v34, v35
    v_max3_f32 v1, v1, v36, v37
    v_max3_f32 v208, v208, v38, v39
    v_max3_f32 v1, v1, v40, v41
    v_max3_f32 v208, v208, v42, v43
    v_max3_f32 v1, v1, v44, v45
    v_max3_f32 v208, v208, v46, v47
    v_max3_f32 v1, v1, v48, v49
    v_max3_f32 v208, v208, v50, v51
    v_max3_f32 v1, v1, v52, v53
    v_max3_f32 v208, v208, v54, v55
    v_max3_f32 v1, v1, v56, v57
    v_max3_f32 v208, v208, v58, v59
    v_max3_f32 v1, v1, v60, v61
    v_max3_f32 v208, v208, v62, v63
    v_max3_f32 v1, v1, v64, v65
    v_max3_f32 v208, v208, v66, v67
    v_max3_f32 v1, v1, v68, v69
    v_max3_f32 v208, v208, v70, v71
    v_max3_f32 v1, v1, v72, v73
    v_max3_f32 v208, v208, v74, v75
    v_max3_f32 v1, v1, v76, v77
    v_max3_f32 v208, v208, v78, v79
    v_max3_f32 v1, v1, v80, v81
    v_max3_f32 v208, v208, v82, v83
    v_max3_f32 v1, v1, v84, v85
    v_max3_f32 v208, v208, v86, v87
    v_max3_f32 v1, v1, v88, v89
    v_max3_f32 v208, v208, v90, v91
    v_max3_f32 v1, v1, v92, v93
    v_max3_f32 v208, v208, v94, v95
    v_max_f32 v208, v208, v1
    v_mov_b32 v1, v208
    s_nop 1
    v_permlane32_swap_b32 v1, v208
    v_max_f32 v208, v208, v1
    v_mov_b32 v1, v208
    s_nop 1
    v_permlane16_swap_b32 v1, v208
    v_max_f32 v208, v208, v1
    v_cndmask_b32 v104, v104, v27, s[60:61]
    v_cndmask_b32 v168, v27, v168, s[60:61]
    v_cndmask_b32 v105, v105, v27, s[62:63]
    v_cndmask_b32 v169, v27, v169, s[62:63]
    v_cndmask_b32 v106, v106, v27, s[64:65]
    v_cndmask_b32 v170, v27, v170, s[64:65]
    v_cndmask_b32 v107, v107, v27, s[66:67]
    v_cndmask_b32 v171, v27, v171, s[66:67]
    v_max3_f32 v210, v104, v105, v106
    v_max3_f32 v1, v107, v108, v109
    v_max3_f32 v210, v210, v110, v111
    v_max3_f32 v1, v1, v112, v113
    v_max3_f32 v210, v210, v114, v115
    v_max3_f32 v1, v1, v116, v117
    v_max3_f32 v210, v210, v118, v119
    v_max3_f32 v1, v1, v120, v121
    v_max3_f32 v210, v210, v122, v123
    v_max3_f32 v1, v1, v124, v125
    v_max3_f32 v210, v210, v126, v127
    v_max3_f32 v1, v1, v128, v129
    v_max3_f32 v210, v210, v130, v131
    v_max3_f32 v1, v1, v132, v133
    v_max3_f32 v210, v210, v134, v135
    v_max3_f32 v1, v1, v136, v137
    v_max3_f32 v210, v210, v138, v139
    v_max3_f32 v1, v1, v140, v141
    v_max3_f32 v210, v210, v142, v143
    v_max3_f32 v1, v1, v144, v145
    v_max3_f32 v210, v210, v146, v147
    v_max3_f32 v1, v1, v148, v149
    v_max3_f32 v210, v210, v150, v151
    v_max3_f32 v1, v1, v152, v153
    v_max3_f32 v210, v210, v154, v155
    v_max3_f32 v1, v1, v156, v157
    v_max3_f32 v210, v210, v158, v159
    v_max3_f32 v1, v1, v160, v161
    v_max3_f32 v210, v210, v162, v163
    v_max3_f32 v1, v1, v164, v165
    v_max3_f32 v210, v210, v166, v167
    v_max3_f32 v1, v1, v168, v169
    v_max3_f32 v210, v210, v170, v171
    v_max_f32 v210, v210, v1
    v_mov_b32 v1, v210
    s_nop 1
    v_permlane32_swap_b32 v1, v210
    v_max_f32 v210, v210, v1
    v_mov_b32 v1, v210
    s_nop 1
    v_permlane16_swap_b32 v1, v210
    v_max_f32 v210, v210, v1
    v_pk_add_f32 v[28:29], v[28:29], v[208:209] op_sel_hi:[1,0] neg_lo:[0,1] neg_hi:[0,1]
    v_pk_add_f32 v[30:31], v[30:31], v[208:209] op_sel_hi:[1,0] neg_lo:[0,1] neg_hi:[0,1]
    v_exp_f32 v28, v28
    v_exp_f32 v29, v29
    v_exp_f32 v30, v30
    v_exp_f32 v31, v31
    v_pk_add_f32 v[32:33], v[32:33], v[208:209] op_sel_hi:[1,0] neg_lo:[0,1] neg_hi:[0,1]
    v_pk_add_f32 v[34:35], v[34:35], v[208:209] op_sel_hi:[1,0] neg_lo:[0,1] neg_hi:[0,1]
    v_exp_f32 v32, v32
    v_exp_f32 v33, v33
    v_exp_f32 v34, v34
    v_exp_f32 v35, v35
    v_cvt_pk_bf16_f32 v28, v28, v29
    v_cvt_pk_bf16_f32 v29, v30, v31
    v_cvt_pk_bf16_f32 v30, v32, v33
    v_cvt_pk_bf16_f32 v31, v34, v35
    v_pk_add_f32 v[104:105], v[104:105], v[210:211] op_sel_hi:[1,0] neg_lo:[0,1] neg_hi:[0,1]
    v_pk_add_f32 v[106:107], v[106:107], v[210:211] op_sel_hi:[1,0] neg_lo:[0,1] neg_hi:[0,1]
    v_exp_f32 v104, v104
    v_exp_f32 v105, v105
    v_exp_f32 v106, v106
    v_exp_f32 v107, v107
    v_mov_b32 v100, 0
    v_mov_b32 v101, 0
    v_cvt_pk_bf16_f32 v102, v104, v105
    v_cvt_pk_bf16_f32 v103, v106, v107
    ds_read_b128 v[200:203], v25 offset:32000
    s_mov_b64 exec, s[70:71]
    ds_read_b128 v[204:207], v26 offset:32000
    s_mov_b64 exec, -1
    s_waitcnt lgkmcnt(2)
    v_mfma_f32_16x16x32_bf16 v[212:215], v[192:195], v[28:31], 0
    v_mfma_f32_16x16x32_bf16 v[216:219], v[196:199], v[28:31], 0
    v_mfma_f32_16x16x32_bf16 v[220:223], v[192:195], v[100:103], 0
    v_mfma_f32_16x16x32_bf16 v[224:227], v[196:199], v[100:103], 0
    v_pk_add_f32 v[36:37], v[36:37], v[208:209] op_sel_hi:[1,0] neg_lo:[0,1] neg_hi:[0,1]
    v_pk_add_f32 v[38:39], v[38:39], v[208:209] op_sel_hi:[1,0] neg_lo:[0,1] neg_hi:[0,1]
    v_exp_f32 v36, v36
    v_exp_f32 v37, v37
    v_exp_f32 v38, v38
    v_exp_f32 v39, v39
    v_pk_add_f32 v[40:41], v[40:41], v[208:209] op_sel_hi:[1,0] neg_lo:[0,1] neg_hi:[0,1]
    v_pk_add_f32 v[42:43], v[42:43], v[208:209] op_sel_hi:[1,0] neg_lo:[0,1] neg_hi:[0,1]
    v_exp_f32 v40, v40
    v_exp_f32 v41, v41
    v_exp_f32 v42, v42
    v_exp_f32 v43, v43
    v_cvt_pk_bf16_f32 v36, v36, v37
    v_cvt_pk_bf16_f32 v37, v38, v39
    v_cvt_pk_bf16_f32 v38, v40, v41
    v_cvt_pk_bf16_f32 v39, v42, v43
    v_pk_add_f32 v[108:109], v[108:109], v[210:211] op_sel_hi:[1,0] neg_lo:[0,1] neg_hi:[0,1]
    v_pk_add_f32 v[110:111], v[110:111], v[210:211] op_sel_hi:[1,0] neg_lo:[0,1] neg_hi:[0,1]
    v_exp_f32 v108, v108
    v_exp_f32 v109, v109
    v_exp_f32 v110, v110
    v_exp_f32 v111, v111
    v_pk_add_f32 v[112:113], v[112:113], v[210:211] op_sel_hi:[1,0] neg_lo:[0,1] neg_hi:[0,1]
    v_pk_add_f32 v[114:115], v[114:115], v[210:211] op_sel_hi:[1,0] neg_lo:[0,1] neg_hi:[0,1]
    v_exp_f32 v112, v112
    v_exp_f32 v113, v113
    v_exp_f32 v114, v114
    v_exp_f32 v115, v115
    v_cvt_pk_bf16_f32 v108, v108, v109
    v_cvt_pk_bf16_f32 v109, v110, v111
    v_cvt_pk_bf16_f32 v110, v112, v113
    v_cvt_pk_bf16_f32 v111, v114, v115
    ds_read_b128 v[192:195], v25 offset:33280
    s_mov_b64 exec, s[70:71]
    ds_read_b128 v[196:199], v26 offset:33280
    s_mov_b64 exec, -1
    s_waitcnt lgkmcnt(2)
    v_mfma_f32_16x16x32_bf16 v[212:215], v[200:203], v[36:39], v[212:215]
    v_mfma_f32_16x16x32_bf16 v[216:219], v[204:207], v[36:39], v[216:219]
    v_mfma_f32_16x16x32_bf16 v[220:223], v[200:203], v[108:111], v[220:223]
    v_mfma_f32_16x16x32_bf16 v[224:227], v[204:207], v[108:111], v[224:227]
    v_pk_add_f32 v[44:45], v[44:45], v[208:209] op_sel_hi:[1,0] neg_lo:[0,1] neg_hi:[0,1]
    v_pk_add_f32 v[46:47], v[46:47], v[208:209] op_sel_hi:[1,0] neg_lo:[0,1] neg_hi:[0,1]
    v_exp_f32 v44, v44
    v_exp_f32 v45, v45
    v_exp_f32 v46, v46
    v_exp_f32 v47, v47
    v_pk_add_f32 v[48:49], v[48:49], v[208:209] op_sel_hi:[1,0] neg_lo:[0,1] neg_hi:[0,1]
    v_pk_add_f32 v[50:51], v[50:51], v[208:209] op_sel_hi:[1,0] neg_lo:[0,1] neg_hi:[0,1]
    v_exp_f32 v48, v48
    v_exp_f32 v49, v49
    v_exp_f32 v50, v50
    v_exp_f32 v51, v51
    v_cvt_pk_bf16_f32 v44, v44, v45
    v_cvt_pk_bf16_f32 v45, v46, v47
    v_cvt_pk_bf16_f32 v46, v48, v49
    v_cvt_pk_bf16_f32 v47, v50, v51
    v_pk_add_f32 v[116:117], v[116:117], v[210:211] op_sel_hi:[1,0] neg_lo:[0,1] neg_hi:[0,1]
    v_pk_add_f32 v[118:119], v[118:119], v[210:211] op_sel_hi:[1,0] neg_lo:[0,1] neg_hi:[0,1]
    v_exp_f32 v116, v116
    v_exp_f32 v117, v117
    v_exp_f32 v118, v118
    v_exp_f32 v119, v119
    v_pk_add_f32 v[120:121], v[120:121], v[210:211] op_sel_hi:[1,0] neg_lo:[0,1] neg_hi:[0,1]
    v_pk_add_f32 v[122:123], v[122:123], v[210:211] op_sel_hi:[1,0] neg_lo:[0,1] neg_hi:[0,1]
    v_exp_f32 v120, v120
    v_exp_f32 v121, v121
    v_exp_f32 v122, v122
    v_exp_f32 v123, v123
    v_cvt_pk_bf16_f32 v116, v116, v117
    v_cvt_pk_bf16_f32 v117, v118, v119
    v_cvt_pk_bf16_f32 v118, v120, v121
    v_cvt_pk_bf16_f32 v119, v122, v123
    ds_read_b128 v[200:203], v25 offset:34560
    s_mov_b64 exec, s[70:71]
    ds_read_b128 v[204:207], v26 offset:34560
    s_mov_b64 exec, -1
    s_waitcnt lgkmcnt(2)
    v_mfma_f32_16x16x32_bf16 v[212:215], v[192:195], v[44:47], v[212:215]
    v_mfma_f32_16x16x32_bf16 v[216:219], v[196:199], v[44:47], v[216:219]
    v_mfma_f32_16x16x32_bf16 v[220:223], v[192:195], v[116:119], v[220:223]
    v_mfma_f32_16x16x32_bf16 v[224:227], v[196:199], v[116:119], v[224:227]
    v_pk_add_f32 v[52:53], v[52:53], v[208:209] op_sel_hi:[1,0] neg_lo:[0,1] neg_hi:[0,1]
    v_pk_add_f32 v[54:55], v[54:55], v[208:209] op_sel_hi:[1,0] neg_lo:[0,1] neg_hi:[0,1]
    v_exp_f32 v52, v52
    v_exp_f32 v53, v53
    v_exp_f32 v54, v54
    v_exp_f32 v55, v55
    v_pk_add_f32 v[56:57], v[56:57], v[208:209] op_sel_hi:[1,0] neg_lo:[0,1] neg_hi:[0,1]
    v_pk_add_f32 v[58:59], v[58:59], v[208:209] op_sel_hi:[1,0] neg_lo:[0,1] neg_hi:[0,1]
    v_exp_f32 v56, v56
    v_exp_f32 v57, v57
    v_exp_f32 v58, v58
    v_exp_f32 v59, v59
    v_cvt_pk_bf16_f32 v52, v52, v53
    v_cvt_pk_bf16_f32 v53, v54, v55
    v_cvt_pk_bf16_f32 v54, v56, v57
    v_cvt_pk_bf16_f32 v55, v58, v59
    v_pk_add_f32 v[124:125], v[124:125], v[210:211] op_sel_hi:[1,0] neg_lo:[0,1] neg_hi:[0,1]
    v_pk_add_f32 v[126:127], v[126:127], v[210:211] op_sel_hi:[1,0] neg_lo:[0,1] neg_hi:[0,1]
    v_exp_f32 v124, v124
    v_exp_f32 v125, v125
    v_exp_f32 v126, v126
    v_exp_f32 v127, v127
    v_pk_add_f32 v[128:129], v[128:129], v[210:211] op_sel_hi:[1,0] neg_lo:[0,1] neg_hi:[0,1]
    v_pk_add_f32 v[130:131], v[130:131], v[210:211] op_sel_hi:[1,0] neg_lo:[0,1] neg_hi:[0,1]
    v_exp_f32 v128, v128
    v_exp_f32 v129, v129
    v_exp_f32 v130, v130
    v_exp_f32 v131, v131
    v_cvt_pk_bf16_f32 v124, v124, v125
    v_cvt_pk_bf16_f32 v125, v126, v127
    v_cvt_pk_bf16_f32 v126, v128, v129
    v_cvt_pk_bf16_f32 v127, v130, v131
    ds_read_b128 v[192:195], v25 offset:35840
    s_mov_b64 exec, s[70:71]
    ds_read_b128 v[196:199], v26 offset:35840
    s_mov_b64 exec, -1
    s_waitcnt lgkmcnt(2)
    v_mfma_f32_16x16x32_bf16 v[212:215], v[200:203], v[52:55], v[212:215]
    v_mfma_f32_16x16x32_bf16 v[216:219], v[204:207], v[52:55], v[216:219]
    v_mfma_f32_16x16x32_bf16 v[220:223], v[200:203], v[124:127], v[220:223]
    v_mfma_f32_16x16x32_bf16 v[224:227], v[204:207], v[124:127], v[224:227]
    v_pk_add_f32 v[60:61], v[60:61], v[208:209] op_sel_hi:[1,0] neg_lo:[0,1] neg_hi:[0,1]
    v_pk_add_f32 v[62:63], v[62:63], v[208:209] op_sel_hi:[1,0] neg_lo:[0,1] neg_hi:[0,1]
    v_exp_f32 v60, v60
    v_exp_f32 v61, v61
    v_exp_f32 v62, v62
    v_exp_f32 v63, v63
    v_pk_add_f32 v[64:65], v[64:65], v[208:209] op_sel_hi:[1,0] neg_lo:[0,1] neg_hi:[0,1]
    v_pk_add_f32 v[66:67], v[66:67], v[208:209] op_sel_hi:[1,0] neg_lo:[0,1] neg_hi:[0,1]
    v_exp_f32 v64, v64
    v_exp_f32 v65, v65
    v_exp_f32 v66, v66
    v_exp_f32 v67, v67
    v_cvt_pk_bf16_f32 v60, v60, v61
    v_cvt_pk_bf16_f32 v61, v62, v63
    v_cvt_pk_bf16_f32 v62, v64, v65
    v_cvt_pk_bf16_f32 v63, v66, v67
    v_pk_add_f32 v[132:133], v[132:133], v[210:211] op_sel_hi:[1,0] neg_lo:[0,1] neg_hi:[0,1]
    v_pk_add_f32 v[134:135], v[134:135], v[210:211] op_sel_hi:[1,0] neg_lo:[0,1] neg_hi:[0,1]
    v_exp_f32 v132, v132
    v_exp_f32 v133, v133
    v_exp_f32 v134, v134
    v_exp_f32 v135, v135
    v_pk_add_f32 v[136:137], v[136:137], v[210:211] op_sel_hi:[1,0] neg_lo:[0,1] neg_hi:[0,1]
    v_pk_add_f32 v[138:139], v[138:139], v[210:211] op_sel_hi:[1,0] neg_lo:[0,1] neg_hi:[0,1]
    v_exp_f32 v136, v136
    v_exp_f32 v137, v137
    v_exp_f32 v138, v138
    v_exp_f32 v139, v139
    v_cvt_pk_bf16_f32 v132, v132, v133
    v_cvt_pk_bf16_f32 v133, v134, v135
    v_cvt_pk_bf16_f32 v134, v136, v137
    v_cvt_pk_bf16_f32 v135, v138, v139
    ds_read_b128 v[200:203], v25 offset:37120
    s_mov_b64 exec, s[70:71]
    ds_read_b128 v[204:207], v26 offset:37120
    s_mov_b64 exec, -1
    s_waitcnt lgkmcnt(2)
    v_mfma_f32_16x16x32_bf16 v[212:215], v[192:195], v[60:63], v[212:215]
    v_mfma_f32_16x16x32_bf16 v[216:219], v[196:199], v[60:63], v[216:219]
    v_mfma_f32_16x16x32_bf16 v[220:223], v[192:195], v[132:135], v[220:223]
    v_mfma_f32_16x16x32_bf16 v[224:227], v[196:199], v[132:135], v[224:227]
    v_pk_add_f32 v[68:69], v[68:69], v[208:209] op_sel_hi:[1,0] neg_lo:[0,1] neg_hi:[0,1]
    v_pk_add_f32 v[70:71], v[70:71], v[208:209] op_sel_hi:[1,0] neg_lo:[0,1] neg_hi:[0,1]
    v_exp_f32 v68, v68
    v_exp_f32 v69, v69
    v_exp_f32 v70, v70
    v_exp_f32 v71, v71
    v_pk_add_f32 v[72:73], v[72:73], v[208:209] op_sel_hi:[1,0] neg_lo:[0,1] neg_hi:[0,1]
    v_pk_add_f32 v[74:75], v[74:75], v[208:209] op_sel_hi:[1,0] neg_lo:[0,1] neg_hi:[0,1]
    v_exp_f32 v72, v72
    v_exp_f32 v73, v73
    v_exp_f32 v74, v74
    v_exp_f32 v75, v75
    v_cvt_pk_bf16_f32 v68, v68, v69
    v_cvt_pk_bf16_f32 v69, v70, v71
    v_cvt_pk_bf16_f32 v70, v72, v73
    v_cvt_pk_bf16_f32 v71, v74, v75
    v_pk_add_f32 v[140:141], v[140:141], v[210:211] op_sel_hi:[1,0] neg_lo:[0,1] neg_hi:[0,1]
    v_pk_add_f32 v[142:143], v[142:143], v[210:211] op_sel_hi:[1,0] neg_lo:[0,1] neg_hi:[0,1]
    v_exp_f32 v140, v140
    v_exp_f32 v141, v141
    v_exp_f32 v142, v142
    v_exp_f32 v143, v143
    v_pk_add_f32 v[144:145], v[144:145], v[210:211] op_sel_hi:[1,0] neg_lo:[0,1] neg_hi:[0,1]
    v_pk_add_f32 v[146:147], v[146:147], v[210:211] op_sel_hi:[1,0] neg_lo:[0,1] neg_hi:[0,1]
    v_exp_f32 v144, v144
    v_exp_f32 v145, v145
    v_exp_f32 v146, v146
    v_exp_f32 v147, v147
    v_cvt_pk_bf16_f32 v140, v140, v141
    v_cvt_pk_bf16_f32 v141, v142, v143
    v_cvt_pk_bf16_f32 v142, v144, v145
    v_cvt_pk_bf16_f32 v143, v146, v147
    ds_read_b128 v[192:195], v25 offset:38400
    s_mov_b64 exec, s[70:71]
    ds_read_b128 v[196:199], v26 offset:38400
    s_mov_b64 exec, -1
    s_waitcnt lgkmcnt(2)
    v_mfma_f32_16x16x32_bf16 v[212:215], v[200:203], v[68:71], v[212:215]
    v_mfma_f32_16x16x32_bf16 v[216:219], v[204:207], v[68:71], v[216:219]
    v_mfma_f32_16x16x32_bf16 v[220:223], v[200:203], v[140:143], v[220:223]
    v_mfma_f32_16x16x32_bf16 v[224:227], v[204:207], v[140:143], v[224:227]
    v_pk_add_f32 v[76:77], v[76:77], v[208:209] op_sel_hi:[1,0] neg_lo:[0,1] neg_hi:[0,1]
    v_pk_add_f32 v[78:79], v[78:79], v[208:209] op_sel_hi:[1,0] neg_lo:[0,1] neg_hi:[0,1]
    v_exp_f32 v76, v76
    v_exp_f32 v77, v77
    v_exp_f32 v78, v78
    v_exp_f32 v79, v79
    v_pk_add_f32 v[80:81], v[80:81], v[208:209] op_sel_hi:[1,0] neg_lo:[0,1] neg_hi:[0,1]
    v_pk_add_f32 v[82:83], v[82:83], v[208:209] op_sel_hi:[1,0] neg_lo:[0,1] neg_hi:[0,1]
    v_exp_f32 v80, v80
    v_exp_f32 v81, v81
    v_exp_f32 v82, v82
    v_exp_f32 v83, v83
    v_cvt_pk_bf16_f32 v76, v76, v77
    v_cvt_pk_bf16_f32 v77, v78, v79
    v_cvt_pk_bf16_f32 v78, v80, v81
    v_cvt_pk_bf16_f32 v79, v82, v83
    v_pk_add_f32 v[148:149], v[148:149], v[210:211] op_sel_hi:[1,0] neg_lo:[0,1] neg_hi:[0,1]
    v_pk_add_f32 v[150:151], v[150:151], v[210:211] op_sel_hi:[1,0] neg_lo:[0,1] neg_hi:[0,1]
    v_exp_f32 v148, v148
    v_exp_f32 v149, v149
    v_exp_f32 v150, v150
    v_exp_f32 v151, v151
    v_pk_add_f32 v[152:153], v[152:153], v[210:211] op_sel_hi:[1,0] neg_lo:[0,1] neg_hi:[0,1]
    v_pk_add_f32 v[154:155], v[154:155], v[210:211] op_sel_hi:[1,0] neg_lo:[0,1] neg_hi:[0,1]
    v_exp_f32 v152, v152
    v_exp_f32 v153, v153
    v_exp_f32 v154, v154
    v_exp_f32 v155, v155
    v_cvt_pk_bf16_f32 v148, v148, v149
    v_cvt_pk_bf16_f32 v149, v150, v151
    v_cvt_pk_bf16_f32 v150, v152, v153
    v_cvt_pk_bf16_f32 v151, v154, v155
    ds_read_b128 v[200:203], v25 offset:39680
    s_mov_b64 exec, s[70:71]
    ds_read_b128 v[204:207], v26 offset:39680
    s_mov_b64 exec, -1
    s_waitcnt lgkmcnt(2)
    v_mfma_f32_16x16x32_bf16 v[212:215], v[192:195], v[76:79], v[212:215]
    v_mfma_f32_16x16x32_bf16 v[216:219], v[196:199], v[76:79], v[216:219]
    v_mfma_f32_16x16x32_bf16 v[220:223], v[192:195], v[148:151], v[220:223]
    v_mfma_f32_16x16x32_bf16 v[224:227], v[196:199], v[148:151], v[224:227]
    v_pk_add_f32 v[84:85], v[84:85], v[208:209] op_sel_hi:[1,0] neg_lo:[0,1] neg_hi:[0,1]
    v_pk_add_f32 v[86:87], v[86:87], v[208:209] op_sel_hi:[1,0] neg_lo:[0,1] neg_hi:[0,1]
    v_exp_f32 v84, v84
    v_exp_f32 v85, v85
    v_exp_f32 v86, v86
    v_exp_f32 v87, v87
    v_pk_add_f32 v[88:89], v[88:89], v[208:209] op_sel_hi:[1,0] neg_lo:[0,1] neg_hi:[0,1]
    v_pk_add_f32 v[90:91], v[90:91], v[208:209] op_sel_hi:[1,0] neg_lo:[0,1] neg_hi:[0,1]
    v_exp_f32 v88, v88
    v_exp_f32 v89, v89
    v_exp_f32 v90, v90
    v_exp_f32 v91, v91
    v_cvt_pk_bf16_f32 v84, v84, v85
    v_cvt_pk_bf16_f32 v85, v86, v87
    v_cvt_pk_bf16_f32 v86, v88, v89
    v_cvt_pk_bf16_f32 v87, v90, v91
    v_pk_add_f32 v[156:157], v[156:157], v[210:211] op_sel_hi:[1,0] neg_lo:[0,1] neg_hi:[0,1]
    v_pk_add_f32 v[158:159], v[158:159], v[210:211] op_sel_hi:[1,0] neg_lo:[0,1] neg_hi:[0,1]
    v_exp_f32 v156, v156
    v_exp_f32 v157, v157
    v_exp_f32 v158, v158
    v_exp_f32 v159, v159
    v_pk_add_f32 v[160:161], v[160:161], v[210:211] op_sel_hi:[1,0] neg_lo:[0,1] neg_hi:[0,1]
    v_pk_add_f32 v[162:163], v[162:163], v[210:211] op_sel_hi:[1,0] neg_lo:[0,1] neg_hi:[0,1]
    v_exp_f32 v160, v160
    v_exp_f32 v161, v161
    v_exp_f32 v162, v162
    v_exp_f32 v163, v163
    v_cvt_pk_bf16_f32 v156, v156, v157
    v_cvt_pk_bf16_f32 v157, v158, v159
    v_cvt_pk_bf16_f32 v158, v160, v161
    v_cvt_pk_bf16_f32 v159, v162, v163
    ds_read_b128 v[192:195], v25 offset:40960
    s_mov_b64 exec, s[70:71]
    ds_read_b128 v[196:199], v26 offset:40960
    s_mov_b64 exec, -1
    s_waitcnt lgkmcnt(2)
    v_mfma_f32_16x16x32_bf16 v[212:215], v[200:203], v[84:87], v[212:215]
    v_mfma_f32_16x16x32_bf16 v[216:219], v[204:207], v[84:87], v[216:219]
    v_mfma_f32_16x16x32_bf16 v[220:223], v[200:203], v[156:159], v[220:223]
    v_mfma_f32_16x16x32_bf16 v[224:227], v[204:207], v[156:159], v[224:227]
    v_pk_add_f32 v[92:93], v[92:93], v[208:209] op_sel_hi:[1,0] neg_lo:[0,1] neg_hi:[0,1]
    v_pk_add_f32 v[94:95], v[94:95], v[208:209] op_sel_hi:[1,0] neg_lo:[0,1] neg_hi:[0,1]
    v_exp_f32 v92, v92
    v_exp_f32 v93, v93
    v_exp_f32 v94, v94
    v_exp_f32 v95, v95
    v_cvt_pk_bf16_f32 v92, v92, v93
    v_cvt_pk_bf16_f32 v93, v94, v95
    v_mov_b32 v94, 0
    v_mov_b32 v95, 0
    v_pk_add_f32 v[164:165], v[164:165], v[210:211] op_sel_hi:[1,0] neg_lo:[0,1] neg_hi:[0,1]
    v_pk_add_f32 v[166:167], v[166:167], v[210:211] op_sel_hi:[1,0] neg_lo:[0,1] neg_hi:[0,1]
    v_exp_f32 v164, v164
    v_exp_f32 v165, v165
    v_exp_f32 v166, v166
    v_exp_f32 v167, v167
    v_pk_add_f32 v[168:169], v[168:169], v[210:211] op_sel_hi:[1,0] neg_lo:[0,1] neg_hi:[0,1]
    v_pk_add_f32 v[170:171], v[170:171], v[210:211] op_sel_hi:[1,0] neg_lo:[0,1] neg_hi:[0,1]
    v_exp_f32 v168, v168
    v_exp_f32 v169, v169
    v_exp_f32 v170, v170
    v_exp_f32 v171, v171
    v_cvt_pk_bf16_f32 v164, v164, v165
    v_cvt_pk_bf16_f32 v165, v166, v167
    v_cvt_pk_bf16_f32 v166, v168, v169
    v_cvt_pk_bf16_f32 v167, v170, v171
    s_waitcnt lgkmcnt(0)
    v_mfma_f32_16x16x32_bf16 v[212:215], v[192:195], v[92:95], v[212:215]
    v_mfma_f32_16x16x32_bf16 v[216:219], v[196:199], v[92:95], v[216:219]
    v_mfma_f32_16x16x32_bf16 v[220:223], v[192:195], v[164:167], v[220:223]
    v_mfma_f32_16x16x32_bf16 v[224:227], v[196:199], v[164:167], v[224:227]
    s_nop 5
    v_mov_b32 v1, v216
    v_mov_b32 v4, v216
    s_nop 1
    v_permlane16_swap_b32 v1, v4
    v_rcp_f32 v5, v4
    s_nop 0
    v_mul_f32 v212, v212, v5
    v_mul_f32 v216, v216, v5
    v_mul_f32 v213, v213, v5
    v_mul_f32 v217, v217, v5
    v_mul_f32 v214, v214, v5
    v_mul_f32 v218, v218, v5
    v_mul_f32 v215, v215, v5
    v_mul_f32 v219, v219, v5
    v_cvt_pk_bf16_f32 v230, v212, v213
    v_cvt_pk_bf16_f32 v231, v214, v215
    v_cvt_pk_bf16_f32 v234, v216, v217
    v_cvt_pk_bf16_f32 v235, v218, v219
    v_mov_b32 v1, v224
    v_mov_b32 v4, v224
    s_nop 1
    v_permlane16_swap_b32 v1, v4
    v_rcp_f32 v5, v4
    s_nop 0
    v_mul_f32 v220, v220, v5
    v_mul_f32 v224, v224, v5
    v_mul_f32 v221, v221, v5
    v_mul_f32 v225, v225, v5
    v_mul_f32 v222, v222, v5
    v_mul_f32 v226, v226, v5
    v_mul_f32 v223, v223, v5
    v_mul_f32 v227, v227, v5
    v_cvt_pk_bf16_f32 v238, v220, v221
    v_cvt_pk_bf16_f32 v239, v222, v223
    v_cvt_pk_bf16_f32 v242, v224, v225
    v_cvt_pk_bf16_f32 v243, v226, v227
    v_lshrrev_b32 v2, 4, v0
    v_and_b32 v3, 15, v0
    v_lshlrev_b32 v4, 12, v2
    v_lshl_add_u32 v4, v3, 4, v4
    v_lshlrev_b32 v1, 4, v3
    v_add_u32 v1, 16384, v1
    v_mov_b32 v5, 0x7f000000
    v_cmp_eq_u32 vcc, 0, v2
    s_nop 1
    v_cndmask_b32 v1, v5, v1, vcc
    s_lshl_b32 s52, s44, 8
    s_add_u32 s73, s73, s52
    s_add_u32 s73, s73, 7929856
    s_cmp_eq_u32 s100, 0
    s_cbranch_scc1 L_safe_14
    buffer_store_dwordx4 v[228:231], v4, s[24:27], s73 offen
    buffer_store_dwordx4 v[232:235], v1, s[24:27], s73 offen
    s_add_u32 s52, s73, 20480
    buffer_store_dwordx4 v[236:239], v4, s[24:27], s52 offen
    buffer_store_dwordx4 v[240:243], v1, s[24:27], s52 offen
    s_nop 1
    s_branch L_join_15
L_safe_14:
    buffer_store_dwordx4 v[228:231], v4, s[24:27], s73 offen sc1
    buffer_store_dwordx4 v[232:235], v1, s[24:27], s73 offen sc1
    s_add_u32 s52, s73, 20480
    buffer_store_dwordx4 v[236:239], v4, s[24:27], s52 offen sc1
    buffer_store_dwordx4 v[240:243], v1, s[24:27], s52 offen sc1
    s_nop 1
L_join_15:
    s_waitcnt vmcnt(0)
    s_lshl_b32 s48, s41, 5
    s_add_u32 s48, s48, s42
    s_lshl_b32 s48, s48, 2
    s_add_u32 s48, s48, s46
    s_lshl_b32 s48, s48, 2
    s_add_u32 s48, s48, 4096
    v_mov_b32 v1, s45
    v_mov_b32 v2, 0
    s_mov_b64 exec, 1
    s_cmp_eq_u32 s100, 0
    s_cbranch_scc1 L_safe_16
    buffer_store_dword v1, v2, s[24:27], s48 offen
    s_branch L_join_17
L_safe_16:
    buffer_store_dword v1, v2, s[24:27], s48 offen sc1
L_join_17:
    s_mov_b64 exec, -1
    v_lshlrev_b32 v5, 4, v0
    s_lshl_b32 s48, s59, 2
    s_add_u32 s48, s48, s46
    s_mul_i32 s48, s48, 61440
    s_add_u32 s48, s48, 22515712
    buffer_load_dwordx4 v[8:11], v5, s[24:27], s48 offen offset:0 sc1
    buffer_load_dwordx4 v[12:15], v5, s[24:27], s48 offen offset:1024 sc1
    buffer_load_dwordx4 v[16:19], v5, s[24:27], s48 offen offset:2048 sc1
    buffer_load_dwordx4 v[20:23], v5, s[24:27], s48 offen offset:3072 sc1
    s_add_u32 s48, s48, 4096
    buffer_load_dwordx4 v[24:27], v5, s[24:27], s48 offen offset:0 sc1
    buffer_load_dwordx4 v[28:31], v5, s[24:27], s48 offen offset:1024 sc1
    buffer_load_dwordx4 v[32:35], v5, s[24:27], s48 offen offset:2048 sc1
    buffer_load_dwordx4 v[36:39], v5, s[24:27], s48 offen offset:3072 sc1
    s_add_u32 s48, s48, 4096
    buffer_load_dwordx4 v[40:43], v5, s[24:27], s48 offen offset:0 sc1
    buffer_load_dwordx4 v[44:47], v5, s[24:27], s48 offen offset:1024 sc1
    buffer_load_dwordx4 v[48:51], v5, s[24:27], s48 offen offset:2048 sc1
    buffer_load_dwordx4 v[52:55], v5, s[24:27], s48 offen offset:3072 sc1
    s_add_u32 s48, s48, 4096
    buffer_load_dwordx4 v[56:59], v5, s[24:27], s48 offen offset:0 sc1
    buffer_load_dwordx4 v[60:63], v5, s[24:27], s48 offen offset:1024 sc1
    buffer_load_dwordx4 v[64:67], v5, s[24:27], s48 offen offset:2048 sc1
    buffer_load_dwordx4 v[68:71], v5, s[24:27], s48 offen offset:3072 sc1
    s_add_u32 s48, s48, 4096
    buffer_load_dwordx4 v[72:75], v5, s[24:27], s48 offen offset:0 sc1
    buffer_load_dwordx4 v[76:79], v5, s[24:27], s48 offen offset:1024 sc1
    buffer_load_dwordx4 v[80:83], v5, s[24:27], s48 offen offset:2048 sc1
    buffer_load_dwordx4 v[84:87], v5, s[24:27], s48 offen offset:3072 sc1
    s_add_u32 s48, s48, 4096
    buffer_load_dwordx4 v[88:91], v5, s[24:27], s48 offen offset:0 sc1
    buffer_load_dwordx4 v[92:95], v5, s[24:27], s48 offen offset:1024 sc1
    buffer_load_dwordx4 v[96:99], v5, s[24:27], s48 offen offset:2048 sc1
    buffer_load_dwordx4 v[100:103], v5, s[24:27], s48 offen offset:3072 sc1
    v_and_b32 v1, 15, v0
    v_lshrrev_b32 v2, 4, v0
    v_mul_u32_u24 v3, 0x500, v1
    v_lshl_add_u32 v3, v2, 3, v3
    s_lshl_b32 s50, s40, 4
    s_add_u32 s50, s50, s58
    s_mul_i32 s50, s50, 1280
    s_mul_i32 s51, s59, 160
    s_add_u32 s74, s50, s51
    buffer_load_dwordx2 v[104:105], v3, s[4:7], s74 offen offset:0
    buffer_load_dwordx2 v[106:107], v3, s[4:7], s74 offen offset:32
    buffer_load_dwordx2 v[108:109], v3, s[4:7], s74 offen offset:64
    buffer_load_dwordx2 v[110:111], v3, s[4:7], s74 offen offset:96
    buffer_load_dwordx2 v[112:113], v3, s[4:7], s74 offen offset:128
    v_add_u32 v6, 0x10000, v5
    v_add_u32 v7, 0x20000, v5
    s_lshr_b32 s75, s58, 4
    s_add_u32 s75, s75, s40
    s_and_b32 s50, s75, 0xfffffffe
    s_mul_i32 s50, s50, 20480
    s_and_b32 s68, s40, 1
    s_mul_i32 s51, s68, 10240
    s_add_u32 s50, s50, s51
    s_add_u32 s50, s50, 7929856
    s_add_u32 s69, s50, 20480
    v_lshlrev_b32 v114, 4, v0
    v_lshrrev_b32 v1, 4, v0
    v_bfe_u32 v2, v0, 2, 2
    v_lshl_add_u32 v1, v1, 2, v2
    v_mul_u32_u24 v1, 160, v1
    v_and_b32 v2, 3, v0
    v_lshl_add_u32 v5, v2, 3, v1
    s_mul_i32 s51, s68, 51200
    v_add_u32 v5, s51, v5
    v_add_u32 v6, 0x10000, v5
    v_add_u32 v7, 0x20000, v5
    s_lshr_b32 s49, s58, 7
    s_and_b32 s49, s49, 1
    s_lshl_b32 s49, s49, 4
    s_lshr_b32 s51, s75, 1
    s_and_b32 s51, s51, 3
    v_and_b32 v1, 15, v0
    s_lshl_b32 s54, s41, 5
    s_add_u32 s54, s54, s49
    s_lshl_b32 s54, s54, 4
    s_lshl_b32 s55, s51, 2
    s_add_u32 s54, s54, s55
    s_add_u32 s54, s54, 4096
    v_lshl_add_u32 v1, v1, 4, s54
    s_mov_b32 s56, 0
    s_nop 0
L_poll_18:
    buffer_load_dword v2, v1, s[24:27], 0 offen sc1
    s_waitcnt vmcnt(0)
    v_xor_b32 v2, s45, v2
    v_cmp_ne_u32 vcc, 0, v2
    s_nop 2
    s_cmp_eq_u64 vcc, 0
    s_nop 0
    s_cbranch_scc1 L_polldone_19
    s_add_u32 s56, s56, 1
    s_cmp_lt_u32 s56, 131072
    s_cbranch_scc0 L_polldone_19
    s_branch L_poll_18
L_polldone_19:
    s_add_u32 s52, s50, 0
    buffer_load_dwordx4 v[116:119], v114, s[24:27], s52 offen offset:0 sc1
    s_add_u32 s52, s69, 0
    buffer_load_dwordx4 v[120:123], v114, s[24:27], s52 offen offset:0 sc1
    s_add_u32 s52, s50, 0
    buffer_load_dwordx4 v[124:127], v114, s[24:27], s52 offen offset:1024 sc1
    s_add_u32 s52, s69, 0
    buffer_load_dwordx4 v[128:131], v114, s[24:27], s52 offen offset:1024 sc1
    s_add_u32 s52, s50, 0
    buffer_load_dwordx4 v[132:135], v114, s[24:27], s52 offen offset:2048 sc1
    s_add_u32 s52, s69, 0
    buffer_load_dwordx4 v[136:139], v114, s[24:27], s52 offen offset:2048 sc1
    s_add_u32 s52, s50, 0
    buffer_load_dwordx4 v[140:143], v114, s[24:27], s52 offen offset:3072 sc1
    s_add_u32 s52, s69, 0
    buffer_load_dwordx4 v[144:147], v114, s[24:27], s52 offen offset:3072 sc1
    s_barrier
    ds_read_b64_tr_b16 v[196:197], v5 offset:61440
    ds_read_b64_tr_b16 v[198:199], v5 offset:64000
    ds_read_b64_tr_b16 v[200:201], v5 offset:61472
    ds_read_b64_tr_b16 v[202:203], v5 offset:64032
    ds_read_b64_tr_b16 v[204:205], v5 offset:61504
    ds_read_b64_tr_b16 v[206:207], v5 offset:64064
    ds_read_b64_tr_b16 v[208:209], v5 offset:61536
    ds_read_b64_tr_b16 v[210:211], v5 offset:64096
    ds_read_b64_tr_b16 v[212:213], v5 offset:61568
    ds_read_b64_tr_b16 v[214:215], v5 offset:64128
    s_add_u32 s52, s50, 4096
    buffer_load_dwordx4 v[148:151], v114, s[24:27], s52 offen offset:0 sc1
    s_add_u32 s52, s69, 4096
    buffer_load_dwordx4 v[152:155], v114, s[24:27], s52 offen offset:0 sc1
    s_waitcnt vmcnt(8) lgkmcnt(0)
    v_mfma_f32_16x16x32_bf16 v[156:159], v[196:199], v[116:119], 0
    ds_read_b64_tr_b16 v[216:217], v6 offset:1024
    v_mfma_f32_16x16x32_bf16 v[176:179], v[196:199], v[120:123], 0
    ds_read_b64_tr_b16 v[218:219], v6 offset:3584
    v_mfma_f32_16x16x32_bf16 v[160:163], v[200:203], v[116:119], 0
    ds_read_b64_tr_b16 v[220:221], v6 offset:1056
    v_mfma_f32_16x16x32_bf16 v[180:183], v[200:203], v[120:123], 0
    ds_read_b64_tr_b16 v[222:223], v6 offset:3616
    v_mfma_f32_16x16x32_bf16 v[164:167], v[204:207], v[116:119], 0
    ds_read_b64_tr_b16 v[224:225], v6 offset:1088
    v_mfma_f32_16x16x32_bf16 v[184:187], v[204:207], v[120:123], 0
    ds_read_b64_tr_b16 v[226:227], v6 offset:3648
    v_mfma_f32_16x16x32_bf16 v[168:171], v[208:211], v[116:119], 0
    ds_read_b64_tr_b16 v[228:229], v6 offset:1120
    v_mfma_f32_16x16x32_bf16 v[188:191], v[208:211], v[120:123], 0
    ds_read_b64_tr_b16 v[230:231], v6 offset:3680
    v_mfma_f32_16x16x32_bf16 v[172:175], v[212:215], v[116:119], 0
    ds_read_b64_tr_b16 v[232:233], v6 offset:1152
    v_mfma_f32_16x16x32_bf16 v[192:195], v[212:215], v[120:123], 0
    ds_read_b64_tr_b16 v[234:235], v6 offset:3712
    s_add_u32 s52, s50, 4096
    buffer_load_dwordx4 v[116:119], v114, s[24:27], s52 offen offset:1024 sc1
    s_add_u32 s52, s69, 4096
    buffer_load_dwordx4 v[120:123], v114, s[24:27], s52 offen offset:1024 sc1
    s_waitcnt vmcnt(8) lgkmcnt(0)
    v_mfma_f32_16x16x32_bf16 v[156:159], v[216:219], v[124:127], v[156:159]
    ds_read_b64_tr_b16 v[196:197], v6 offset:6144
    v_mfma_f32_16x16x32_bf16 v[176:179], v[216:219], v[128:131], v[176:179]
    ds_read_b64_tr_b16 v[198:199], v6 offset:8704
    v_mfma_f32_16x16x32_bf16 v[160:163], v[220:223], v[124:127], v[160:163]
    ds_read_b64_tr_b16 v[200:201], v6 offset:6176
    v_mfma_f32_16x16x32_bf16 v[180:183], v[220:223], v[128:131], v[180:183]
    ds_read_b64_tr_b16 v[202:203], v6 offset:8736
    v_mfma_f32_16x16x32_bf16 v[164:167], v[224:227], v[124:127], v[164:167]
    ds_read_b64_tr_b16 v[204:205], v6 offset:6208
    v_mfma_f32_16x16x32_bf16 v[184:187], v[224:227], v[128:131], v[184:187]
    ds_read_b64_tr_b16 v[206:207], v6 offset:8768
    v_mfma_f32_16x16x32_bf16 v[168:171], v[228:231], v[124:127], v[168:171]
    ds_read_b64_tr_b16 v[208:209], v6 offset:6240
    v_mfma_f32_16x16x32_bf16 v[188:191], v[228:231], v[128:131], v[188:191]
    ds_read_b64_tr_b16 v[210:211], v6 offset:8800
    v_mfma_f32_16x16x32_bf16 v[172:175], v[232:235], v[124:127], v[172:175]
    ds_read_b64_tr_b16 v[212:213], v6 offset:6272
    v_mfma_f32_16x16x32_bf16 v[192:195], v[232:235], v[128:131], v[192:195]
    ds_read_b64_tr_b16 v[214:215], v6 offset:8832
    s_add_u32 s52, s50, 4096
    buffer_load_dwordx4 v[124:127], v114, s[24:27], s52 offen offset:2048 sc1
    s_add_u32 s52, s69, 4096
    buffer_load_dwordx4 v[128:131], v114, s[24:27], s52 offen offset:2048 sc1
    s_waitcnt vmcnt(8) lgkmcnt(0)
    v_mfma_f32_16x16x32_bf16 v[156:159], v[196:199], v[132:135], v[156:159]
    ds_read_b64_tr_b16 v[216:217], v6 offset:11264
    v_mfma_f32_16x16x32_bf16 v[176:179], v[196:199], v[136:139], v[176:179]
    ds_read_b64_tr_b16 v[218:219], v6 offset:13824
    v_mfma_f32_16x16x32_bf16 v[160:163], v[200:203], v[132:135], v[160:163]
    ds_read_b64_tr_b16 v[220:221], v6 offset:11296
    v_mfma_f32_16x16x32_bf16 v[180:183], v[200:203], v[136:139], v[180:183]
    ds_read_b64_tr_b16 v[222:223], v6 offset:13856
    v_mfma_f32_16x16x32_bf16 v[164:167], v[204:207], v[132:135], v[164:167]
    ds_read_b64_tr_b16 v[224:225], v6 offset:11328
    v_mfma_f32_16x16x32_bf16 v[184:187], v[204:207], v[136:139], v[184:187]
    ds_read_b64_tr_b16 v[226:227], v6 offset:13888
    v_mfma_f32_16x16x32_bf16 v[168:171], v[208:211], v[132:135], v[168:171]
    ds_read_b64_tr_b16 v[228:229], v6 offset:11360
    v_mfma_f32_16x16x32_bf16 v[188:191], v[208:211], v[136:139], v[188:191]
    ds_read_b64_tr_b16 v[230:231], v6 offset:13920
    v_mfma_f32_16x16x32_bf16 v[172:175], v[212:215], v[132:135], v[172:175]
    ds_read_b64_tr_b16 v[232:233], v6 offset:11392
    v_mfma_f32_16x16x32_bf16 v[192:195], v[212:215], v[136:139], v[192:195]
    ds_read_b64_tr_b16 v[234:235], v6 offset:13952
    s_add_u32 s52, s50, 4096
    buffer_load_dwordx4 v[132:135], v114, s[24:27], s52 offen offset:3072 sc1
    s_add_u32 s52, s69, 4096
    buffer_load_dwordx4 v[136:139], v114, s[24:27], s52 offen offset:3072 sc1
    s_waitcnt vmcnt(8) lgkmcnt(0)
    v_mfma_f32_16x16x32_bf16 v[156:159], v[216:219], v[140:143], v[156:159]
    ds_read_b64_tr_b16 v[196:197], v6 offset:16384
    v_mfma_f32_16x16x32_bf16 v[176:179], v[216:219], v[144:147], v[176:179]
    ds_read_b64_tr_b16 v[198:199], v6 offset:18944
    v_mfma_f32_16x16x32_bf16 v[160:163], v[220:223], v[140:143], v[160:163]
    ds_read_b64_tr_b16 v[200:201], v6 offset:16416
    v_mfma_f32_16x16x32_bf16 v[180:183], v[220:223], v[144:147], v[180:183]
    ds_read_b64_tr_b16 v[202:203], v6 offset:18976
    v_mfma_f32_16x16x32_bf16 v[164:167], v[224:227], v[140:143], v[164:167]
    ds_read_b64_tr_b16 v[204:205], v6 offset:16448
    v_mfma_f32_16x16x32_bf16 v[184:187], v[224:227], v[144:147], v[184:187]
    ds_read_b64_tr_b16 v[206:207], v6 offset:19008
    v_mfma_f32_16x16x32_bf16 v[168:171], v[228:231], v[140:143], v[168:171]
    ds_read_b64_tr_b16 v[208:209], v6 offset:16480
    v_mfma_f32_16x16x32_bf16 v[188:191], v[228:231], v[144:147], v[188:191]
    ds_read_b64_tr_b16 v[210:211], v6 offset:19040
    v_mfma_f32_16x16x32_bf16 v[172:175], v[232:235], v[140:143], v[172:175]
    ds_read_b64_tr_b16 v[212:213], v6 offset:16512
    v_mfma_f32_16x16x32_bf16 v[192:195], v[232:235], v[144:147], v[192:195]
    ds_read_b64_tr_b16 v[214:215], v6 offset:19072
    s_add_u32 s52, s50, 8192
    buffer_load_dwordx4 v[140:143], v114, s[24:27], s52 offen offset:0 sc1
    s_add_u32 s52, s69, 8192
    buffer_load_dwordx4 v[144:147], v114, s[24:27], s52 offen offset:0 sc1
    s_waitcnt vmcnt(8) lgkmcnt(0)
    v_mfma_f32_16x16x32_bf16 v[156:159], v[196:199], v[148:151], v[156:159]
    ds_read_b64_tr_b16 v[216:217], v6 offset:21504
    v_mfma_f32_16x16x32_bf16 v[176:179], v[196:199], v[152:155], v[176:179]
    ds_read_b64_tr_b16 v[218:219], v6 offset:24064
    v_mfma_f32_16x16x32_bf16 v[160:163], v[200:203], v[148:151], v[160:163]
    ds_read_b64_tr_b16 v[220:221], v6 offset:21536
    v_mfma_f32_16x16x32_bf16 v[180:183], v[200:203], v[152:155], v[180:183]
    ds_read_b64_tr_b16 v[222:223], v6 offset:24096
    v_mfma_f32_16x16x32_bf16 v[164:167], v[204:207], v[148:151], v[164:167]
    ds_read_b64_tr_b16 v[224:225], v6 offset:21568
    v_mfma_f32_16x16x32_bf16 v[184:187], v[204:207], v[152:155], v[184:187]
    ds_read_b64_tr_b16 v[226:227], v6 offset:24128
    v_mfma_f32_16x16x32_bf16 v[168:171], v[208:211], v[148:151], v[168:171]
    ds_read_b64_tr_b16 v[228:229], v6 offset:21600
    v_mfma_f32_16x16x32_bf16 v[188:191], v[208:211], v[152:155], v[188:191]
    ds_read_b64_tr_b16 v[230:231], v6 offset:24160
    v_mfma_f32_16x16x32_bf16 v[172:175], v[212:215], v[148:151], v[172:175]
    ds_read_b64_tr_b16 v[232:233], v6 offset:21632
    v_mfma_f32_16x16x32_bf16 v[192:195], v[212:215], v[152:155], v[192:195]
    ds_read_b64_tr_b16 v[234:235], v6 offset:24192
    s_add_u32 s52, s50, 8192
    buffer_load_dwordx4 v[148:151], v114, s[24:27], s52 offen offset:1024 sc1
    s_add_u32 s52, s69, 8192
    buffer_load_dwordx4 v[152:155], v114, s[24:27], s52 offen offset:1024 sc1
    s_waitcnt vmcnt(8) lgkmcnt(0)
    v_mfma_f32_16x16x32_bf16 v[156:159], v[216:219], v[116:119], v[156:159]
    ds_read_b64_tr_b16 v[196:197], v6 offset:26624
    v_mfma_f32_16x16x32_bf16 v[176:179], v[216:219], v[120:123], v[176:179]
    ds_read_b64_tr_b16 v[198:199], v6 offset:29184
    v_mfma_f32_16x16x32_bf16 v[160:163], v[220:223], v[116:119], v[160:163]
    ds_read_b64_tr_b16 v[200:201], v6 offset:26656
    v_mfma_f32_16x16x32_bf16 v[180:183], v[220:223], v[120:123], v[180:183]
    ds_read_b64_tr_b16 v[202:203], v6 offset:29216
    v_mfma_f32_16x16x32_bf16 v[164:167], v[224:227], v[116:119], v[164:167]
    ds_read_b64_tr_b16 v[204:205], v6 offset:26688
    v_mfma_f32_16x16x32_bf16 v[184:187], v[224:227], v[120:123], v[184:187]
    ds_read_b64_tr_b16 v[206:207], v6 offset:29248
    v_mfma_f32_16x16x32_bf16 v[168:171], v[228:231], v[116:119], v[168:171]
    ds_read_b64_tr_b16 v[208:209], v6 offset:26720
    v_mfma_f32_16x16x32_bf16 v[188:191], v[228:231], v[120:123], v[188:191]
    ds_read_b64_tr_b16 v[210:211], v6 offset:29280
    v_mfma_f32_16x16x32_bf16 v[172:175], v[232:235], v[116:119], v[172:175]
    ds_read_b64_tr_b16 v[212:213], v6 offset:26752
    v_mfma_f32_16x16x32_bf16 v[192:195], v[232:235], v[120:123], v[192:195]
    ds_read_b64_tr_b16 v[214:215], v6 offset:29312
    s_waitcnt vmcnt(6) lgkmcnt(0)
    v_mfma_f32_16x16x32_bf16 v[156:159], v[196:199], v[124:127], v[156:159]
    ds_read_b64_tr_b16 v[216:217], v6 offset:31744
    v_mfma_f32_16x16x32_bf16 v[176:179], v[196:199], v[128:131], v[176:179]
    ds_read_b64_tr_b16 v[218:219], v6 offset:34304
    v_mfma_f32_16x16x32_bf16 v[160:163], v[200:203], v[124:127], v[160:163]
    ds_read_b64_tr_b16 v[220:221], v6 offset:31776
    v_mfma_f32_16x16x32_bf16 v[180:183], v[200:203], v[128:131], v[180:183]
    ds_read_b64_tr_b16 v[222:223], v6 offset:34336
    v_mfma_f32_16x16x32_bf16 v[164:167], v[204:207], v[124:127], v[164:167]
    ds_read_b64_tr_b16 v[224:225], v6 offset:31808
    v_mfma_f32_16x16x32_bf16 v[184:187], v[204:207], v[128:131], v[184:187]
    ds_read_b64_tr_b16 v[226:227], v6 offset:34368
    v_mfma_f32_16x16x32_bf16 v[168:171], v[208:211], v[124:127], v[168:171]
    ds_read_b64_tr_b16 v[228:229], v6 offset:31840
    v_mfma_f32_16x16x32_bf16 v[188:191], v[208:211], v[128:131], v[188:191]
    ds_read_b64_tr_b16 v[230:231], v6 offset:34400
    v_mfma_f32_16x16x32_bf16 v[172:175], v[212:215], v[124:127], v[172:175]
    ds_read_b64_tr_b16 v[232:233], v6 offset:31872
    v_mfma_f32_16x16x32_bf16 v[192:195], v[212:215], v[128:131], v[192:195]
    ds_read_b64_tr_b16 v[234:235], v6 offset:34432
    s_waitcnt vmcnt(4) lgkmcnt(0)
    v_mfma_f32_16x16x32_bf16 v[156:159], v[216:219], v[132:135], v[156:159]
    ds_read_b64_tr_b16 v[196:197], v6 offset:36864
    v_mfma_f32_16x16x32_bf16 v[176:179], v[216:219], v[136:139], v[176:179]
    ds_read_b64_tr_b16 v[198:199], v6 offset:39424
    v_mfma_f32_16x16x32_bf16 v[160:163], v[220:223], v[132:135], v[160:163]
    ds_read_b64_tr_b16 v[200:201], v6 offset:36896
    v_mfma_f32_16x16x32_bf16 v[180:183], v[220:223], v[136:139], v[180:183]
    ds_read_b64_tr_b16 v[202:203], v6 offset:39456
    v_mfma_f32_16x16x32_bf16 v[164:167], v[224:227], v[132:135], v[164:167]
    ds_read_b64_tr_b16 v[204:205], v6 offset:36928
    v_mfma_f32_16x16x32_bf16 v[184:187], v[224:227], v[136:139], v[184:187]
    ds_read_b64_tr_b16 v[206:207], v6 offset:39488
    v_mfma_f32_16x16x32_bf16 v[168:171], v[228:231], v[132:135], v[168:171]
    ds_read_b64_tr_b16 v[208:209], v6 offset:36960
    v_mfma_f32_16x16x32_bf16 v[188:191], v[228:231], v[136:139], v[188:191]
    ds_read_b64_tr_b16 v[210:211], v6 offset:39520
    v_mfma_f32_16x16x32_bf16 v[172:175], v[232:235], v[132:135], v[172:175]
    ds_read_b64_tr_b16 v[212:213], v6 offset:36992
    v_mfma_f32_16x16x32_bf16 v[192:195], v[232:235], v[136:139], v[192:195]
    ds_read_b64_tr_b16 v[214:215], v6 offset:39552
    s_waitcnt vmcnt(2) lgkmcnt(0)
    v_mfma_f32_16x16x32_bf16 v[156:159], v[196:199], v[140:143], v[156:159]
    ds_read_b64_tr_b16 v[216:217], v6 offset:41984
    v_mfma_f32_16x16x32_bf16 v[176:179], v[196:199], v[144:147], v[176:179]
    ds_read_b64_tr_b16 v[218:219], v6 offset:44544
    v_mfma_f32_16x16x32_bf16 v[160:163], v[200:203], v[140:143], v[160:163]
    ds_read_b64_tr_b16 v[220:221], v6 offset:42016
    v_mfma_f32_16x16x32_bf16 v[180:183], v[200:203], v[144:147], v[180:183]
    ds_read_b64_tr_b16 v[222:223], v6 offset:44576
    v_mfma_f32_16x16x32_bf16 v[164:167], v[204:207], v[140:143], v[164:167]
    ds_read_b64_tr_b16 v[224:225], v6 offset:42048
    v_mfma_f32_16x16x32_bf16 v[184:187], v[204:207], v[144:147], v[184:187]
    ds_read_b64_tr_b16 v[226:227], v6 offset:44608
    v_mfma_f32_16x16x32_bf16 v[168:171], v[208:211], v[140:143], v[168:171]
    ds_read_b64_tr_b16 v[228:229], v6 offset:42080
    v_mfma_f32_16x16x32_bf16 v[188:191], v[208:211], v[144:147], v[188:191]
    ds_read_b64_tr_b16 v[230:231], v6 offset:44640
    v_mfma_f32_16x16x32_bf16 v[172:175], v[212:215], v[140:143], v[172:175]
    ds_read_b64_tr_b16 v[232:233], v6 offset:42112
    v_mfma_f32_16x16x32_bf16 v[192:195], v[212:215], v[144:147], v[192:195]
    ds_read_b64_tr_b16 v[234:235], v6 offset:44672
    s_waitcnt vmcnt(0) lgkmcnt(0)
    v_mfma_f32_16x16x32_bf16 v[156:159], v[216:219], v[148:151], v[156:159]
    v_mfma_f32_16x16x32_bf16 v[176:179], v[216:219], v[152:155], v[176:179]
    v_mfma_f32_16x16x32_bf16 v[160:163], v[220:223], v[148:151], v[160:163]
    v_mfma_f32_16x16x32_bf16 v[180:183], v[220:223], v[152:155], v[180:183]
    v_mfma_f32_16x16x32_bf16 v[164:167], v[224:227], v[148:151], v[164:167]
    v_mfma_f32_16x16x32_bf16 v[184:187], v[224:227], v[152:155], v[184:187]
    v_mfma_f32_16x16x32_bf16 v[168:171], v[228:231], v[148:151], v[168:171]
    v_mfma_f32_16x16x32_bf16 v[188:191], v[228:231], v[152:155], v[188:191]
    v_mfma_f32_16x16x32_bf16 v[172:175], v[232:235], v[148:151], v[172:175]
    v_mfma_f32_16x16x32_bf16 v[192:195], v[232:235], v[152:155], v[192:195]
    s_barrier
    v_lshlrev_b32 v115, 4, v0
    s_mul_i32 s51, s40, 5120
    s_add_u32 s51, s51, 61440
    v_add_u32 v1, s51, v115
    s_xor_b32 s51, s40, 1
    s_mul_i32 s51, s51, 5120
    s_add_u32 s51, s51, 61440
    v_add_u32 v2, s51, v115
    s_cmp_eq_u32 s68, 0
    s_nop 0
    s_cbranch_scc0 L_kh1_20
    ds_write_b128 v1, v[176:179] offset:0
    ds_write_b128 v1, v[180:183] offset:1024
    ds_write_b128 v1, v[184:187] offset:2048
    ds_write_b128 v1, v[188:191] offset:3072
    ds_write_b128 v1, v[192:195] offset:4096
    s_branch L_khj_21
L_kh1_20:
    ds_write_b128 v1, v[156:159] offset:0
    ds_write_b128 v1, v[160:163] offset:1024
    ds_write_b128 v1, v[164:167] offset:2048
    ds_write_b128 v1, v[168:171] offset:3072
    ds_write_b128 v1, v[172:175] offset:4096
    s_waitcnt lgkmcnt(0)
    v_mov_b32 v156, v176
    v_mov_b32 v157, v177
    v_mov_b32 v158, v178
    v_mov_b32 v159, v179
    v_mov_b32 v160, v180
    v_mov_b32 v161, v181
    v_mov_b32 v162, v182
    v_mov_b32 v163, v183
    v_mov_b32 v164, v184
    v_mov_b32 v165, v185
    v_mov_b32 v166, v186
    v_mov_b32 v167, v187
    v_mov_b32 v168, v188
    v_mov_b32 v169, v189
    v_mov_b32 v170, v190
    v_mov_b32 v171, v191
    v_mov_b32 v172, v192
    v_mov_b32 v173, v193
    v_mov_b32 v174, v194
    v_mov_b32 v175, v195
    s_nop 1
L_khj_21:
    s_waitcnt lgkmcnt(0)
    s_barrier
    ds_read_b128 v[196:199], v2 offset:0
    ds_read_b128 v[200:203], v2 offset:1024
    ds_read_b128 v[204:207], v2 offset:2048
    ds_read_b128 v[208:211], v2 offset:3072
    ds_read_b128 v[212:215], v2 offset:4096
    s_waitcnt lgkmcnt(0)
    v_pk_add_f32 v[156:157], v[156:157], v[196:197]
    v_pk_add_f32 v[158:159], v[158:159], v[198:199]
    v_pk_add_f32 v[160:161], v[160:161], v[200:201]
    v_pk_add_f32 v[162:163], v[162:163], v[202:203]
    v_pk_add_f32 v[164:165], v[164:165], v[204:205]
    v_pk_add_f32 v[166:167], v[166:167], v[206:207]
    v_pk_add_f32 v[168:169], v[168:169], v[208:209]
    v_pk_add_f32 v[170:171], v[170:171], v[210:211]
    v_pk_add_f32 v[172:173], v[172:173], v[212:213]
    v_pk_add_f32 v[174:175], v[174:175], v[214:215]
    v_lshlrev_b32 v1, 16, v104
    v_and_b32 v2, 0xffff0000, v104
    v_add_f32 v156, v156, v1
    v_add_f32 v157, v157, v2
    v_cvt_pk_bf16_f32 v116, v156, v157
    v_lshlrev_b32 v1, 16, v105
    v_and_b32 v2, 0xffff0000, v105
    v_add_f32 v158, v158, v1
    v_add_f32 v159, v159, v2
    v_cvt_pk_bf16_f32 v117, v158, v159
    v_lshlrev_b32 v1, 16, v106
    v_and_b32 v2, 0xffff0000, v106
    v_add_f32 v160, v160, v1
    v_add_f32 v161, v161, v2
    v_cvt_pk_bf16_f32 v118, v160, v161
    v_lshlrev_b32 v1, 16, v107
    v_and_b32 v2, 0xffff0000, v107
    v_add_f32 v162, v162, v1
    v_add_f32 v163, v163, v2
    v_cvt_pk_bf16_f32 v119, v162, v163
    v_lshlrev_b32 v1, 16, v108
    v_and_b32 v2, 0xffff0000, v108
    v_add_f32 v164, v164, v1
    v_add_f32 v165, v165, v2
    v_cvt_pk_bf16_f32 v120, v164, v165
    v_lshlrev_b32 v1, 16, v109
    v_and_b32 v2, 0xffff0000, v109
    v_add_f32 v166, v166, v1
    v_add_f32 v167, v167, v2
    v_cvt_pk_bf16_f32 v121, v166, v167
    v_lshlrev_b32 v1, 16, v110
    v_and_b32 v2, 0xffff0000, v110
    v_add_f32 v168, v168, v1
    v_add_f32 v169, v169, v2
    v_cvt_pk_bf16_f32 v122, v168, v169
    v_lshlrev_b32 v1, 16, v111
    v_and_b32 v2, 0xffff0000, v111
    v_add_f32 v170, v170, v1
    v_add_f32 v171, v171, v2
    v_cvt_pk_bf16_f32 v123, v170, v171
    v_lshlrev_b32 v1, 16, v112
    v_and_b32 v2, 0xffff0000, v112
    v_add_f32 v172, v172, v1
    v_add_f32 v173, v173, v2
    v_cvt_pk_bf16_f32 v124, v172, v173
    v_lshlrev_b32 v1, 16, v113
    v_and_b32 v2, 0xffff0000, v113
    v_add_f32 v174, v174, v1
    v_add_f32 v175, v175, v2
    v_cvt_pk_bf16_f32 v125, v174, v175
    v_and_b32 v1, 15, v0
    v_lshrrev_b32 v2, 4, v0
    v_lshlrev_b32 v3, 8, v2
    v_lshl_add_u32 v3, v1, 4, v3
    s_mul_i32 s50, s75, 20480
    s_add_u32 s50, s50, 10551296
    s_mul_i32 s51, s59, 5
    s_cmp_eq_u32 s100, 0
    s_cbranch_scc1 L_safe_22
    s_add_u32 s52, s51, 0
    s_lshr_b32 s53, s52, 1
    s_lshl_b32 s53, s53, 10
    s_and_b32 s52, s52, 1
    s_lshl_b32 s52, s52, 3
    s_add_u32 s53, s53, s52
    s_add_u32 s53, s53, s50
    buffer_store_dwordx2 v[116:117], v3, s[24:27], s53 offen
    s_add_u32 s52, s51, 1
    s_lshr_b32 s53, s52, 1
    s_lshl_b32 s53, s53, 10
    s_and_b32 s52, s52, 1
    s_lshl_b32 s52, s52, 3
    s_add_u32 s53, s53, s52
    s_add_u32 s53, s53, s50
    buffer_store_dwordx2 v[118:119], v3, s[24:27], s53 offen
    s_add_u32 s52, s51, 2
    s_lshr_b32 s53, s52, 1
    s_lshl_b32 s53, s53, 10
    s_and_b32 s52, s52, 1
    s_lshl_b32 s52, s52, 3
    s_add_u32 s53, s53, s52
    s_add_u32 s53, s53, s50
    buffer_store_dwordx2 v[120:121], v3, s[24:27], s53 offen
    s_add_u32 s52, s51, 3
    s_lshr_b32 s53, s52, 1
    s_lshl_b32 s53, s53, 10
    s_and_b32 s52, s52, 1
    s_lshl_b32 s52, s52, 3
    s_add_u32 s53, s53, s52
    s_add_u32 s53, s53, s50
    buffer_store_dwordx2 v[122:123], v3, s[24:27], s53 offen
    s_add_u32 s52, s51, 4
    s_lshr_b32 s53, s52, 1
    s_lshl_b32 s53, s53, 10
    s_and_b32 s52, s52, 1
    s_lshl_b32 s52, s52, 3
    s_add_u32 s53, s53, s52
    s_add_u32 s53, s53, s50
    buffer_store_dwordx2 v[124:125], v3, s[24:27], s53 offen
    s_branch L_join_23
L_safe_22:
    s_add_u32 s52, s51, 0
    s_lshr_b32 s53, s52, 1
    s_lshl_b32 s53, s53, 10
    s_and_b32 s52, s52, 1
    s_lshl_b32 s52, s52, 3
    s_add_u32 s53, s53, s52
    s_add_u32 s53, s53, s50
    buffer_store_dwordx2 v[116:117], v3, s[24:27], s53 offen sc1
    s_add_u32 s52, s51, 1
    s_lshr_b32 s53, s52, 1
    s_lshl_b32 s53, s53, 10
    s_and_b32 s52, s52, 1
    s_lshl_b32 s52, s52, 3
    s_add_u32 s53, s53, s52
    s_add_u32 s53, s53, s50
    buffer_store_dwordx2 v[118:119], v3, s[24:27], s53 offen sc1
    s_add_u32 s52, s51, 2
    s_lshr_b32 s53, s52, 1
    s_lshl_b32 s53, s53, 10
    s_and_b32 s52, s52, 1
    s_lshl_b32 s52, s52, 3
    s_add_u32 s53, s53, s52
    s_add_u32 s53, s53, s50
    buffer_store_dwordx2 v[120:121], v3, s[24:27], s53 offen sc1
    s_add_u32 s52, s51, 3
    s_lshr_b32 s53, s52, 1
    s_lshl_b32 s53, s53, 10
    s_and_b32 s52, s52, 1
    s_lshl_b32 s52, s52, 3
    s_add_u32 s53, s53, s52
    s_add_u32 s53, s53, s50
    buffer_store_dwordx2 v[122:123], v3, s[24:27], s53 offen sc1
    s_add_u32 s52, s51, 4
    s_lshr_b32 s53, s52, 1
    s_lshl_b32 s53, s53, 10
    s_and_b32 s52, s52, 1
    s_lshl_b32 s52, s52, 3
    s_add_u32 s53, s53, s52
    s_add_u32 s53, s53, s50
    buffer_store_dwordx2 v[124:125], v3, s[24:27], s53 offen sc1
L_join_23:
    v_lshlrev_b32 v236, 16, v116
    v_and_b32 v237, 0xffff0000, v116
    v_lshlrev_b32 v238, 16, v117
    v_and_b32 v239, 0xffff0000, v117
    v_lshlrev_b32 v240, 16, v118
    v_and_b32 v241, 0xffff0000, v118
    v_lshlrev_b32 v242, 16, v119
    v_and_b32 v243, 0xffff0000, v119
    v_lshlrev_b32 v244, 16, v120
    v_and_b32 v245, 0xffff0000, v120
    v_lshlrev_b32 v246, 16, v121
    v_and_b32 v247, 0xffff0000, v121
    v_lshlrev_b32 v248, 16, v122
    v_and_b32 v249, 0xffff0000, v122
    v_lshlrev_b32 v250, 16, v123
    v_and_b32 v251, 0xffff0000, v123
    v_lshlrev_b32 v252, 16, v124
    v_and_b32 v253, 0xffff0000, v124
    v_lshlrev_b32 v254, 16, v125
    v_and_b32 v255, 0xffff0000, v125
    v_add_f32 v126, v236, v237
    v_add_f32 v128, v238, v239
    v_add_f32 v126, v126, v240
    v_add_f32 v128, v128, v241
    v_add_f32 v126, v126, v242
    v_add_f32 v128, v128, v243
    v_add_f32 v126, v126, v244
    v_add_f32 v128, v128, v245
    v_add_f32 v126, v126, v246
    v_add_f32 v128, v128, v247
    v_add_f32 v126, v126, v248
    v_add_f32 v128, v128, v249
    v_add_f32 v126, v126, v250
    v_add_f32 v128, v128, v251
    v_add_f32 v126, v126, v252
    v_add_f32 v128, v128, v253
    v_add_f32 v126, v126, v254
    v_add_f32 v128, v128, v255
    v_add_f32 v126, v126, v128
    v_mov_b32 v4, v126
    s_nop 1
    v_permlane32_swap_b32 v4, v126
    v_add_f32 v126, v126, v4
    v_mov_b32 v4, v126
    s_nop 1
    v_permlane16_swap_b32 v4, v126
    v_add_f32 v126, v126, v4
    v_mul_f32 v126, 0x3c4ccccd, v126
    v_sub_f32 v4, v236, v126
    v_mul_f32 v127, v4, v4
    v_sub_f32 v2, v237, v126
    v_mul_f32 v128, v2, v2
    v_sub_f32 v4, v238, v126
    v_fmac_f32 v127, v4, v4
    v_sub_f32 v2, v239, v126
    v_fmac_f32 v128, v2, v2
    v_sub_f32 v4, v240, v126
    v_fmac_f32 v127, v4, v4
    v_sub_f32 v2, v241, v126
    v_fmac_f32 v128, v2, v2
    v_sub_f32 v4, v242, v126
    v_fmac_f32 v127, v4, v4
    v_sub_f32 v2, v243, v126
    v_fmac_f32 v128, v2, v2
    v_sub_f32 v4, v244, v126
    v_fmac_f32 v127, v4, v4
    v_sub_f32 v2, v245, v126
    v_fmac_f32 v128, v2, v2
    v_sub_f32 v4, v246, v126
    v_fmac_f32 v127, v4, v4
    v_sub_f32 v2, v247, v126
    v_fmac_f32 v128, v2, v2
    v_sub_f32 v4, v248, v126
    v_fmac_f32 v127, v4, v4
    v_sub_f32 v2, v249, v126
    v_fmac_f32 v128, v2, v2
    v_sub_f32 v4, v250, v126
    v_fmac_f32 v127, v4, v4
    v_sub_f32 v2, v251, v126
    v_fmac_f32 v128, v2, v2
    v_sub_f32 v4, v252, v126
    v_fmac_f32 v127, v4, v4
    v_sub_f32 v2, v253, v126
    v_fmac_f32 v128, v2, v2
    v_sub_f32 v4, v254, v126
    v_fmac_f32 v127, v4, v4
    v_sub_f32 v2, v255, v126
    v_fmac_f32 v128, v2, v2
    v_add_f32 v127, v127, v128
    v_mov_b32 v4, v127
    s_nop 1
    v_permlane32_swap_b32 v4, v127
    v_add_f32 v127, v127, v4
    v_mov_b32 v4, v127
    s_nop 1
    v_permlane16_swap_b32 v4, v127
    v_add_f32 v127, v127, v4
    v_mov_b32 v130, v126
    v_mov_b32 v131, v127
    v_lshrrev_b32 v2, 4, v0
    v_lshlrev_b32 v3, 6, v1
    v_mov_b32 v4, 0x7f000000
    v_cmp_eq_u32 vcc, 0, v2
    s_nop 1
    v_cndmask_b32 v3, v4, v3, vcc
    s_lshl_b32 s50, s75, 10
    s_lshl_b32 s51, s59, 3
    s_add_u32 s50, s50, s51
    s_add_u32 s50, s50, 22282240
    s_cmp_eq_u32 s100, 0
    s_cbranch_scc1 L_safe_24
    buffer_store_dwordx2 v[130:131], v3, s[24:27], s50 offen
    s_branch L_join_25
L_safe_24:
    buffer_store_dwordx2 v[130:131], v3, s[24:27], s50 offen sc1
L_join_25:
    s_waitcnt vmcnt(0)
    s_lshl_b32 s48, s41, 5
    s_add_u32 s48, s48, s42
    s_lshl_b32 s48, s48, 2
    s_add_u32 s48, s48, s46
    s_lshl_b32 s48, s48, 2
    s_add_u32 s48, s48, 8192
    v_mov_b32 v1, s45
    v_mov_b32 v2, 0
    s_mov_b64 exec, 1
    s_cmp_eq_u32 s100, 0
    s_cbranch_scc1 L_safe_26
    buffer_store_dword v1, v2, s[24:27], s48 offen
    s_branch L_join_27
L_safe_26:
    buffer_store_dword v1, v2, s[24:27], s48 offen sc1
L_join_27:
    s_mov_b64 exec, -1
    v_mov_b32 v4, s57
    v_mov_b32 v5, s57
    v_mov_b32 v6, s57
    v_mov_b32 v7, s57
    s_nop 1
    v_mfma_f32_16x16x32_bf16 v[104:107], v[8:11], v[4:7], 0
    v_mfma_f32_16x16x32_bf16 v[108:111], v[12:15], v[4:7], 0
    v_mfma_f32_16x16x32_bf16 v[112:115], v[16:19], v[4:7], 0
    v_mfma_f32_16x16x32_bf16 v[104:107], v[20:23], v[4:7], v[104:107]
    v_mfma_f32_16x16x32_bf16 v[108:111], v[24:27], v[4:7], v[108:111]
    v_mfma_f32_16x16x32_bf16 v[112:115], v[28:31], v[4:7], v[112:115]
    v_mfma_f32_16x16x32_bf16 v[104:107], v[32:35], v[4:7], v[104:107]
    v_mfma_f32_16x16x32_bf16 v[108:111], v[36:39], v[4:7], v[108:111]
    v_mfma_f32_16x16x32_bf16 v[112:115], v[40:43], v[4:7], v[112:115]
    v_mfma_f32_16x16x32_bf16 v[104:107], v[44:47], v[4:7], v[104:107]
    v_mfma_f32_16x16x32_bf16 v[108:111], v[48:51], v[4:7], v[108:111]
    v_mfma_f32_16x16x32_bf16 v[112:115], v[52:55], v[4:7], v[112:115]
    v_mfma_f32_16x16x32_bf16 v[104:107], v[56:59], v[4:7], v[104:107]
    v_mfma_f32_16x16x32_bf16 v[108:111], v[60:63], v[4:7], v[108:111]
    v_mfma_f32_16x16x32_bf16 v[112:115], v[64:67], v[4:7], v[112:115]
    v_mfma_f32_16x16x32_bf16 v[104:107], v[68:71], v[4:7], v[104:107]
    v_mfma_f32_16x16x32_bf16 v[108:111], v[72:75], v[4:7], v[108:111]
    v_mfma_f32_16x16x32_bf16 v[112:115], v[76:79], v[4:7], v[112:115]
    v_mfma_f32_16x16x32_bf16 v[104:107], v[80:83], v[4:7], v[104:107]
    v_mfma_f32_16x16x32_bf16 v[108:111], v[84:87], v[4:7], v[108:111]
    v_mfma_f32_16x16x32_bf16 v[112:115], v[88:91], v[4:7], v[112:115]
    v_mfma_f32_16x16x32_bf16 v[104:107], v[92:95], v[4:7], v[104:107]
    v_mfma_f32_16x16x32_bf16 v[108:111], v[96:99], v[4:7], v[108:111]
    v_mfma_f32_16x16x32_bf16 v[112:115], v[100:103], v[4:7], v[112:115]
    s_and_b32 s53, s42, 24
    v_and_b32 v3, 7, v0
    s_lshl_b32 s54, s41, 5
    s_add_u32 s54, s54, s53
    s_lshl_b32 s54, s54, 4
    s_lshl_b32 s55, s46, 2
    s_add_u32 s54, s54, s55
    s_add_u32 s54, s54, 8192
    v_lshl_add_u32 v3, v3, 4, s54
    s_mov_b32 s56, 0
    s_nop 0
L_poll_28:
    buffer_load_dword v4, v3, s[24:27], 0 offen sc1
    s_waitcnt vmcnt(0)
    v_xor_b32 v4, s45, v4
    v_cmp_ne_u32 vcc, 0, v4
    s_nop 2
    s_cmp_eq_u64 vcc, 0
    s_nop 0
    s_cbranch_scc1 L_polldone_29
    s_add_u32 s56, s56, 1
    s_cmp_lt_u32 s56, 131072
    s_cbranch_scc0 L_polldone_29
    s_branch L_poll_28
L_polldone_29:
    v_lshlrev_b32 v3, 4, v0
    s_lshr_b32 s48, s58, 4
    s_add_u32 s48, s48, s46
    s_mul_i32 s48, s48, 20480
    s_add_u32 s48, s48, 10561536
    s_mul_i32 s49, s46, 20480
    s_add_u32 m0, s49, 92160
    s_add_u32 s50, s48, 0
    buffer_load_dwordx4 v3, s[24:27], s50 offen sc1 lds
    s_add_u32 m0, s49, 93184
    s_add_u32 s50, s48, 1024
    buffer_load_dwordx4 v3, s[24:27], s50 offen sc1 lds
    s_add_u32 m0, s49, 94208
    s_add_u32 s50, s48, 2048
    buffer_load_dwordx4 v3, s[24:27], s50 offen sc1 lds
    s_add_u32 m0, s49, 95232
    s_add_u32 s50, s48, 3072
    buffer_load_dwordx4 v3, s[24:27], s50 offen sc1 lds
    s_add_u32 m0, s49, 96256
    s_add_u32 s50, s48, 4096
    buffer_load_dwordx4 v3, s[24:27], s50 offen sc1 lds
    s_add_u32 m0, s49, 97280
    s_add_u32 s50, s48, 5120
    buffer_load_dwordx4 v3, s[24:27], s50 offen sc1 lds
    s_add_u32 m0, s49, 98304
    s_add_u32 s50, s48, 6144
    buffer_load_dwordx4 v3, s[24:27], s50 offen sc1 lds
    s_add_u32 m0, s49, 99328
    s_add_u32 s50, s48, 7168
    buffer_load_dwordx4 v3, s[24:27], s50 offen sc1 lds
    s_add_u32 m0, s49, 100352
    s_add_u32 s50, s48, 8192
    buffer_load_dwordx4 v3, s[24:27], s50 offen sc1 lds
    s_add_u32 m0, s49, 101376
    s_add_u32 s50, s48, 9216
    buffer_load_dwordx4 v3, s[24:27], s50 offen sc1 lds
    v_lshrrev_b32 v4, 4, v0
    v_lshlrev_b32 v5, 3, v4
    s_mul_i32 s50, s59, 384
    s_mul_i32 s51, s46, 96
    s_add_u32 s50, s50, s51
    buffer_load_dwordx2 v[180:181], v5, s[32:35], s50 offen offset:0
    buffer_load_dwordx2 v[182:183], v5, s[32:35], s50 offen offset:32
    buffer_load_dwordx2 v[184:185], v5, s[32:35], s50 offen offset:64
    v_add_u32 v1, 0x10000, v3
    v_add_u32 v2, 0x20000, v3
    v_and_b32 v194, 15, v0
    v_lshlrev_b32 v194, 6, v194
    s_lshl_b32 s73, s58, 6
    s_add_u32 s73, s73, 22282240
    s_waitcnt vmcnt(0)
    s_barrier
    v_add_u32 v201, 0, v0
    v_mul_u32_u24 v202, 6554, v201
    v_lshrrev_b32 v202, 16, v202
    v_mul_u32_u24 v203, 10, v202
    v_sub_u32 v201, v201, v203
    v_and_b32 v203, 3, v202
    v_mul_u32_u24 v196, 1, v203
    v_bfe_u32 v203, v202, 2, 2
    v_mad_u32_u24 v196, v203, 4, v196
    v_lshrrev_b32 v203, 4, v202
    v_mad_u32_u24 v196, v203, 16, v196
    v_mul_u32_u24 v196, 1280, v196
    v_lshl_add_u32 v196, v201, 4, v196
    v_add_u32 v201, 64, v0
    v_mul_u32_u24 v202, 6554, v201
    v_lshrrev_b32 v202, 16, v202
    v_mul_u32_u24 v203, 10, v202
    v_sub_u32 v201, v201, v203
    v_and_b32 v203, 3, v202
    v_mul_u32_u24 v197, 1, v203
    v_bfe_u32 v203, v202, 2, 2
    v_mad_u32_u24 v197, v203, 4, v197
    v_lshrrev_b32 v203, 4, v202
    v_mad_u32_u24 v197, v203, 16, v197
    v_mul_u32_u24 v197, 1280, v197
    v_lshl_add_u32 v197, v201, 4, v197
    v_add_u32 v201, 128, v0
    v_mul_u32_u24 v202, 6554, v201
    v_lshrrev_b32 v202, 16, v202
    v_mul_u32_u24 v203, 10, v202
    v_sub_u32 v201, v201, v203
    v_and_b32 v203, 3, v202
    v_mul_u32_u24 v198, 1, v203
    v_bfe_u32 v203, v202, 2, 2
    v_mad_u32_u24 v198, v203, 4, v198
    v_lshrrev_b32 v203, 4, v202
    v_mad_u32_u24 v198, v203, 16, v198
    v_mul_u32_u24 v198, 1280, v198
    v_lshl_add_u32 v198, v201, 4, v198
    v_add_u32 v201, 192, v0
    v_mul_u32_u24 v202, 6554, v201
    v_lshrrev_b32 v202, 16, v202
    v_mul_u32_u24 v203, 10, v202
    v_sub_u32 v201, v201, v203
    v_and_b32 v203, 3, v202
    v_mul_u32_u24 v199, 1, v203
    v_bfe_u32 v203, v202, 2, 2
    v_mad_u32_u24 v199, v203, 4, v199
    v_lshrrev_b32 v203, 4, v202
    v_mad_u32_u24 v199, v203, 16, v199
    v_mul_u32_u24 v199, 1280, v199
    v_lshl_add_u32 v199, v201, 4, v199
    v_add_u32 v201, 256, v0
    v_mul_u32_u24 v202, 6554, v201
    v_lshrrev_b32 v202, 16, v202
    v_mul_u32_u24 v203, 10, v202
    v_sub_u32 v201, v201, v203
    v_and_b32 v203, 3, v202
    v_mul_u32_u24 v200, 1, v203
    v_bfe_u32 v203, v202, 2, 2
    v_mad_u32_u24 v200, v203, 4, v200
    v_lshrrev_b32 v203, 4, v202
    v_mad_u32_u24 v200, v203, 16, v200
    v_mul_u32_u24 v200, 1280, v200
    v_lshl_add_u32 v200, v201, 4, v200
    s_mul_i32 s76, s59, 160
    s_mul_i32 s77, s46, 40960
    s_add_u32 s76, s76, s77
    s_mul_i32 s77, s46, 5120
    s_add_u32 s78, s76, 1146880
    s_add_u32 m0, s77, 61440
    s_nop 0
    buffer_load_dwordx4 v196, s[20:23], s78 offen lds
    s_add_u32 m0, s77, 62464
    s_nop 0
    buffer_load_dwordx4 v197, s[20:23], s78 offen lds
    s_add_u32 m0, s77, 63488
    s_nop 0
    buffer_load_dwordx4 v198, s[20:23], s78 offen lds
    s_add_u32 m0, s77, 64512
    s_nop 0
    buffer_load_dwordx4 v199, s[20:23], s78 offen lds
    s_add_u32 m0, s77, 65536
    s_nop 0
    buffer_load_dwordx4 v200, s[20:23], s78 offen lds
    ds_read_b128 v[164:167], v1 offset:28672
    ds_read_b128 v[168:171], v1 offset:49152
    ds_read_b128 v[172:175], v2 offset:4096
    ds_read_b128 v[176:179], v2 offset:24576
    s_waitcnt lgkmcnt(3)
    v_mfma_f32_16x16x32_bf16 v[116:119], v[8:11], v[164:167], 0
    v_mfma_f32_16x16x32_bf16 v[120:123], v[12:15], v[164:167], 0
    v_mfma_f32_16x16x32_bf16 v[124:127], v[16:19], v[164:167], 0
    ds_read_b128 v[164:167], v1 offset:29696
    s_waitcnt lgkmcnt(3)
    v_mfma_f32_16x16x32_bf16 v[128:131], v[8:11], v[168:171], 0
    v_mfma_f32_16x16x32_bf16 v[132:135], v[12:15], v[168:171], 0
    v_mfma_f32_16x16x32_bf16 v[136:139], v[16:19], v[168:171], 0
    ds_read_b128 v[168:171], v1 offset:50176
    s_waitcnt lgkmcnt(3)
    v_mfma_f32_16x16x32_bf16 v[140:143], v[8:11], v[172:175], 0
    v_mfma_f32_16x16x32_bf16 v[144:147], v[12:15], v[172:175], 0
    v_mfma_f32_16x16x32_bf16 v[148:151], v[16:19], v[172:175], 0
    ds_read_b128 v[172:175], v2 offset:5120
    s_waitcnt lgkmcnt(3)
    v_mfma_f32_16x16x32_bf16 v[152:155], v[8:11], v[176:179], 0
    v_mfma_f32_16x16x32_bf16 v[156:159], v[12:15], v[176:179], 0
    v_mfma_f32_16x16x32_bf16 v[160:163], v[16:19], v[176:179], 0
    ds_read_b128 v[176:179], v2 offset:25600
    s_waitcnt lgkmcnt(3)
    v_mfma_f32_16x16x32_bf16 v[116:119], v[20:23], v[164:167], v[116:119]
    v_mfma_f32_16x16x32_bf16 v[120:123], v[24:27], v[164:167], v[120:123]
    v_mfma_f32_16x16x32_bf16 v[124:127], v[28:31], v[164:167], v[124:127]
    ds_read_b128 v[164:167], v1 offset:30720
    s_waitcnt lgkmcnt(3)
    v_mfma_f32_16x16x32_bf16 v[128:131], v[20:23], v[168:171], v[128:131]
    v_mfma_f32_16x16x32_bf16 v[132:135], v[24:27], v[168:171], v[132:135]
    v_mfma_f32_16x16x32_bf16 v[136:139], v[28:31], v[168:171], v[136:139]
    ds_read_b128 v[168:171], v1 offset:51200
    s_waitcnt lgkmcnt(3)
    v_mfma_f32_16x16x32_bf16 v[140:143], v[20:23], v[172:175], v[140:143]
    v_mfma_f32_16x16x32_bf16 v[144:147], v[24:27], v[172:175], v[144:147]
    v_mfma_f32_16x16x32_bf16 v[148:151], v[28:31], v[172:175], v[148:151]
    ds_read_b128 v[172:175], v2 offset:6144
    s_waitcnt lgkmcnt(3)
    v_mfma_f32_16x16x32_bf16 v[152:155], v[20:23], v[176:179], v[152:155]
    v_mfma_f32_16x16x32_bf16 v[156:159], v[24:27], v[176:179], v[156:159]
    v_mfma_f32_16x16x32_bf16 v[160:163], v[28:31], v[176:179], v[160:163]
    ds_read_b128 v[176:179], v2 offset:26624
    buffer_load_dwordx4 v[8:11], v194, s[24:27], s73 offen offset:0 sc1
    buffer_load_dwordx4 v[12:15], v194, s[24:27], s73 offen offset:16 sc1
    buffer_load_dwordx4 v[16:19], v194, s[24:27], s73 offen offset:32 sc1
    buffer_load_dwordx4 v[20:23], v194, s[24:27], s73 offen offset:48 sc1
    s_waitcnt lgkmcnt(3)
    v_mfma_f32_16x16x32_bf16 v[116:119], v[32:35], v[164:167], v[116:119]
    v_mfma_f32_16x16x32_bf16 v[120:123], v[36:39], v[164:167], v[120:123]
    v_mfma_f32_16x16x32_bf16 v[124:127], v[40:43], v[164:167], v[124:127]
    ds_read_b128 v[164:167], v1 offset:31744
    s_waitcnt lgkmcnt(3)
    v_mfma_f32_16x16x32_bf16 v[128:131], v[32:35], v[168:171], v[128:131]
    v_mfma_f32_16x16x32_bf16 v[132:135], v[36:39], v[168:171], v[132:135]
    v_mfma_f32_16x16x32_bf16 v[136:139], v[40:43], v[168:171], v[136:139]
    ds_read_b128 v[168:171], v1 offset:52224
    s_waitcnt lgkmcnt(3)
    v_mfma_f32_16x16x32_bf16 v[140:143], v[32:35], v[172:175], v[140:143]
    v_mfma_f32_16x16x32_bf16 v[144:147], v[36:39], v[172:175], v[144:147]
    v_mfma_f32_16x16x32_bf16 v[148:151], v[40:43], v[172:175], v[148:151]
    ds_read_b128 v[172:175], v2 offset:7168
    s_waitcnt lgkmcnt(3)
    v_mfma_f32_16x16x32_bf16 v[152:155], v[32:35], v[176:179], v[152:155]
    v_mfma_f32_16x16x32_bf16 v[156:159], v[36:39], v[176:179], v[156:159]
    v_mfma_f32_16x16x32_bf16 v[160:163], v[40:43], v[176:179], v[160:163]
    ds_read_b128 v[176:179], v2 offset:27648
    s_waitcnt lgkmcnt(3)
    v_mfma_f32_16x16x32_bf16 v[116:119], v[44:47], v[164:167], v[116:119]
    v_mfma_f32_16x16x32_bf16 v[120:123], v[48:51], v[164:167], v[120:123]
    v_mfma_f32_16x16x32_bf16 v[124:127], v[52:55], v[164:167], v[124:127]
    ds_read_b128 v[164:167], v1 offset:32768
    s_waitcnt lgkmcnt(3)
    v_mfma_f32_16x16x32_bf16 v[128:131], v[44:47], v[168:171], v[128:131]
    v_mfma_f32_16x16x32_bf16 v[132:135], v[48:51], v[168:171], v[132:135]
    v_mfma_f32_16x16x32_bf16 v[136:139], v[52:55], v[168:171], v[136:139]
    ds_read_b128 v[168:171], v1 offset:53248
    s_waitcnt lgkmcnt(3)
    v_mfma_f32_16x16x32_bf16 v[140:143], v[44:47], v[172:175], v[140:143]
    v_mfma_f32_16x16x32_bf16 v[144:147], v[48:51], v[172:175], v[144:147]
    v_mfma_f32_16x16x32_bf16 v[148:151], v[52:55], v[172:175], v[148:151]
    ds_read_b128 v[172:175], v2 offset:8192
    s_waitcnt lgkmcnt(3)
    v_mfma_f32_16x16x32_bf16 v[152:155], v[44:47], v[176:179], v[152:155]
    v_mfma_f32_16x16x32_bf16 v[156:159], v[48:51], v[176:179], v[156:159]
    v_mfma_f32_16x16x32_bf16 v[160:163], v[52:55], v[176:179], v[160:163]
    ds_read_b128 v[176:179], v2 offset:28672
    s_waitcnt vmcnt(0)
    s_waitcnt lgkmcnt(3)
    v_mfma_f32_16x16x32_bf16 v[116:119], v[56:59], v[164:167], v[116:119]
    v_add_f32 v3, v8, v10
    v_add_f32 v3, v3, v12
    v_mfma_f32_16x16x32_bf16 v[120:123], v[60:63], v[164:167], v[120:123]
    v_add_f32 v3, v3, v14
    v_add_f32 v3, v3, v16
    v_mfma_f32_16x16x32_bf16 v[124:127], v[64:67], v[164:167], v[124:127]
    v_add_f32 v3, v3, v18
    v_add_f32 v3, v3, v20
    ds_read_b128 v[164:167], v1 offset:33792
    s_waitcnt lgkmcnt(3)
    v_mfma_f32_16x16x32_bf16 v[128:131], v[56:59], v[168:171], v[128:131]
    v_add_f32 v3, v3, v22
    v_mul_f32 v3, 0.125, v3
    v_mfma_f32_16x16x32_bf16 v[132:135], v[60:63], v[168:171], v[132:135]
    v_add_f32 v4, v9, v11
    v_add_f32 v4, v4, v13
    v_mfma_f32_16x16x32_bf16 v[136:139], v[64:67], v[168:171], v[136:139]
    v_add_f32 v4, v4, v15
    v_add_f32 v4, v4, v17
    ds_read_b128 v[168:171], v1 offset:54272
    s_waitcnt lgkmcnt(3)
    v_mfma_f32_16x16x32_bf16 v[140:143], v[56:59], v[172:175], v[140:143]
    v_add_f32 v4, v4, v19
    v_add_f32 v4, v4, v21
    v_mfma_f32_16x16x32_bf16 v[144:147], v[60:63], v[172:175], v[144:147]
    v_add_f32 v4, v4, v23
    v_sub_f32 v5, v8, v3
    v_mfma_f32_16x16x32_bf16 v[148:151], v[64:67], v[172:175], v[148:151]
    v_mul_f32 v6, v5, v5
    v_sub_f32 v5, v10, v3
    ds_read_b128 v[172:175], v2 offset:9216
    s_waitcnt lgkmcnt(3)
    v_mfma_f32_16x16x32_bf16 v[152:155], v[56:59], v[176:179], v[152:155]
    v_fmac_f32 v6, v5, v5
    v_sub_f32 v5, v12, v3
    v_mfma_f32_16x16x32_bf16 v[156:159], v[60:63], v[176:179], v[156:159]
    v_fmac_f32 v6, v5, v5
    v_sub_f32 v5, v14, v3
    v_mfma_f32_16x16x32_bf16 v[160:163], v[64:67], v[176:179], v[160:163]
    v_fmac_f32 v6, v5, v5
    v_sub_f32 v5, v16, v3
    ds_read_b128 v[176:179], v2 offset:29696
    s_waitcnt lgkmcnt(3)
    v_mfma_f32_16x16x32_bf16 v[116:119], v[68:71], v[164:167], v[116:119]
    v_fmac_f32 v6, v5, v5
    v_sub_f32 v5, v18, v3
    v_mfma_f32_16x16x32_bf16 v[120:123], v[72:75], v[164:167], v[120:123]
    v_fmac_f32 v6, v5, v5
    v_sub_f32 v5, v20, v3
    v_mfma_f32_16x16x32_bf16 v[124:127], v[76:79], v[164:167], v[124:127]
    v_fmac_f32 v6, v5, v5
    v_sub_f32 v5, v22, v3
    ds_read_b128 v[164:167], v1 offset:34816
    s_waitcnt lgkmcnt(3)
    v_mfma_f32_16x16x32_bf16 v[128:131], v[68:71], v[168:171], v[128:131]
    v_fmac_f32 v6, v5, v5
    v_mov_b32 v7, 0x42a00000
    v_mfma_f32_16x16x32_bf16 v[132:135], v[72:75], v[168:171], v[132:135]
    v_fmac_f32 v4, v6, v7
    v_mov_b32 v7, 0x3727c5ac
    v_mfma_f32_16x16x32_bf16 v[136:139], v[76:79], v[168:171], v[136:139]
    v_fmac_f32 v7, 0x3acccccd, v4
    v_rsq_f32 v186, v7
    ds_read_b128 v[168:171], v1 offset:55296
    s_waitcnt lgkmcnt(3)
    v_mfma_f32_16x16x32_bf16 v[140:143], v[68:71], v[172:175], v[140:143]
    v_mul_f32 v188, v3, v186
    v_sub_f32 v188, 0, v188
    v_mfma_f32_16x16x32_bf16 v[144:147], v[72:75], v[172:175], v[144:147]
    v_mfma_f32_16x16x32_bf16 v[148:151], v[76:79], v[172:175], v[148:151]
    ds_read_b128 v[172:175], v2 offset:10240
    s_waitcnt lgkmcnt(3)
    v_mfma_f32_16x16x32_bf16 v[152:155], v[68:71], v[176:179], v[152:155]
    v_mfma_f32_16x16x32_bf16 v[156:159], v[72:75], v[176:179], v[156:159]
    v_mfma_f32_16x16x32_bf16 v[160:163], v[76:79], v[176:179], v[160:163]
    ds_read_b128 v[176:179], v2 offset:30720
    buffer_load_dwordx4 v[8:11], v194, s[24:27], s73 offen offset:1024 sc1
    buffer_load_dwordx4 v[12:15], v194, s[24:27], s73 offen offset:1040 sc1
    buffer_load_dwordx4 v[16:19], v194, s[24:27], s73 offen offset:1056 sc1
    buffer_load_dwordx4 v[20:23], v194, s[24:27], s73 offen offset:1072 sc1
    s_waitcnt lgkmcnt(3)
    v_mfma_f32_16x16x32_bf16 v[116:119], v[80:83], v[164:167], v[116:119]
    v_mfma_f32_16x16x32_bf16 v[120:123], v[84:87], v[164:167], v[120:123]
    v_mfma_f32_16x16x32_bf16 v[124:127], v[88:91], v[164:167], v[124:127]
    ds_read_b128 v[164:167], v1 offset:35840
    s_waitcnt lgkmcnt(3)
    v_mfma_f32_16x16x32_bf16 v[128:131], v[80:83], v[168:171], v[128:131]
    v_mfma_f32_16x16x32_bf16 v[132:135], v[84:87], v[168:171], v[132:135]
    v_mfma_f32_16x16x32_bf16 v[136:139], v[88:91], v[168:171], v[136:139]
    ds_read_b128 v[168:171], v1 offset:56320
    s_waitcnt lgkmcnt(3)
    v_mfma_f32_16x16x32_bf16 v[140:143], v[80:83], v[172:175], v[140:143]
    v_mfma_f32_16x16x32_bf16 v[144:147], v[84:87], v[172:175], v[144:147]
    v_mfma_f32_16x16x32_bf16 v[148:151], v[88:91], v[172:175], v[148:151]
    ds_read_b128 v[172:175], v2 offset:11264
    s_waitcnt lgkmcnt(3)
    v_mfma_f32_16x16x32_bf16 v[152:155], v[80:83], v[176:179], v[152:155]
    v_mfma_f32_16x16x32_bf16 v[156:159], v[84:87], v[176:179], v[156:159]
    v_mfma_f32_16x16x32_bf16 v[160:163], v[88:91], v[176:179], v[160:163]
    ds_read_b128 v[176:179], v2 offset:31744
    s_waitcnt lgkmcnt(3)
    v_mfma_f32_16x16x32_bf16 v[116:119], v[92:95], v[164:167], v[116:119]
    v_mfma_f32_16x16x32_bf16 v[120:123], v[96:99], v[164:167], v[120:123]
    v_mfma_f32_16x16x32_bf16 v[124:127], v[100:103], v[164:167], v[124:127]
    s_waitcnt lgkmcnt(2)
    v_mfma_f32_16x16x32_bf16 v[128:131], v[92:95], v[168:171], v[128:131]
    v_mfma_f32_16x16x32_bf16 v[132:135], v[96:99], v[168:171], v[132:135]
    v_mfma_f32_16x16x32_bf16 v[136:139], v[100:103], v[168:171], v[136:139]
    s_waitcnt lgkmcnt(1)
    v_mfma_f32_16x16x32_bf16 v[140:143], v[92:95], v[172:175], v[140:143]
    v_mfma_f32_16x16x32_bf16 v[144:147], v[96:99], v[172:175], v[144:147]
    v_mfma_f32_16x16x32_bf16 v[148:151], v[100:103], v[172:175], v[148:151]
    s_waitcnt lgkmcnt(0)
    v_mfma_f32_16x16x32_bf16 v[152:155], v[92:95], v[176:179], v[152:155]
    v_mfma_f32_16x16x32_bf16 v[156:159], v[96:99], v[176:179], v[156:159]
    v_mfma_f32_16x16x32_bf16 v[160:163], v[100:103], v[176:179], v[160:163]
    s_waitcnt vmcnt(0)
    v_add_f32 v3, v8, v10
    v_add_f32 v3, v3, v12
    v_add_f32 v3, v3, v14
    v_add_f32 v3, v3, v16
    v_add_f32 v3, v3, v18
    v_add_f32 v3, v3, v20
    v_add_f32 v3, v3, v22
    v_mul_f32 v3, 0.125, v3
    v_add_f32 v4, v9, v11
    v_add_f32 v4, v4, v13
    v_add_f32 v4, v4, v15
    v_add_f32 v4, v4, v17
    v_add_f32 v4, v4, v19
    v_add_f32 v4, v4, v21
    v_add_f32 v4, v4, v23
    v_sub_f32 v5, v8, v3
    v_mul_f32 v6, v5, v5
    v_sub_f32 v5, v10, v3
    v_fmac_f32 v6, v5, v5
    v_sub_f32 v5, v12, v3
    v_fmac_f32 v6, v5, v5
    v_sub_f32 v5, v14, v3
    v_fmac_f32 v6, v5, v5
    v_sub_f32 v5, v16, v3
    v_fmac_f32 v6, v5, v5
    v_sub_f32 v5, v18, v3
    v_fmac_f32 v6, v5, v5
    v_sub_f32 v5, v20, v3
    v_fmac_f32 v6, v5, v5
    v_sub_f32 v5, v22, v3
    v_fmac_f32 v6, v5, v5
    v_mov_b32 v7, 0x42a00000
    v_fmac_f32 v4, v6, v7
    v_mov_b32 v7, 0x3727c5ac
    v_fmac_f32 v7, 0x3acccccd, v4
    v_rsq_f32 v190, v7
    s_nop 0
    v_mul_f32 v192, v3, v190
    v_sub_f32 v192, 0, v192
    s_cmp_lg_u32 s42, 0
    s_nop 0
    s_cbranch_scc1 L_nowb_30
    s_cmp_lg_u32 s40, 3
    s_cbranch_scc1 L_nowb_30
    buffer_wbl2 sc1
L_nowb_30:
    s_barrier
    v_lshlrev_b32 v3, 4, v0
    s_mul_i32 s48, s46, 18432
    s_add_u32 s48, s48, 81920
    v_add_u32 v195, s48, v3
    v_add_u32 v196, 9216, v195
    ds_write_b128 v195, v[140:143] offset:0
    ds_write_b128 v195, v[144:147] offset:1024
    ds_write_b128 v195, v[148:151] offset:2048
    ds_write_b128 v195, v[152:155] offset:3072
    ds_write_b128 v195, v[156:159] offset:4096
    ds_write_b128 v195, v[160:163] offset:5120
    ds_write_b128 v195, v[104:107] offset:6144
    ds_write_b128 v195, v[108:111] offset:7168
    ds_write_b128 v195, v[112:115] offset:8192
    s_waitcnt lgkmcnt(0)
    s_barrier
    ds_read_b128 v[140:143], v196 offset:0
    ds_read_b128 v[144:147], v196 offset:1024
    ds_read_b128 v[148:151], v196 offset:2048
    ds_read_b128 v[152:155], v196 offset:3072
    ds_read_b128 v[156:159], v196 offset:4096
    ds_read_b128 v[160:163], v196 offset:5120
    ds_read_b128 v[164:167], v196 offset:6144
    ds_read_b128 v[168:171], v196 offset:7168
    ds_read_b128 v[172:175], v196 offset:8192
    v_lshlrev_b32 v24, 16, v180
    v_and_b32 v25, 0xffff0000, v180
    v_lshlrev_b32 v26, 16, v181
    v_and_b32 v27, 0xffff0000, v181
    v_lshlrev_b32 v28, 16, v182
    v_and_b32 v29, 0xffff0000, v182
    v_lshlrev_b32 v30, 16, v183
    v_and_b32 v31, 0xffff0000, v183
    v_lshlrev_b32 v32, 16, v184
    v_and_b32 v33, 0xffff0000, v184
    v_lshlrev_b32 v34, 16, v185
    v_and_b32 v35, 0xffff0000, v185
    s_waitcnt lgkmcnt(0)
    s_barrier
    v_pk_add_f32 v[104:105], v[104:105], v[164:165]
    v_pk_add_f32 v[106:107], v[106:107], v[166:167]
    v_pk_add_f32 v[108:109], v[108:109], v[168:169]
    v_pk_add_f32 v[110:111], v[110:111], v[170:171]
    v_pk_add_f32 v[112:113], v[112:113], v[172:173]
    v_pk_add_f32 v[114:115], v[114:115], v[174:175]
    v_pk_add_f32 v[116:117], v[116:117], v[140:141]
    v_pk_add_f32 v[118:119], v[118:119], v[142:143]
    v_pk_add_f32 v[120:121], v[120:121], v[144:145]
    v_pk_add_f32 v[122:123], v[122:123], v[146:147]
    v_pk_add_f32 v[124:125], v[124:125], v[148:149]
    v_pk_add_f32 v[126:127], v[126:127], v[150:151]
    v_pk_add_f32 v[128:129], v[128:129], v[152:153]
    v_pk_add_f32 v[130:131], v[130:131], v[154:155]
    v_pk_add_f32 v[132:133], v[132:133], v[156:157]
    v_pk_add_f32 v[134:135], v[134:135], v[158:159]
    v_pk_add_f32 v[136:137], v[136:137], v[160:161]
    v_pk_add_f32 v[138:139], v[138:139], v[162:163]
    s_mov_b32 s70, 0xbdd2d3e8
    s_mov_b32 s71, 0xbdd2d3e8
    v_mov_b32 v198, 0xc0135761
    v_mov_b32 v199, 0xc0135761
    v_pk_fma_f32 v[8:9], v[104:105], v[188:189], v[24:25] op_sel_hi:[1,0,1]
    v_pk_fma_f32 v[10:11], v[106:107], v[188:189], v[26:27] op_sel_hi:[1,0,1]
    v_pk_fma_f32 v[116:117], v[116:117], v[186:187], v[8:9] op_sel_hi:[1,0,1]
    v_pk_fma_f32 v[118:119], v[118:119], v[186:187], v[10:11] op_sel_hi:[1,0,1]
    v_pk_mul_f32 v[8:9], v[116:117], v[116:117]
    v_pk_mul_f32 v[10:11], v[118:119], v[118:119]
    v_pk_fma_f32 v[8:9], v[8:9], s[70:71], v[198:199]
    v_pk_fma_f32 v[10:11], v[10:11], s[70:71], v[198:199]
    v_pk_mul_f32 v[8:9], v[8:9], v[116:117]
    v_pk_mul_f32 v[10:11], v[10:11], v[118:119]
    v_exp_f32 v8, v8
    v_exp_f32 v9, v9
    v_exp_f32 v10, v10
    v_exp_f32 v11, v11
    v_pk_add_f32 v[8:9], v[8:9], 1.0 op_sel_hi:[1,0]
    v_pk_add_f32 v[10:11], v[10:11], 1.0 op_sel_hi:[1,0]
    v_rcp_f32 v8, v8
    v_rcp_f32 v9, v9
    v_rcp_f32 v10, v10
    v_rcp_f32 v11, v11
    v_pk_mul_f32 v[116:117], v[116:117], v[8:9]
    v_pk_mul_f32 v[118:119], v[118:119], v[10:11]
    v_cvt_pk_bf16_f32 v140, v116, v117
    v_cvt_pk_bf16_f32 v141, v118, v119
    v_pk_fma_f32 v[12:13], v[104:105], v[192:193], v[24:25] op_sel_hi:[1,0,1]
    v_pk_fma_f32 v[14:15], v[106:107], v[192:193], v[26:27] op_sel_hi:[1,0,1]
    v_pk_fma_f32 v[128:129], v[128:129], v[190:191], v[12:13] op_sel_hi:[1,0,1]
    v_pk_fma_f32 v[130:131], v[130:131], v[190:191], v[14:15] op_sel_hi:[1,0,1]
    v_pk_mul_f32 v[12:13], v[128:129], v[128:129]
    v_pk_mul_f32 v[14:15], v[130:131], v[130:131]
    v_pk_fma_f32 v[12:13], v[12:13], s[70:71], v[198:199]
    v_pk_fma_f32 v[14:15], v[14:15], s[70:71], v[198:199]
    v_pk_mul_f32 v[12:13], v[12:13], v[128:129]
    v_pk_mul_f32 v[14:15], v[14:15], v[130:131]
    v_exp_f32 v12, v12
    v_exp_f32 v13, v13
    v_exp_f32 v14, v14
    v_exp_f32 v15, v15
    v_pk_add_f32 v[12:13], v[12:13], 1.0 op_sel_hi:[1,0]
    v_pk_add_f32 v[14:15], v[14:15], 1.0 op_sel_hi:[1,0]
    v_rcp_f32 v12, v12
    v_rcp_f32 v13, v13
    v_rcp_f32 v14, v14
    v_rcp_f32 v15, v15
    v_pk_mul_f32 v[128:129], v[128:129], v[12:13]
    v_pk_mul_f32 v[130:131], v[130:131], v[14:15]
    v_cvt_pk_bf16_f32 v144, v128, v129
    v_cvt_pk_bf16_f32 v145, v130, v131
    v_pk_fma_f32 v[8:9], v[108:109], v[188:189], v[28:29] op_sel_hi:[1,0,1]
    v_pk_fma_f32 v[10:11], v[110:111], v[188:189], v[30:31] op_sel_hi:[1,0,1]
    v_pk_fma_f32 v[120:121], v[120:121], v[186:187], v[8:9] op_sel_hi:[1,0,1]
    v_pk_fma_f32 v[122:123], v[122:123], v[186:187], v[10:11] op_sel_hi:[1,0,1]
    v_pk_mul_f32 v[8:9], v[120:121], v[120:121]
    v_pk_mul_f32 v[10:11], v[122:123], v[122:123]
    v_pk_fma_f32 v[8:9], v[8:9], s[70:71], v[198:199]
    v_pk_fma_f32 v[10:11], v[10:11], s[70:71], v[198:199]
    v_pk_mul_f32 v[8:9], v[8:9], v[120:121]
    v_pk_mul_f32 v[10:11], v[10:11], v[122:123]
    v_exp_f32 v8, v8
    v_exp_f32 v9, v9
    v_exp_f32 v10, v10
    v_exp_f32 v11, v11
    v_pk_add_f32 v[8:9], v[8:9], 1.0 op_sel_hi:[1,0]
    v_pk_add_f32 v[10:11], v[10:11], 1.0 op_sel_hi:[1,0]
    v_rcp_f32 v8, v8
    v_rcp_f32 v9, v9
    v_rcp_f32 v10, v10
    v_rcp_f32 v11, v11
    v_pk_mul_f32 v[120:121], v[120:121], v[8:9]
    v_pk_mul_f32 v[122:123], v[122:123], v[10:11]
    v_cvt_pk_bf16_f32 v148, v120, v121
    v_cvt_pk_bf16_f32 v149, v122, v123
    v_pk_fma_f32 v[12:13], v[108:109], v[192:193], v[28:29] op_sel_hi:[1,0,1]
    v_pk_fma_f32 v[14:15], v[110:111], v[192:193], v[30:31] op_sel_hi:[1,0,1]
    v_pk_fma_f32 v[132:133], v[132:133], v[190:191], v[12:13] op_sel_hi:[1,0,1]
    v_pk_fma_f32 v[134:135], v[134:135], v[190:191], v[14:15] op_sel_hi:[1,0,1]
    v_pk_mul_f32 v[12:13], v[132:133], v[132:133]
    v_pk_mul_f32 v[14:15], v[134:135], v[134:135]
    v_pk_fma_f32 v[12:13], v[12:13], s[70:71], v[198:199]
    v_pk_fma_f32 v[14:15], v[14:15], s[70:71], v[198:199]
    v_pk_mul_f32 v[12:13], v[12:13], v[132:133]
    v_pk_mul_f32 v[14:15], v[14:15], v[134:135]
    v_exp_f32 v12, v12
    v_exp_f32 v13, v13
    v_exp_f32 v14, v14
    v_exp_f32 v15, v15
    v_pk_add_f32 v[12:13], v[12:13], 1.0 op_sel_hi:[1,0]
    v_pk_add_f32 v[14:15], v[14:15], 1.0 op_sel_hi:[1,0]
    v_rcp_f32 v12, v12
    v_rcp_f32 v13, v13
    v_rcp_f32 v14, v14
    v_rcp_f32 v15, v15
    v_pk_mul_f32 v[132:133], v[132:133], v[12:13]
    v_pk_mul_f32 v[134:135], v[134:135], v[14:15]
    v_cvt_pk_bf16_f32 v152, v132, v133
    v_cvt_pk_bf16_f32 v153, v134, v135
    v_pk_fma_f32 v[8:9], v[112:113], v[188:189], v[32:33] op_sel_hi:[1,0,1]
    v_pk_fma_f32 v[10:11], v[114:115], v[188:189], v[34:35] op_sel_hi:[1,0,1]
    v_pk_fma_f32 v[124:125], v[124:125], v[186:187], v[8:9] op_sel_hi:[1,0,1]
    v_pk_fma_f32 v[126:127], v[126:127], v[186:187], v[10:11] op_sel_hi:[1,0,1]
    v_pk_mul_f32 v[8:9], v[124:125], v[124:125]
    v_pk_mul_f32 v[10:11], v[126:127], v[126:127]
    v_pk_fma_f32 v[8:9], v[8:9], s[70:71], v[198:199]
    v_pk_fma_f32 v[10:11], v[10:11], s[70:71], v[198:199]
    v_pk_mul_f32 v[8:9], v[8:9], v[124:125]
    v_pk_mul_f32 v[10:11], v[10:11], v[126:127]
    v_exp_f32 v8, v8
    v_exp_f32 v9, v9
    v_exp_f32 v10, v10
    v_exp_f32 v11, v11
    v_pk_add_f32 v[8:9], v[8:9], 1.0 op_sel_hi:[1,0]
    v_pk_add_f32 v[10:11], v[10:11], 1.0 op_sel_hi:[1,0]
    v_rcp_f32 v8, v8
    v_rcp_f32 v9, v9
    v_rcp_f32 v10, v10
    v_rcp_f32 v11, v11
    v_pk_mul_f32 v[124:125], v[124:125], v[8:9]
    v_pk_mul_f32 v[126:127], v[126:127], v[10:11]
    v_cvt_pk_bf16_f32 v156, v124, v125
    v_cvt_pk_bf16_f32 v157, v126, v127
    v_pk_fma_f32 v[12:13], v[112:113], v[192:193], v[32:33] op_sel_hi:[1,0,1]
    v_pk_fma_f32 v[14:15], v[114:115], v[192:193], v[34:35] op_sel_hi:[1,0,1]
    v_pk_fma_f32 v[136:137], v[136:137], v[190:191], v[12:13] op_sel_hi:[1,0,1]
    v_pk_fma_f32 v[138:139], v[138:139], v[190:191], v[14:15] op_sel_hi:[1,0,1]
    v_pk_mul_f32 v[12:13], v[136:137], v[136:137]
    v_pk_mul_f32 v[14:15], v[138:139], v[138:139]
    v_pk_fma_f32 v[12:13], v[12:13], s[70:71], v[198:199]
    v_pk_fma_f32 v[14:15], v[14:15], s[70:71], v[198:199]
    v_pk_mul_f32 v[12:13], v[12:13], v[136:137]
    v_pk_mul_f32 v[14:15], v[14:15], v[138:139]
    v_exp_f32 v12, v12
    v_exp_f32 v13, v13
    v_exp_f32 v14, v14
    v_exp_f32 v15, v15
    v_pk_add_f32 v[12:13], v[12:13], 1.0 op_sel_hi:[1,0]
    v_pk_add_f32 v[14:15], v[14:15], 1.0 op_sel_hi:[1,0]
    v_rcp_f32 v12, v12
    v_rcp_f32 v13, v13
    v_rcp_f32 v14, v14
    v_rcp_f32 v15, v15
    v_pk_mul_f32 v[136:137], v[136:137], v[12:13]
    v_pk_mul_f32 v[138:139], v[138:139], v[14:15]
    v_cvt_pk_bf16_f32 v160, v136, v137
    v_cvt_pk_bf16_f32 v161, v138, v139
    v_and_b32 v3, 15, v0
    v_lshrrev_b32 v4, 4, v0
    v_lshlrev_b32 v5, 8, v4
    v_lshl_add_u32 v5, v3, 4, v5
    s_lshr_b32 s50, s58, 4
    s_mul_i32 s50, s50, 49152
    s_add_u32 s50, s50, 13172736
    s_mul_i32 s51, s59, 12
    s_mul_i32 s52, s46, 3
    s_add_u32 s51, s51, s52
    s_cmp_eq_u32 s100, 0
    s_cbranch_scc1 L_safe_31
    s_add_u32 s52, s51, 0
    s_lshr_b32 s53, s52, 1
    s_lshl_b32 s53, s53, 10
    s_and_b32 s52, s52, 1
    s_lshl_b32 s52, s52, 3
    s_add_u32 s53, s53, s52
    s_add_u32 s53, s53, s50
    s_add_u32 s52, s53, 0
    buffer_store_dwordx2 v[140:141], v5, s[24:27], s52 offen
    s_add_u32 s52, s53, 49152
    buffer_store_dwordx2 v[144:145], v5, s[24:27], s52 offen
    s_add_u32 s52, s51, 1
    s_lshr_b32 s53, s52, 1
    s_lshl_b32 s53, s53, 10
    s_and_b32 s52, s52, 1
    s_lshl_b32 s52, s52, 3
    s_add_u32 s53, s53, s52
    s_add_u32 s53, s53, s50
    s_add_u32 s52, s53, 0
    buffer_store_dwordx2 v[148:149], v5, s[24:27], s52 offen
    s_add_u32 s52, s53, 49152
    buffer_store_dwordx2 v[152:153], v5, s[24:27], s52 offen
    s_add_u32 s52, s51, 2
    s_lshr_b32 s53, s52, 1
    s_lshl_b32 s53, s53, 10
    s_and_b32 s52, s52, 1
    s_lshl_b32 s52, s52, 3
    s_add_u32 s53, s53, s52
    s_add_u32 s53, s53, s50
    s_add_u32 s52, s53, 0
    buffer_store_dwordx2 v[156:157], v5, s[24:27], s52 offen
    s_add_u32 s52, s53, 49152
    buffer_store_dwordx2 v[160:161], v5, s[24:27], s52 offen
    s_branch L_join_32
L_safe_31:
    s_add_u32 s52, s51, 0
    s_lshr_b32 s53, s52, 1
    s_lshl_b32 s53, s53, 10
    s_and_b32 s52, s52, 1
    s_lshl_b32 s52, s52, 3
    s_add_u32 s53, s53, s52
    s_add_u32 s53, s53, s50
    s_add_u32 s52, s53, 0
    buffer_store_dwordx2 v[140:141], v5, s[24:27], s52 offen sc1
    s_add_u32 s52, s53, 49152
    buffer_store_dwordx2 v[144:145], v5, s[24:27], s52 offen sc1
    s_add_u32 s52, s51, 1
    s_lshr_b32 s53, s52, 1
    s_lshl_b32 s53, s53, 10
    s_and_b32 s52, s52, 1
    s_lshl_b32 s52, s52, 3
    s_add_u32 s53, s53, s52
    s_add_u32 s53, s53, s50
    s_add_u32 s52, s53, 0
    buffer_store_dwordx2 v[148:149], v5, s[24:27], s52 offen sc1
    s_add_u32 s52, s53, 49152
    buffer_store_dwordx2 v[152:153], v5, s[24:27], s52 offen sc1
    s_add_u32 s52, s51, 2
    s_lshr_b32 s53, s52, 1
    s_lshl_b32 s53, s53, 10
    s_and_b32 s52, s52, 1
    s_lshl_b32 s52, s52, 3
    s_add_u32 s53, s53, s52
    s_add_u32 s53, s53, s50
    s_add_u32 s52, s53, 0
    buffer_store_dwordx2 v[156:157], v5, s[24:27], s52 offen sc1
    s_add_u32 s52, s53, 49152
    buffer_store_dwordx2 v[160:161], v5, s[24:27], s52 offen sc1
L_join_32:
    s_waitcnt vmcnt(0)
    s_lshl_b32 s48, s41, 5
    s_add_u32 s48, s48, s42
    s_lshl_b32 s48, s48, 3
    s_add_u32 s48, s48, s40
    s_lshl_b32 s48, s48, 2
    s_add_u32 s48, s48, 32768
    v_mov_b32 v3, s45
    v_mov_b32 v4, 0
    s_mov_b64 exec, 1
    s_cmp_eq_u32 s100, 0
    s_cbranch_scc1 L_safe_33
    buffer_store_dword v3, v4, s[24:27], s48 offen
    s_branch L_join_34
L_safe_33:
    buffer_store_dword v3, v4, s[24:27], s48 offen sc1
L_join_34:
    s_mov_b64 exec, -1
    v_lshlrev_b32 v158, 4, v0
    s_and_b32 s68, s40, 1
    v_lshrrev_b32 v159, 4, v0
    v_bfe_u32 v160, v0, 2, 2
    v_lshl_add_u32 v159, v159, 2, v160
    v_mul_u32_u24 v159, 160, v159
    v_and_b32 v160, 3, v0
    v_lshl_add_u32 v162, v160, 3, v159
    s_and_b32 s50, s75, 0xfffffffe
    s_mul_i32 s50, s50, 49152
    s_mul_i32 s51, s68, 24576
    s_add_u32 s50, s50, s51
    s_add_u32 s50, s50, 13172736
    s_add_u32 s69, s50, 49152
    v_lshrrev_b32 v160, 4, v0
    v_lshlrev_b32 v161, 3, v160
    s_mul_i32 s51, s59, 160
    buffer_load_dwordx2 v[148:149], v161, s[36:39], s51 offen offset:0
    buffer_load_dwordx2 v[150:151], v161, s[36:39], s51 offen offset:32
    buffer_load_dwordx2 v[152:153], v161, s[36:39], s51 offen offset:64
    buffer_load_dwordx2 v[154:155], v161, s[36:39], s51 offen offset:96
    buffer_load_dwordx2 v[156:157], v161, s[36:39], s51 offen offset:128
    s_and_b32 s49, s42, 24
    v_and_b32 v159, 7, v0
    s_lshl_b32 s54, s41, 5
    s_add_u32 s54, s54, s49
    s_lshl_b32 s54, s54, 5
    s_add_u32 s54, s54, 32768
    v_lshl_add_u32 v159, v159, 5, s54
    v_bfe_u32 v160, v0, 3, 3
    v_lshl_add_u32 v159, v160, 2, v159
    s_mov_b32 s56, 0
    s_nop 0
L_poll_35:
    buffer_load_dword v160, v159, s[24:27], 0 offen sc1
    s_waitcnt vmcnt(0)
    v_xor_b32 v160, s45, v160
    v_cmp_ne_u32 vcc, 0, v160
    s_nop 2
    s_cmp_eq_u64 vcc, 0
    s_nop 0
    s_cbranch_scc1 L_polldone_36
    s_add_u32 s56, s56, 1
    s_cmp_lt_u32 s56, 131072
    s_cbranch_scc0 L_polldone_36
    s_branch L_poll_35
L_polldone_36:
    s_add_u32 s52, s50, 0
    buffer_load_dwordx4 v[4:7], v158, s[24:27], s52 offen offset:0 sc1
    s_add_u32 s52, s69, 0
    buffer_load_dwordx4 v[8:11], v158, s[24:27], s52 offen offset:0 sc1
    s_add_u32 s52, s50, 0
    buffer_load_dwordx4 v[12:15], v158, s[24:27], s52 offen offset:1024 sc1
    s_add_u32 s52, s69, 0
    buffer_load_dwordx4 v[16:19], v158, s[24:27], s52 offen offset:1024 sc1
    s_add_u32 s52, s50, 0
    buffer_load_dwordx4 v[20:23], v158, s[24:27], s52 offen offset:2048 sc1
    s_add_u32 s52, s69, 0
    buffer_load_dwordx4 v[24:27], v158, s[24:27], s52 offen offset:2048 sc1
    s_add_u32 s52, s50, 0
    buffer_load_dwordx4 v[28:31], v158, s[24:27], s52 offen offset:3072 sc1
    s_add_u32 s52, s69, 0
    buffer_load_dwordx4 v[32:35], v158, s[24:27], s52 offen offset:3072 sc1
    s_add_u32 s52, s50, 4096
    buffer_load_dwordx4 v[36:39], v158, s[24:27], s52 offen offset:0 sc1
    s_add_u32 s52, s69, 4096
    buffer_load_dwordx4 v[40:43], v158, s[24:27], s52 offen offset:0 sc1
    s_add_u32 s52, s50, 4096
    buffer_load_dwordx4 v[44:47], v158, s[24:27], s52 offen offset:1024 sc1
    s_add_u32 s52, s69, 4096
    buffer_load_dwordx4 v[48:51], v158, s[24:27], s52 offen offset:1024 sc1
    s_cmp_eq_u32 s68, 0
    s_cselect_b32 s51, 0, 20480
    v_add_u32 v1, s51, v162
    ds_read_b64_tr_b16 v[108:109], v1 offset:0
    ds_read_b64_tr_b16 v[110:111], v1 offset:2560
    ds_read_b64_tr_b16 v[112:113], v1 offset:32
    ds_read_b64_tr_b16 v[114:115], v1 offset:2592
    ds_read_b64_tr_b16 v[116:117], v1 offset:64
    ds_read_b64_tr_b16 v[118:119], v1 offset:2624
    ds_read_b64_tr_b16 v[120:121], v1 offset:96
    ds_read_b64_tr_b16 v[122:123], v1 offset:2656
    ds_read_b64_tr_b16 v[124:125], v1 offset:128
    ds_read_b64_tr_b16 v[126:127], v1 offset:2688
    s_waitcnt vmcnt(10) lgkmcnt(0)
    v_mfma_f32_16x16x32_bf16 v[68:71], v[108:111], v[4:7], 0
    ds_read_b64_tr_b16 v[128:129], v1 offset:5120
    v_mfma_f32_16x16x32_bf16 v[88:91], v[108:111], v[8:11], 0
    ds_read_b64_tr_b16 v[130:131], v1 offset:7680
    v_mfma_f32_16x16x32_bf16 v[72:75], v[112:115], v[4:7], 0
    ds_read_b64_tr_b16 v[132:133], v1 offset:5152
    v_mfma_f32_16x16x32_bf16 v[92:95], v[112:115], v[8:11], 0
    ds_read_b64_tr_b16 v[134:135], v1 offset:7712
    v_mfma_f32_16x16x32_bf16 v[76:79], v[116:119], v[4:7], 0
    ds_read_b64_tr_b16 v[136:137], v1 offset:5184
    v_mfma_f32_16x16x32_bf16 v[96:99], v[116:119], v[8:11], 0
    ds_read_b64_tr_b16 v[138:139], v1 offset:7744
    v_mfma_f32_16x16x32_bf16 v[80:83], v[120:123], v[4:7], 0
    ds_read_b64_tr_b16 v[140:141], v1 offset:5216
    v_mfma_f32_16x16x32_bf16 v[100:103], v[120:123], v[8:11], 0
    ds_read_b64_tr_b16 v[142:143], v1 offset:7776
    v_mfma_f32_16x16x32_bf16 v[84:87], v[124:127], v[4:7], 0
    ds_read_b64_tr_b16 v[144:145], v1 offset:5248
    v_mfma_f32_16x16x32_bf16 v[104:107], v[124:127], v[8:11], 0
    ds_read_b64_tr_b16 v[146:147], v1 offset:7808
    s_add_u32 s52, s50, 4096
    buffer_load_dwordx4 v[52:55], v158, s[24:27], s52 offen offset:2048 sc1
    s_add_u32 s52, s69, 4096
    buffer_load_dwordx4 v[56:59], v158, s[24:27], s52 offen offset:2048 sc1
    s_waitcnt vmcnt(10) lgkmcnt(0)
    v_mfma_f32_16x16x32_bf16 v[68:71], v[128:131], v[12:15], v[68:71]
    ds_read_b64_tr_b16 v[108:109], v1 offset:10240
    v_mfma_f32_16x16x32_bf16 v[88:91], v[128:131], v[16:19], v[88:91]
    ds_read_b64_tr_b16 v[110:111], v1 offset:12800
    v_mfma_f32_16x16x32_bf16 v[72:75], v[132:135], v[12:15], v[72:75]
    ds_read_b64_tr_b16 v[112:113], v1 offset:10272
    v_mfma_f32_16x16x32_bf16 v[92:95], v[132:135], v[16:19], v[92:95]
    ds_read_b64_tr_b16 v[114:115], v1 offset:12832
    v_mfma_f32_16x16x32_bf16 v[76:79], v[136:139], v[12:15], v[76:79]
    ds_read_b64_tr_b16 v[116:117], v1 offset:10304
    v_mfma_f32_16x16x32_bf16 v[96:99], v[136:139], v[16:19], v[96:99]
    ds_read_b64_tr_b16 v[118:119], v1 offset:12864
    v_mfma_f32_16x16x32_bf16 v[80:83], v[140:143], v[12:15], v[80:83]
    ds_read_b64_tr_b16 v[120:121], v1 offset:10336
    v_mfma_f32_16x16x32_bf16 v[100:103], v[140:143], v[16:19], v[100:103]
    ds_read_b64_tr_b16 v[122:123], v1 offset:12896
    v_mfma_f32_16x16x32_bf16 v[84:87], v[144:147], v[12:15], v[84:87]
    ds_read_b64_tr_b16 v[124:125], v1 offset:10368
    v_mfma_f32_16x16x32_bf16 v[104:107], v[144:147], v[16:19], v[104:107]
    ds_read_b64_tr_b16 v[126:127], v1 offset:12928
    s_add_u32 s52, s50, 4096
    buffer_load_dwordx4 v[60:63], v158, s[24:27], s52 offen offset:3072 sc1
    s_add_u32 s52, s69, 4096
    buffer_load_dwordx4 v[64:67], v158, s[24:27], s52 offen offset:3072 sc1
    s_waitcnt vmcnt(10) lgkmcnt(0)
    v_mfma_f32_16x16x32_bf16 v[68:71], v[108:111], v[20:23], v[68:71]
    ds_read_b64_tr_b16 v[128:129], v1 offset:15360
    v_mfma_f32_16x16x32_bf16 v[88:91], v[108:111], v[24:27], v[88:91]
    ds_read_b64_tr_b16 v[130:131], v1 offset:17920
    v_mfma_f32_16x16x32_bf16 v[72:75], v[112:115], v[20:23], v[72:75]
    ds_read_b64_tr_b16 v[132:133], v1 offset:15392
    v_mfma_f32_16x16x32_bf16 v[92:95], v[112:115], v[24:27], v[92:95]
    ds_read_b64_tr_b16 v[134:135], v1 offset:17952
    v_mfma_f32_16x16x32_bf16 v[76:79], v[116:119], v[20:23], v[76:79]
    ds_read_b64_tr_b16 v[136:137], v1 offset:15424
    v_mfma_f32_16x16x32_bf16 v[96:99], v[116:119], v[24:27], v[96:99]
    ds_read_b64_tr_b16 v[138:139], v1 offset:17984
    v_mfma_f32_16x16x32_bf16 v[80:83], v[120:123], v[20:23], v[80:83]
    ds_read_b64_tr_b16 v[140:141], v1 offset:15456
    v_mfma_f32_16x16x32_bf16 v[100:103], v[120:123], v[24:27], v[100:103]
    ds_read_b64_tr_b16 v[142:143], v1 offset:18016
    v_mfma_f32_16x16x32_bf16 v[84:87], v[124:127], v[20:23], v[84:87]
    ds_read_b64_tr_b16 v[144:145], v1 offset:15488
    v_mfma_f32_16x16x32_bf16 v[104:107], v[124:127], v[24:27], v[104:107]
    ds_read_b64_tr_b16 v[146:147], v1 offset:18048
    s_add_u32 s52, s50, 8192
    buffer_load_dwordx4 v[4:7], v158, s[24:27], s52 offen offset:0 sc1
    s_add_u32 s52, s69, 8192
    buffer_load_dwordx4 v[8:11], v158, s[24:27], s52 offen offset:0 sc1
    s_waitcnt vmcnt(10) lgkmcnt(0)
    v_mov_b32 v159, 155712
    v_mov_b32 v160, 1
    s_mov_b64 exec, 1
    ds_add_u32 v159, v160
    s_mov_b64 exec, -1
    s_cmp_eq_u32 s68, 0
    s_mov_b32 s51, 61440
    s_cselect_b32 s51, 40960, s51
    v_add_u32 v2, s51, v162
    v_mfma_f32_16x16x32_bf16 v[68:71], v[128:131], v[28:31], v[68:71]
    ds_read_b64_tr_b16 v[108:109], v2 offset:0
    v_mfma_f32_16x16x32_bf16 v[88:91], v[128:131], v[32:35], v[88:91]
    ds_read_b64_tr_b16 v[110:111], v2 offset:2560
    v_mfma_f32_16x16x32_bf16 v[72:75], v[132:135], v[28:31], v[72:75]
    ds_read_b64_tr_b16 v[112:113], v2 offset:32
    v_mfma_f32_16x16x32_bf16 v[92:95], v[132:135], v[32:35], v[92:95]
    ds_read_b64_tr_b16 v[114:115], v2 offset:2592
    v_mfma_f32_16x16x32_bf16 v[76:79], v[136:139], v[28:31], v[76:79]
    ds_read_b64_tr_b16 v[116:117], v2 offset:64
    v_mfma_f32_16x16x32_bf16 v[96:99], v[136:139], v[32:35], v[96:99]
    ds_read_b64_tr_b16 v[118:119], v2 offset:2624
    v_mfma_f32_16x16x32_bf16 v[80:83], v[140:143], v[28:31], v[80:83]
    ds_read_b64_tr_b16 v[120:121], v2 offset:96
    v_mfma_f32_16x16x32_bf16 v[100:103], v[140:143], v[32:35], v[100:103]
    ds_read_b64_tr_b16 v[122:123], v2 offset:2656
    v_mfma_f32_16x16x32_bf16 v[84:87], v[144:147], v[28:31], v[84:87]
    ds_read_b64_tr_b16 v[124:125], v2 offset:128
    v_mfma_f32_16x16x32_bf16 v[104:107], v[144:147], v[32:35], v[104:107]
    ds_read_b64_tr_b16 v[126:127], v2 offset:2688
    s_add_u32 s52, s50, 8192
    buffer_load_dwordx4 v[12:15], v158, s[24:27], s52 offen offset:1024 sc1
    s_add_u32 s52, s69, 8192
    buffer_load_dwordx4 v[16:19], v158, s[24:27], s52 offen offset:1024 sc1
    s_waitcnt vmcnt(10) lgkmcnt(0)
    v_mfma_f32_16x16x32_bf16 v[68:71], v[108:111], v[36:39], v[68:71]
    ds_read_b64_tr_b16 v[128:129], v2 offset:5120
    v_mfma_f32_16x16x32_bf16 v[88:91], v[108:111], v[40:43], v[88:91]
    ds_read_b64_tr_b16 v[130:131], v2 offset:7680
    v_mfma_f32_16x16x32_bf16 v[72:75], v[112:115], v[36:39], v[72:75]
    ds_read_b64_tr_b16 v[132:133], v2 offset:5152
    v_mfma_f32_16x16x32_bf16 v[92:95], v[112:115], v[40:43], v[92:95]
    ds_read_b64_tr_b16 v[134:135], v2 offset:7712
    v_mfma_f32_16x16x32_bf16 v[76:79], v[116:119], v[36:39], v[76:79]
    ds_read_b64_tr_b16 v[136:137], v2 offset:5184
    v_mfma_f32_16x16x32_bf16 v[96:99], v[116:119], v[40:43], v[96:99]
    ds_read_b64_tr_b16 v[138:139], v2 offset:7744
    v_mfma_f32_16x16x32_bf16 v[80:83], v[120:123], v[36:39], v[80:83]
    ds_read_b64_tr_b16 v[140:141], v2 offset:5216
    v_mfma_f32_16x16x32_bf16 v[100:103], v[120:123], v[40:43], v[100:103]
    ds_read_b64_tr_b16 v[142:143], v2 offset:7776
    v_mfma_f32_16x16x32_bf16 v[84:87], v[124:127], v[36:39], v[84:87]
    ds_read_b64_tr_b16 v[144:145], v2 offset:5248
    v_mfma_f32_16x16x32_bf16 v[104:107], v[124:127], v[40:43], v[104:107]
    ds_read_b64_tr_b16 v[146:147], v2 offset:7808
    s_add_u32 s52, s50, 8192
    buffer_load_dwordx4 v[20:23], v158, s[24:27], s52 offen offset:2048 sc1
    s_add_u32 s52, s69, 8192
    buffer_load_dwordx4 v[24:27], v158, s[24:27], s52 offen offset:2048 sc1
    s_waitcnt vmcnt(10) lgkmcnt(0)
    v_mfma_f32_16x16x32_bf16 v[68:71], v[128:131], v[44:47], v[68:71]
    ds_read_b64_tr_b16 v[108:109], v2 offset:10240
    v_mfma_f32_16x16x32_bf16 v[88:91], v[128:131], v[48:51], v[88:91]
    ds_read_b64_tr_b16 v[110:111], v2 offset:12800
    v_mfma_f32_16x16x32_bf16 v[72:75], v[132:135], v[44:47], v[72:75]
    ds_read_b64_tr_b16 v[112:113], v2 offset:10272
    v_mfma_f32_16x16x32_bf16 v[92:95], v[132:135], v[48:51], v[92:95]
    ds_read_b64_tr_b16 v[114:115], v2 offset:12832
    v_mfma_f32_16x16x32_bf16 v[76:79], v[136:139], v[44:47], v[76:79]
    ds_read_b64_tr_b16 v[116:117], v2 offset:10304
    v_mfma_f32_16x16x32_bf16 v[96:99], v[136:139], v[48:51], v[96:99]
    ds_read_b64_tr_b16 v[118:119], v2 offset:12864
    v_mfma_f32_16x16x32_bf16 v[80:83], v[140:143], v[44:47], v[80:83]
    ds_read_b64_tr_b16 v[120:121], v2 offset:10336
    v_mfma_f32_16x16x32_bf16 v[100:103], v[140:143], v[48:51], v[100:103]
    ds_read_b64_tr_b16 v[122:123], v2 offset:12896
    v_mfma_f32_16x16x32_bf16 v[84:87], v[144:147], v[44:47], v[84:87]
    ds_read_b64_tr_b16 v[124:125], v2 offset:10368
    v_mfma_f32_16x16x32_bf16 v[104:107], v[144:147], v[48:51], v[104:107]
    ds_read_b64_tr_b16 v[126:127], v2 offset:12928
    s_add_u32 s52, s50, 8192
    buffer_load_dwordx4 v[28:31], v158, s[24:27], s52 offen offset:3072 sc1
    s_add_u32 s52, s69, 8192
    buffer_load_dwordx4 v[32:35], v158, s[24:27], s52 offen offset:3072 sc1
    s_waitcnt vmcnt(10) lgkmcnt(0)
    v_mfma_f32_16x16x32_bf16 v[68:71], v[108:111], v[52:55], v[68:71]
    ds_read_b64_tr_b16 v[128:129], v2 offset:15360
    v_mfma_f32_16x16x32_bf16 v[88:91], v[108:111], v[56:59], v[88:91]
    ds_read_b64_tr_b16 v[130:131], v2 offset:17920
    v_mfma_f32_16x16x32_bf16 v[72:75], v[112:115], v[52:55], v[72:75]
    ds_read_b64_tr_b16 v[132:133], v2 offset:15392
    v_mfma_f32_16x16x32_bf16 v[92:95], v[112:115], v[56:59], v[92:95]
    ds_read_b64_tr_b16 v[134:135], v2 offset:17952
    v_mfma_f32_16x16x32_bf16 v[76:79], v[116:119], v[52:55], v[76:79]
    ds_read_b64_tr_b16 v[136:137], v2 offset:15424
    v_mfma_f32_16x16x32_bf16 v[96:99], v[116:119], v[56:59], v[96:99]
    ds_read_b64_tr_b16 v[138:139], v2 offset:17984
    v_mfma_f32_16x16x32_bf16 v[80:83], v[120:123], v[52:55], v[80:83]
    ds_read_b64_tr_b16 v[140:141], v2 offset:15456
    v_mfma_f32_16x16x32_bf16 v[100:103], v[120:123], v[56:59], v[100:103]
    ds_read_b64_tr_b16 v[142:143], v2 offset:18016
    v_mfma_f32_16x16x32_bf16 v[84:87], v[124:127], v[52:55], v[84:87]
    ds_read_b64_tr_b16 v[144:145], v2 offset:15488
    v_mfma_f32_16x16x32_bf16 v[104:107], v[124:127], v[56:59], v[104:107]
    ds_read_b64_tr_b16 v[146:147], v2 offset:18048
    s_add_u32 s52, s50, 12288
    buffer_load_dwordx4 v[36:39], v158, s[24:27], s52 offen offset:0 sc1
    s_add_u32 s52, s69, 12288
    buffer_load_dwordx4 v[40:43], v158, s[24:27], s52 offen offset:0 sc1
    s_waitcnt vmcnt(10) lgkmcnt(0)
    v_mov_b32 v159, 155716
    v_mov_b32 v160, 1
    s_mov_b64 exec, 1
    ds_add_u32 v159, v160
    s_mov_b64 exec, -1
    s_cmp_eq_u32 s68, 0
    s_mov_b32 s51, 102400
    s_cselect_b32 s51, 81920, s51
    v_add_u32 v1, s51, v162
    s_lshl_b32 s51, s68, 2
    s_add_u32 s51, s51, 155664
    v_mov_b32 v159, s51
    s_mov_b32 s56, 0
    s_nop 0
L_lw_37:
    ds_read_b32 v160, v159
    s_waitcnt lgkmcnt(0)
    v_readfirstlane_b32 s79, v160
    s_nop 2
    s_cmp_ge_u32 s79, 3
    s_nop 0
    s_cbranch_scc1 L_lwd_38
    s_add_u32 s56, s56, 1
    s_cmp_lt_u32 s56, 4194304
    s_cbranch_scc1 L_lw_37
L_lwd_38:
    v_mfma_f32_16x16x32_bf16 v[68:71], v[128:131], v[60:63], v[68:71]
    ds_read_b64_tr_b16 v[108:109], v1 offset:0
    v_mfma_f32_16x16x32_bf16 v[88:91], v[128:131], v[64:67], v[88:91]
    ds_read_b64_tr_b16 v[110:111], v1 offset:2560
    v_mfma_f32_16x16x32_bf16 v[72:75], v[132:135], v[60:63], v[72:75]
    ds_read_b64_tr_b16 v[112:113], v1 offset:32
    v_mfma_f32_16x16x32_bf16 v[92:95], v[132:135], v[64:67], v[92:95]
    ds_read_b64_tr_b16 v[114:115], v1 offset:2592
    v_mfma_f32_16x16x32_bf16 v[76:79], v[136:139], v[60:63], v[76:79]
    ds_read_b64_tr_b16 v[116:117], v1 offset:64
    v_mfma_f32_16x16x32_bf16 v[96:99], v[136:139], v[64:67], v[96:99]
    ds_read_b64_tr_b16 v[118:119], v1 offset:2624
    v_mfma_f32_16x16x32_bf16 v[80:83], v[140:143], v[60:63], v[80:83]
    ds_read_b64_tr_b16 v[120:121], v1 offset:96
    v_mfma_f32_16x16x32_bf16 v[100:103], v[140:143], v[64:67], v[100:103]
    ds_read_b64_tr_b16 v[122:123], v1 offset:2656
    v_mfma_f32_16x16x32_bf16 v[84:87], v[144:147], v[60:63], v[84:87]
    ds_read_b64_tr_b16 v[124:125], v1 offset:128
    v_mfma_f32_16x16x32_bf16 v[104:107], v[144:147], v[64:67], v[104:107]
    ds_read_b64_tr_b16 v[126:127], v1 offset:2688
    s_add_u32 s52, s50, 12288
    buffer_load_dwordx4 v[44:47], v158, s[24:27], s52 offen offset:1024 sc1
    s_add_u32 s52, s69, 12288
    buffer_load_dwordx4 v[48:51], v158, s[24:27], s52 offen offset:1024 sc1
    s_waitcnt vmcnt(10) lgkmcnt(0)
    v_mfma_f32_16x16x32_bf16 v[68:71], v[108:111], v[4:7], v[68:71]
    ds_read_b64_tr_b16 v[128:129], v1 offset:5120
    v_mfma_f32_16x16x32_bf16 v[88:91], v[108:111], v[8:11], v[88:91]
    ds_read_b64_tr_b16 v[130:131], v1 offset:7680
    v_mfma_f32_16x16x32_bf16 v[72:75], v[112:115], v[4:7], v[72:75]
    ds_read_b64_tr_b16 v[132:133], v1 offset:5152
    v_mfma_f32_16x16x32_bf16 v[92:95], v[112:115], v[8:11], v[92:95]
    ds_read_b64_tr_b16 v[134:135], v1 offset:7712
    v_mfma_f32_16x16x32_bf16 v[76:79], v[116:119], v[4:7], v[76:79]
    ds_read_b64_tr_b16 v[136:137], v1 offset:5184
    v_mfma_f32_16x16x32_bf16 v[96:99], v[116:119], v[8:11], v[96:99]
    ds_read_b64_tr_b16 v[138:139], v1 offset:7744
    v_mfma_f32_16x16x32_bf16 v[80:83], v[120:123], v[4:7], v[80:83]
    ds_read_b64_tr_b16 v[140:141], v1 offset:5216
    v_mfma_f32_16x16x32_bf16 v[100:103], v[120:123], v[8:11], v[100:103]
    ds_read_b64_tr_b16 v[142:143], v1 offset:7776
    v_mfma_f32_16x16x32_bf16 v[84:87], v[124:127], v[4:7], v[84:87]
    ds_read_b64_tr_b16 v[144:145], v1 offset:5248
    v_mfma_f32_16x16x32_bf16 v[104:107], v[124:127], v[8:11], v[104:107]
    ds_read_b64_tr_b16 v[146:147], v1 offset:7808
    s_add_u32 s52, s50, 12288
    buffer_load_dwordx4 v[52:55], v158, s[24:27], s52 offen offset:2048 sc1
    s_add_u32 s52, s69, 12288
    buffer_load_dwordx4 v[56:59], v158, s[24:27], s52 offen offset:2048 sc1
    s_waitcnt vmcnt(10) lgkmcnt(0)
    v_mfma_f32_16x16x32_bf16 v[68:71], v[128:131], v[12:15], v[68:71]
    ds_read_b64_tr_b16 v[108:109], v1 offset:10240
    v_mfma_f32_16x16x32_bf16 v[88:91], v[128:131], v[16:19], v[88:91]
    ds_read_b64_tr_b16 v[110:111], v1 offset:12800
    v_mfma_f32_16x16x32_bf16 v[72:75], v[132:135], v[12:15], v[72:75]
    ds_read_b64_tr_b16 v[112:113], v1 offset:10272
    v_mfma_f32_16x16x32_bf16 v[92:95], v[132:135], v[16:19], v[92:95]
    ds_read_b64_tr_b16 v[114:115], v1 offset:12832
    v_mfma_f32_16x16x32_bf16 v[76:79], v[136:139], v[12:15], v[76:79]
    ds_read_b64_tr_b16 v[116:117], v1 offset:10304
    v_mfma_f32_16x16x32_bf16 v[96:99], v[136:139], v[16:19], v[96:99]
    ds_read_b64_tr_b16 v[118:119], v1 offset:12864
    v_mfma_f32_16x16x32_bf16 v[80:83], v[140:143], v[12:15], v[80:83]
    ds_read_b64_tr_b16 v[120:121], v1 offset:10336
    v_mfma_f32_16x16x32_bf16 v[100:103], v[140:143], v[16:19], v[100:103]
    ds_read_b64_tr_b16 v[122:123], v1 offset:12896
    v_mfma_f32_16x16x32_bf16 v[84:87], v[144:147], v[12:15], v[84:87]
    ds_read_b64_tr_b16 v[124:125], v1 offset:10368
    v_mfma_f32_16x16x32_bf16 v[104:107], v[144:147], v[16:19], v[104:107]
    ds_read_b64_tr_b16 v[126:127], v1 offset:12928
    s_add_u32 s52, s50, 12288
    buffer_load_dwordx4 v[60:63], v158, s[24:27], s52 offen offset:3072 sc1
    s_add_u32 s52, s69, 12288
    buffer_load_dwordx4 v[64:67], v158, s[24:27], s52 offen offset:3072 sc1
    s_waitcnt vmcnt(10) lgkmcnt(0)
    v_mfma_f32_16x16x32_bf16 v[68:71], v[108:111], v[20:23], v[68:71]
    ds_read_b64_tr_b16 v[128:129], v1 offset:15360
    v_mfma_f32_16x16x32_bf16 v[88:91], v[108:111], v[24:27], v[88:91]
    ds_read_b64_tr_b16 v[130:131], v1 offset:17920
    v_mfma_f32_16x16x32_bf16 v[72:75], v[112:115], v[20:23], v[72:75]
    ds_read_b64_tr_b16 v[132:133], v1 offset:15392
    v_mfma_f32_16x16x32_bf16 v[92:95], v[112:115], v[24:27], v[92:95]
    ds_read_b64_tr_b16 v[134:135], v1 offset:17952
    v_mfma_f32_16x16x32_bf16 v[76:79], v[116:119], v[20:23], v[76:79]
    ds_read_b64_tr_b16 v[136:137], v1 offset:15424
    v_mfma_f32_16x16x32_bf16 v[96:99], v[116:119], v[24:27], v[96:99]
    ds_read_b64_tr_b16 v[138:139], v1 offset:17984
    v_mfma_f32_16x16x32_bf16 v[80:83], v[120:123], v[20:23], v[80:83]
    ds_read_b64_tr_b16 v[140:141], v1 offset:15456
    v_mfma_f32_16x16x32_bf16 v[100:103], v[120:123], v[24:27], v[100:103]
    ds_read_b64_tr_b16 v[142:143], v1 offset:18016
    v_mfma_f32_16x16x32_bf16 v[84:87], v[124:127], v[20:23], v[84:87]
    ds_read_b64_tr_b16 v[144:145], v1 offset:15488
    v_mfma_f32_16x16x32_bf16 v[104:107], v[124:127], v[24:27], v[104:107]
    ds_read_b64_tr_b16 v[146:147], v1 offset:18048
    s_add_u32 s52, s50, 16384
    buffer_load_dwordx4 v[4:7], v158, s[24:27], s52 offen offset:0 sc1
    s_add_u32 s52, s69, 16384
    buffer_load_dwordx4 v[8:11], v158, s[24:27], s52 offen offset:0 sc1
    s_waitcnt vmcnt(10) lgkmcnt(0)
    v_mov_b32 v159, 155720
    v_mov_b32 v160, 1
    s_mov_b64 exec, 1
    ds_add_u32 v159, v160
    s_mov_b64 exec, -1
    s_cmp_eq_u32 s68, 0
    s_cselect_b32 s51, 122880, 0
    v_add_u32 v2, s51, v162
    s_lshl_b32 s51, s68, 2
    s_add_u32 s51, s51, 155672
    v_mov_b32 v159, s51
    s_mov_b32 s56, 0
    s_nop 0
L_lw_39:
    ds_read_b32 v160, v159
    s_waitcnt lgkmcnt(0)
    v_readfirstlane_b32 s79, v160
    s_nop 2
    s_cmp_ge_u32 s79, 3
    s_nop 0
    s_cbranch_scc1 L_lwd_40
    s_add_u32 s56, s56, 1
    s_cmp_lt_u32 s56, 4194304
    s_cbranch_scc1 L_lw_39
L_lwd_40:
    v_mfma_f32_16x16x32_bf16 v[68:71], v[128:131], v[28:31], v[68:71]
    ds_read_b64_tr_b16 v[108:109], v2 offset:0
    v_mfma_f32_16x16x32_bf16 v[88:91], v[128:131], v[32:35], v[88:91]
    ds_read_b64_tr_b16 v[110:111], v2 offset:2560
    v_mfma_f32_16x16x32_bf16 v[72:75], v[132:135], v[28:31], v[72:75]
    ds_read_b64_tr_b16 v[112:113], v2 offset:32
    v_mfma_f32_16x16x32_bf16 v[92:95], v[132:135], v[32:35], v[92:95]
    ds_read_b64_tr_b16 v[114:115], v2 offset:2592
    v_mfma_f32_16x16x32_bf16 v[76:79], v[136:139], v[28:31], v[76:79]
    ds_read_b64_tr_b16 v[116:117], v2 offset:64
    v_mfma_f32_16x16x32_bf16 v[96:99], v[136:139], v[32:35], v[96:99]
    ds_read_b64_tr_b16 v[118:119], v2 offset:2624
    v_mfma_f32_16x16x32_bf16 v[80:83], v[140:143], v[28:31], v[80:83]
    ds_read_b64_tr_b16 v[120:121], v2 offset:96
    v_mfma_f32_16x16x32_bf16 v[100:103], v[140:143], v[32:35], v[100:103]
    ds_read_b64_tr_b16 v[122:123], v2 offset:2656
    v_mfma_f32_16x16x32_bf16 v[84:87], v[144:147], v[28:31], v[84:87]
    ds_read_b64_tr_b16 v[124:125], v2 offset:128
    v_mfma_f32_16x16x32_bf16 v[104:107], v[144:147], v[32:35], v[104:107]
    ds_read_b64_tr_b16 v[126:127], v2 offset:2688
    s_add_u32 s52, s50, 16384
    buffer_load_dwordx4 v[12:15], v158, s[24:27], s52 offen offset:1024 sc1
    s_add_u32 s52, s69, 16384
    buffer_load_dwordx4 v[16:19], v158, s[24:27], s52 offen offset:1024 sc1
    s_waitcnt vmcnt(10) lgkmcnt(0)
    v_mfma_f32_16x16x32_bf16 v[68:71], v[108:111], v[36:39], v[68:71]
    ds_read_b64_tr_b16 v[128:129], v2 offset:5120
    v_mfma_f32_16x16x32_bf16 v[88:91], v[108:111], v[40:43], v[88:91]
    ds_read_b64_tr_b16 v[130:131], v2 offset:7680
    v_mfma_f32_16x16x32_bf16 v[72:75], v[112:115], v[36:39], v[72:75]
    ds_read_b64_tr_b16 v[132:133], v2 offset:5152
    v_mfma_f32_16x16x32_bf16 v[92:95], v[112:115], v[40:43], v[92:95]
    ds_read_b64_tr_b16 v[134:135], v2 offset:7712
    v_mfma_f32_16x16x32_bf16 v[76:79], v[116:119], v[36:39], v[76:79]
    ds_read_b64_tr_b16 v[136:137], v2 offset:5184
    v_mfma_f32_16x16x32_bf16 v[96:99], v[116:119], v[40:43], v[96:99]
    ds_read_b64_tr_b16 v[138:139], v2 offset:7744
    v_mfma_f32_16x16x32_bf16 v[80:83], v[120:123], v[36:39], v[80:83]
    ds_read_b64_tr_b16 v[140:141], v2 offset:5216
    v_mfma_f32_16x16x32_bf16 v[100:103], v[120:123], v[40:43], v[100:103]
    ds_read_b64_tr_b16 v[142:143], v2 offset:7776
    v_mfma_f32_16x16x32_bf16 v[84:87], v[124:127], v[36:39], v[84:87]
    ds_read_b64_tr_b16 v[144:145], v2 offset:5248
    v_mfma_f32_16x16x32_bf16 v[104:107], v[124:127], v[40:43], v[104:107]
    ds_read_b64_tr_b16 v[146:147], v2 offset:7808
    s_add_u32 s52, s50, 16384
    buffer_load_dwordx4 v[20:23], v158, s[24:27], s52 offen offset:2048 sc1
    s_add_u32 s52, s69, 16384
    buffer_load_dwordx4 v[24:27], v158, s[24:27], s52 offen offset:2048 sc1
    s_waitcnt vmcnt(10) lgkmcnt(0)
    v_mfma_f32_16x16x32_bf16 v[68:71], v[128:131], v[44:47], v[68:71]
    ds_read_b64_tr_b16 v[108:109], v2 offset:10240
    v_mfma_f32_16x16x32_bf16 v[88:91], v[128:131], v[48:51], v[88:91]
    ds_read_b64_tr_b16 v[110:111], v2 offset:12800
    v_mfma_f32_16x16x32_bf16 v[72:75], v[132:135], v[44:47], v[72:75]
    ds_read_b64_tr_b16 v[112:113], v2 offset:10272
    v_mfma_f32_16x16x32_bf16 v[92:95], v[132:135], v[48:51], v[92:95]
    ds_read_b64_tr_b16 v[114:115], v2 offset:12832
    v_mfma_f32_16x16x32_bf16 v[76:79], v[136:139], v[44:47], v[76:79]
    ds_read_b64_tr_b16 v[116:117], v2 offset:10304
    v_mfma_f32_16x16x32_bf16 v[96:99], v[136:139], v[48:51], v[96:99]
    ds_read_b64_tr_b16 v[118:119], v2 offset:12864
    v_mfma_f32_16x16x32_bf16 v[80:83], v[140:143], v[44:47], v[80:83]
    ds_read_b64_tr_b16 v[120:121], v2 offset:10336
    v_mfma_f32_16x16x32_bf16 v[100:103], v[140:143], v[48:51], v[100:103]
    ds_read_b64_tr_b16 v[122:123], v2 offset:12896
    v_mfma_f32_16x16x32_bf16 v[84:87], v[144:147], v[44:47], v[84:87]
    ds_read_b64_tr_b16 v[124:125], v2 offset:10368
    v_mfma_f32_16x16x32_bf16 v[104:107], v[144:147], v[48:51], v[104:107]
    ds_read_b64_tr_b16 v[126:127], v2 offset:12928
    s_add_u32 s52, s50, 16384
    buffer_load_dwordx4 v[28:31], v158, s[24:27], s52 offen offset:3072 sc1
    s_add_u32 s52, s69, 16384
    buffer_load_dwordx4 v[32:35], v158, s[24:27], s52 offen offset:3072 sc1
    s_waitcnt vmcnt(10) lgkmcnt(0)
    v_mfma_f32_16x16x32_bf16 v[68:71], v[108:111], v[52:55], v[68:71]
    ds_read_b64_tr_b16 v[128:129], v2 offset:15360
    v_mfma_f32_16x16x32_bf16 v[88:91], v[108:111], v[56:59], v[88:91]
    ds_read_b64_tr_b16 v[130:131], v2 offset:17920
    v_mfma_f32_16x16x32_bf16 v[72:75], v[112:115], v[52:55], v[72:75]
    ds_read_b64_tr_b16 v[132:133], v2 offset:15392
    v_mfma_f32_16x16x32_bf16 v[92:95], v[112:115], v[56:59], v[92:95]
    ds_read_b64_tr_b16 v[134:135], v2 offset:17952
    v_mfma_f32_16x16x32_bf16 v[76:79], v[116:119], v[52:55], v[76:79]
    ds_read_b64_tr_b16 v[136:137], v2 offset:15424
    v_mfma_f32_16x16x32_bf16 v[96:99], v[116:119], v[56:59], v[96:99]
    ds_read_b64_tr_b16 v[138:139], v2 offset:17984
    v_mfma_f32_16x16x32_bf16 v[80:83], v[120:123], v[52:55], v[80:83]
    ds_read_b64_tr_b16 v[140:141], v2 offset:15456
    v_mfma_f32_16x16x32_bf16 v[100:103], v[120:123], v[56:59], v[100:103]
    ds_read_b64_tr_b16 v[142:143], v2 offset:18016
    v_mfma_f32_16x16x32_bf16 v[84:87], v[124:127], v[52:55], v[84:87]
    ds_read_b64_tr_b16 v[144:145], v2 offset:15488
    v_mfma_f32_16x16x32_bf16 v[104:107], v[124:127], v[56:59], v[104:107]
    ds_read_b64_tr_b16 v[146:147], v2 offset:18048
    s_add_u32 s52, s50, 20480
    buffer_load_dwordx4 v[36:39], v158, s[24:27], s52 offen offset:0 sc1
    s_add_u32 s52, s69, 20480
    buffer_load_dwordx4 v[40:43], v158, s[24:27], s52 offen offset:0 sc1
    s_waitcnt vmcnt(10) lgkmcnt(0)
    s_cmp_eq_u32 s68, 0
    s_mov_b32 s51, 40960
    s_cselect_b32 s51, 20480, s51
    v_add_u32 v1, s51, v162
    s_lshl_b32 s51, s68, 2
    s_add_u32 s51, s51, 155680
    v_mov_b32 v159, s51
    s_mov_b32 s56, 0
    s_nop 0
L_lw_41:
    ds_read_b32 v160, v159
    s_waitcnt lgkmcnt(0)
    v_readfirstlane_b32 s79, v160
    s_nop 2
    s_cmp_ge_u32 s79, 3
    s_nop 0
    s_cbranch_scc1 L_lwd_42
    s_add_u32 s56, s56, 1
    s_cmp_lt_u32 s56, 4194304
    s_cbranch_scc1 L_lw_41
L_lwd_42:
    v_mfma_f32_16x16x32_bf16 v[68:71], v[128:131], v[60:63], v[68:71]
    ds_read_b64_tr_b16 v[108:109], v1 offset:0
    v_mfma_f32_16x16x32_bf16 v[88:91], v[128:131], v[64:67], v[88:91]
    ds_read_b64_tr_b16 v[110:111], v1 offset:2560
    v_mfma_f32_16x16x32_bf16 v[72:75], v[132:135], v[60:63], v[72:75]
    ds_read_b64_tr_b16 v[112:113], v1 offset:32
    v_mfma_f32_16x16x32_bf16 v[92:95], v[132:135], v[64:67], v[92:95]
    ds_read_b64_tr_b16 v[114:115], v1 offset:2592
    v_mfma_f32_16x16x32_bf16 v[76:79], v[136:139], v[60:63], v[76:79]
    ds_read_b64_tr_b16 v[116:117], v1 offset:64
    v_mfma_f32_16x16x32_bf16 v[96:99], v[136:139], v[64:67], v[96:99]
    ds_read_b64_tr_b16 v[118:119], v1 offset:2624
    v_mfma_f32_16x16x32_bf16 v[80:83], v[140:143], v[60:63], v[80:83]
    ds_read_b64_tr_b16 v[120:121], v1 offset:96
    v_mfma_f32_16x16x32_bf16 v[100:103], v[140:143], v[64:67], v[100:103]
    ds_read_b64_tr_b16 v[122:123], v1 offset:2656
    v_mfma_f32_16x16x32_bf16 v[84:87], v[144:147], v[60:63], v[84:87]
    ds_read_b64_tr_b16 v[124:125], v1 offset:128
    v_mfma_f32_16x16x32_bf16 v[104:107], v[144:147], v[64:67], v[104:107]
    ds_read_b64_tr_b16 v[126:127], v1 offset:2688
    s_add_u32 s52, s50, 20480
    buffer_load_dwordx4 v[44:47], v158, s[24:27], s52 offen offset:1024 sc1
    s_add_u32 s52, s69, 20480
    buffer_load_dwordx4 v[48:51], v158, s[24:27], s52 offen offset:1024 sc1
    s_waitcnt vmcnt(10) lgkmcnt(0)
    v_mfma_f32_16x16x32_bf16 v[68:71], v[108:111], v[4:7], v[68:71]
    ds_read_b64_tr_b16 v[128:129], v1 offset:5120
    v_mfma_f32_16x16x32_bf16 v[88:91], v[108:111], v[8:11], v[88:91]
    ds_read_b64_tr_b16 v[130:131], v1 offset:7680
    v_mfma_f32_16x16x32_bf16 v[72:75], v[112:115], v[4:7], v[72:75]
    ds_read_b64_tr_b16 v[132:133], v1 offset:5152
    v_mfma_f32_16x16x32_bf16 v[92:95], v[112:115], v[8:11], v[92:95]
    ds_read_b64_tr_b16 v[134:135], v1 offset:7712
    v_mfma_f32_16x16x32_bf16 v[76:79], v[116:119], v[4:7], v[76:79]
    ds_read_b64_tr_b16 v[136:137], v1 offset:5184
    v_mfma_f32_16x16x32_bf16 v[96:99], v[116:119], v[8:11], v[96:99]
    ds_read_b64_tr_b16 v[138:139], v1 offset:7744
    v_mfma_f32_16x16x32_bf16 v[80:83], v[120:123], v[4:7], v[80:83]
    ds_read_b64_tr_b16 v[140:141], v1 offset:5216
    v_mfma_f32_16x16x32_bf16 v[100:103], v[120:123], v[8:11], v[100:103]
    ds_read_b64_tr_b16 v[142:143], v1 offset:7776
    v_mfma_f32_16x16x32_bf16 v[84:87], v[124:127], v[4:7], v[84:87]
    ds_read_b64_tr_b16 v[144:145], v1 offset:5248
    v_mfma_f32_16x16x32_bf16 v[104:107], v[124:127], v[8:11], v[104:107]
    ds_read_b64_tr_b16 v[146:147], v1 offset:7808
    s_add_u32 s52, s50, 20480
    buffer_load_dwordx4 v[52:55], v158, s[24:27], s52 offen offset:2048 sc1
    s_add_u32 s52, s69, 20480
    buffer_load_dwordx4 v[56:59], v158, s[24:27], s52 offen offset:2048 sc1
    s_waitcnt vmcnt(10) lgkmcnt(0)
    v_mfma_f32_16x16x32_bf16 v[68:71], v[128:131], v[12:15], v[68:71]
    ds_read_b64_tr_b16 v[108:109], v1 offset:10240
    v_mfma_f32_16x16x32_bf16 v[88:91], v[128:131], v[16:19], v[88:91]
    ds_read_b64_tr_b16 v[110:111], v1 offset:12800
    v_mfma_f32_16x16x32_bf16 v[72:75], v[132:135], v[12:15], v[72:75]
    ds_read_b64_tr_b16 v[112:113], v1 offset:10272
    v_mfma_f32_16x16x32_bf16 v[92:95], v[132:135], v[16:19], v[92:95]
    ds_read_b64_tr_b16 v[114:115], v1 offset:12832
    v_mfma_f32_16x16x32_bf16 v[76:79], v[136:139], v[12:15], v[76:79]
    ds_read_b64_tr_b16 v[116:117], v1 offset:10304
    v_mfma_f32_16x16x32_bf16 v[96:99], v[136:139], v[16:19], v[96:99]
    ds_read_b64_tr_b16 v[118:119], v1 offset:12864
    v_mfma_f32_16x16x32_bf16 v[80:83], v[140:143], v[12:15], v[80:83]
    ds_read_b64_tr_b16 v[120:121], v1 offset:10336
    v_mfma_f32_16x16x32_bf16 v[100:103], v[140:143], v[16:19], v[100:103]
    ds_read_b64_tr_b16 v[122:123], v1 offset:12896
    v_mfma_f32_16x16x32_bf16 v[84:87], v[144:147], v[12:15], v[84:87]
    ds_read_b64_tr_b16 v[124:125], v1 offset:10368
    v_mfma_f32_16x16x32_bf16 v[104:107], v[144:147], v[16:19], v[104:107]
    ds_read_b64_tr_b16 v[126:127], v1 offset:12928
    s_add_u32 s52, s50, 20480
    buffer_load_dwordx4 v[60:63], v158, s[24:27], s52 offen offset:3072 sc1
    s_add_u32 s52, s69, 20480
    buffer_load_dwordx4 v[64:67], v158, s[24:27], s52 offen offset:3072 sc1
    s_waitcnt vmcnt(10) lgkmcnt(0)
    v_mfma_f32_16x16x32_bf16 v[68:71], v[108:111], v[20:23], v[68:71]
    ds_read_b64_tr_b16 v[128:129], v1 offset:15360
    v_mfma_f32_16x16x32_bf16 v[88:91], v[108:111], v[24:27], v[88:91]
    ds_read_b64_tr_b16 v[130:131], v1 offset:17920
    v_mfma_f32_16x16x32_bf16 v[72:75], v[112:115], v[20:23], v[72:75]
    ds_read_b64_tr_b16 v[132:133], v1 offset:15392
    v_mfma_f32_16x16x32_bf16 v[92:95], v[112:115], v[24:27], v[92:95]
    ds_read_b64_tr_b16 v[134:135], v1 offset:17952
    v_mfma_f32_16x16x32_bf16 v[76:79], v[116:119], v[20:23], v[76:79]
    ds_read_b64_tr_b16 v[136:137], v1 offset:15424
    v_mfma_f32_16x16x32_bf16 v[96:99], v[116:119], v[24:27], v[96:99]
    ds_read_b64_tr_b16 v[138:139], v1 offset:17984
    v_mfma_f32_16x16x32_bf16 v[80:83], v[120:123], v[20:23], v[80:83]
    ds_read_b64_tr_b16 v[140:141], v1 offset:15456
    v_mfma_f32_16x16x32_bf16 v[100:103], v[120:123], v[24:27], v[100:103]
    ds_read_b64_tr_b16 v[142:143], v1 offset:18016
    v_mfma_f32_16x16x32_bf16 v[84:87], v[124:127], v[20:23], v[84:87]
    ds_read_b64_tr_b16 v[144:145], v1 offset:15488
    v_mfma_f32_16x16x32_bf16 v[104:107], v[124:127], v[24:27], v[104:107]
    ds_read_b64_tr_b16 v[146:147], v1 offset:18048
    s_waitcnt vmcnt(8) lgkmcnt(0)
    s_cmp_eq_u32 s68, 0
    s_mov_b32 s51, 81920
    s_cselect_b32 s51, 61440, s51
    v_add_u32 v2, s51, v162
    s_lshl_b32 s51, s68, 2
    s_add_u32 s51, s51, 155688
    v_mov_b32 v159, s51
    s_mov_b32 s56, 0
    s_nop 0
L_lw_43:
    ds_read_b32 v160, v159
    s_waitcnt lgkmcnt(0)
    v_readfirstlane_b32 s79, v160
    s_nop 2
    s_cmp_ge_u32 s79, 3
    s_nop 0
    s_cbranch_scc1 L_lwd_44
    s_add_u32 s56, s56, 1
    s_cmp_lt_u32 s56, 4194304
    s_cbranch_scc1 L_lw_43
L_lwd_44:
    v_mfma_f32_16x16x32_bf16 v[68:71], v[128:131], v[28:31], v[68:71]
    ds_read_b64_tr_b16 v[108:109], v2 offset:0
    v_mfma_f32_16x16x32_bf16 v[88:91], v[128:131], v[32:35], v[88:91]
    ds_read_b64_tr_b16 v[110:111], v2 offset:2560
    v_mfma_f32_16x16x32_bf16 v[72:75], v[132:135], v[28:31], v[72:75]
    ds_read_b64_tr_b16 v[112:113], v2 offset:32
    v_mfma_f32_16x16x32_bf16 v[92:95], v[132:135], v[32:35], v[92:95]
    ds_read_b64_tr_b16 v[114:115], v2 offset:2592
    v_mfma_f32_16x16x32_bf16 v[76:79], v[136:139], v[28:31], v[76:79]
    ds_read_b64_tr_b16 v[116:117], v2 offset:64
    v_mfma_f32_16x16x32_bf16 v[96:99], v[136:139], v[32:35], v[96:99]
    ds_read_b64_tr_b16 v[118:119], v2 offset:2624
    v_mfma_f32_16x16x32_bf16 v[80:83], v[140:143], v[28:31], v[80:83]
    ds_read_b64_tr_b16 v[120:121], v2 offset:96
    v_mfma_f32_16x16x32_bf16 v[100:103], v[140:143], v[32:35], v[100:103]
    ds_read_b64_tr_b16 v[122:123], v2 offset:2656
    v_mfma_f32_16x16x32_bf16 v[84:87], v[144:147], v[28:31], v[84:87]
    ds_read_b64_tr_b16 v[124:125], v2 offset:128
    v_mfma_f32_16x16x32_bf16 v[104:107], v[144:147], v[32:35], v[104:107]
    ds_read_b64_tr_b16 v[126:127], v2 offset:2688
    s_waitcnt vmcnt(6) lgkmcnt(0)
    v_mfma_f32_16x16x32_bf16 v[68:71], v[108:111], v[36:39], v[68:71]
    ds_read_b64_tr_b16 v[128:129], v2 offset:5120
    v_mfma_f32_16x16x32_bf16 v[88:91], v[108:111], v[40:43], v[88:91]
    ds_read_b64_tr_b16 v[130:131], v2 offset:7680
    v_mfma_f32_16x16x32_bf16 v[72:75], v[112:115], v[36:39], v[72:75]
    ds_read_b64_tr_b16 v[132:133], v2 offset:5152
    v_mfma_f32_16x16x32_bf16 v[92:95], v[112:115], v[40:43], v[92:95]
    ds_read_b64_tr_b16 v[134:135], v2 offset:7712
    v_mfma_f32_16x16x32_bf16 v[76:79], v[116:119], v[36:39], v[76:79]
    ds_read_b64_tr_b16 v[136:137], v2 offset:5184
    v_mfma_f32_16x16x32_bf16 v[96:99], v[116:119], v[40:43], v[96:99]
    ds_read_b64_tr_b16 v[138:139], v2 offset:7744
    v_mfma_f32_16x16x32_bf16 v[80:83], v[120:123], v[36:39], v[80:83]
    ds_read_b64_tr_b16 v[140:141], v2 offset:5216
    v_mfma_f32_16x16x32_bf16 v[100:103], v[120:123], v[40:43], v[100:103]
    ds_read_b64_tr_b16 v[142:143], v2 offset:7776
    v_mfma_f32_16x16x32_bf16 v[84:87], v[124:127], v[36:39], v[84:87]
    ds_read_b64_tr_b16 v[144:145], v2 offset:5248
    v_mfma_f32_16x16x32_bf16 v[104:107], v[124:127], v[40:43], v[104:107]
    ds_read_b64_tr_b16 v[146:147], v2 offset:7808
    s_waitcnt vmcnt(4) lgkmcnt(0)
    v_mfma_f32_16x16x32_bf16 v[68:71], v[128:131], v[44:47], v[68:71]
    ds_read_b64_tr_b16 v[108:109], v2 offset:10240
    v_mfma_f32_16x16x32_bf16 v[88:91], v[128:131], v[48:51], v[88:91]
    ds_read_b64_tr_b16 v[110:111], v2 offset:12800
    v_mfma_f32_16x16x32_bf16 v[72:75], v[132:135], v[44:47], v[72:75]
    ds_read_b64_tr_b16 v[112:113], v2 offset:10272
    v_mfma_f32_16x16x32_bf16 v[92:95], v[132:135], v[48:51], v[92:95]
    ds_read_b64_tr_b16 v[114:115], v2 offset:12832
    v_mfma_f32_16x16x32_bf16 v[76:79], v[136:139], v[44:47], v[76:79]
    ds_read_b64_tr_b16 v[116:117], v2 offset:10304
    v_mfma_f32_16x16x32_bf16 v[96:99], v[136:139], v[48:51], v[96:99]
    ds_read_b64_tr_b16 v[118:119], v2 offset:12864
    v_mfma_f32_16x16x32_bf16 v[80:83], v[140:143], v[44:47], v[80:83]
    ds_read_b64_tr_b16 v[120:121], v2 offset:10336
    v_mfma_f32_16x16x32_bf16 v[100:103], v[140:143], v[48:51], v[100:103]
    ds_read_b64_tr_b16 v[122:123], v2 offset:12896
    v_mfma_f32_16x16x32_bf16 v[84:87], v[144:147], v[44:47], v[84:87]
    ds_read_b64_tr_b16 v[124:125], v2 offset:10368
    v_mfma_f32_16x16x32_bf16 v[104:107], v[144:147], v[48:51], v[104:107]
    ds_read_b64_tr_b16 v[126:127], v2 offset:12928
    s_waitcnt vmcnt(2) lgkmcnt(0)
    v_mfma_f32_16x16x32_bf16 v[68:71], v[108:111], v[52:55], v[68:71]
    ds_read_b64_tr_b16 v[128:129], v2 offset:15360
    v_mfma_f32_16x16x32_bf16 v[88:91], v[108:111], v[56:59], v[88:91]
    ds_read_b64_tr_b16 v[130:131], v2 offset:17920
    v_mfma_f32_16x16x32_bf16 v[72:75], v[112:115], v[52:55], v[72:75]
    ds_read_b64_tr_b16 v[132:133], v2 offset:15392
    v_mfma_f32_16x16x32_bf16 v[92:95], v[112:115], v[56:59], v[92:95]
    ds_read_b64_tr_b16 v[134:135], v2 offset:17952
    v_mfma_f32_16x16x32_bf16 v[76:79], v[116:119], v[52:55], v[76:79]
    ds_read_b64_tr_b16 v[136:137], v2 offset:15424
    v_mfma_f32_16x16x32_bf16 v[96:99], v[116:119], v[56:59], v[96:99]
    ds_read_b64_tr_b16 v[138:139], v2 offset:17984
    v_mfma_f32_16x16x32_bf16 v[80:83], v[120:123], v[52:55], v[80:83]
    ds_read_b64_tr_b16 v[140:141], v2 offset:15456
    v_mfma_f32_16x16x32_bf16 v[100:103], v[120:123], v[56:59], v[100:103]
    ds_read_b64_tr_b16 v[142:143], v2 offset:18016
    v_mfma_f32_16x16x32_bf16 v[84:87], v[124:127], v[52:55], v[84:87]
    ds_read_b64_tr_b16 v[144:145], v2 offset:15488
    v_mfma_f32_16x16x32_bf16 v[104:107], v[124:127], v[56:59], v[104:107]
    ds_read_b64_tr_b16 v[146:147], v2 offset:18048
    s_waitcnt vmcnt(0) lgkmcnt(0)
    v_mfma_f32_16x16x32_bf16 v[68:71], v[128:131], v[60:63], v[68:71]
    v_mfma_f32_16x16x32_bf16 v[88:91], v[128:131], v[64:67], v[88:91]
    v_mfma_f32_16x16x32_bf16 v[72:75], v[132:135], v[60:63], v[72:75]
    v_mfma_f32_16x16x32_bf16 v[92:95], v[132:135], v[64:67], v[92:95]
    v_mfma_f32_16x16x32_bf16 v[76:79], v[136:139], v[60:63], v[76:79]
    v_mfma_f32_16x16x32_bf16 v[96:99], v[136:139], v[64:67], v[96:99]
    v_mfma_f32_16x16x32_bf16 v[80:83], v[140:143], v[60:63], v[80:83]
    v_mfma_f32_16x16x32_bf16 v[100:103], v[140:143], v[64:67], v[100:103]
    v_mfma_f32_16x16x32_bf16 v[84:87], v[144:147], v[60:63], v[84:87]
    v_mfma_f32_16x16x32_bf16 v[104:107], v[144:147], v[64:67], v[104:107]
    s_barrier
    s_mul_i32 s51, s40, 5120
    v_add_u32 v159, s51, v158
    s_xor_b32 s51, s40, 1
    s_mul_i32 s51, s51, 5120
    v_add_u32 v160, s51, v158
    s_waitcnt vmcnt(0)
    s_cmp_eq_u32 s68, 0
    s_cbranch_scc0 L_kh1_45
    ds_write_b128 v159, v[88:91] offset:0
    ds_write_b128 v159, v[92:95] offset:1024
    ds_write_b128 v159, v[96:99] offset:2048
    ds_write_b128 v159, v[100:103] offset:3072
    ds_write_b128 v159, v[104:107] offset:4096
    s_branch L_khj_46
L_kh1_45:
    ds_write_b128 v159, v[68:71] offset:0
    ds_write_b128 v159, v[72:75] offset:1024
    ds_write_b128 v159, v[76:79] offset:2048
    ds_write_b128 v159, v[80:83] offset:3072
    ds_write_b128 v159, v[84:87] offset:4096
    s_waitcnt lgkmcnt(0)
    v_mov_b32 v68, v88
    v_mov_b32 v69, v89
    v_mov_b32 v70, v90
    v_mov_b32 v71, v91
    v_mov_b32 v72, v92
    v_mov_b32 v73, v93
    v_mov_b32 v74, v94
    v_mov_b32 v75, v95
    v_mov_b32 v76, v96
    v_mov_b32 v77, v97
    v_mov_b32 v78, v98
    v_mov_b32 v79, v99
    v_mov_b32 v80, v100
    v_mov_b32 v81, v101
    v_mov_b32 v82, v102
    v_mov_b32 v83, v103
    v_mov_b32 v84, v104
    v_mov_b32 v85, v105
    v_mov_b32 v86, v106
    v_mov_b32 v87, v107
    s_nop 1
L_khj_46:
    s_waitcnt lgkmcnt(0)
    s_barrier
    ds_read_b128 v[108:111], v160 offset:0
    ds_read_b128 v[112:115], v160 offset:1024
    ds_read_b128 v[116:119], v160 offset:2048
    ds_read_b128 v[120:123], v160 offset:3072
    ds_read_b128 v[124:127], v160 offset:4096
    s_waitcnt lgkmcnt(0)
    v_pk_add_f32 v[68:69], v[68:69], v[108:109]
    v_pk_add_f32 v[70:71], v[70:71], v[110:111]
    v_pk_add_f32 v[72:73], v[72:73], v[112:113]
    v_pk_add_f32 v[74:75], v[74:75], v[114:115]
    v_pk_add_f32 v[76:77], v[76:77], v[116:117]
    v_pk_add_f32 v[78:79], v[78:79], v[118:119]
    v_pk_add_f32 v[80:81], v[80:81], v[120:121]
    v_pk_add_f32 v[82:83], v[82:83], v[122:123]
    v_pk_add_f32 v[84:85], v[84:85], v[124:125]
    v_pk_add_f32 v[86:87], v[86:87], v[126:127]
    v_lshlrev_b32 v159, 16, v148
    v_and_b32 v160, 0xffff0000, v148
    v_add_f32 v159, v159, v236
    v_add_f32 v160, v160, v237
    v_add_f32 v68, v68, v159
    v_add_f32 v69, v69, v160
    v_cvt_pk_bf16_f32 v164, v68, v69
    v_lshlrev_b32 v159, 16, v149
    v_and_b32 v160, 0xffff0000, v149
    v_add_f32 v159, v159, v238
    v_add_f32 v160, v160, v239
    v_add_f32 v70, v70, v159
    v_add_f32 v71, v71, v160
    v_cvt_pk_bf16_f32 v165, v70, v71
    v_lshlrev_b32 v159, 16, v150
    v_and_b32 v160, 0xffff0000, v150
    v_add_f32 v159, v159, v240
    v_add_f32 v160, v160, v241
    v_add_f32 v72, v72, v159
    v_add_f32 v73, v73, v160
    v_cvt_pk_bf16_f32 v166, v72, v73
    v_lshlrev_b32 v159, 16, v151
    v_and_b32 v160, 0xffff0000, v151
    v_add_f32 v159, v159, v242
    v_add_f32 v160, v160, v243
    v_add_f32 v74, v74, v159
    v_add_f32 v75, v75, v160
    v_cvt_pk_bf16_f32 v167, v74, v75
    v_lshlrev_b32 v159, 16, v152
    v_and_b32 v160, 0xffff0000, v152
    v_add_f32 v159, v159, v244
    v_add_f32 v160, v160, v245
    v_add_f32 v76, v76, v159
    v_add_f32 v77, v77, v160
    v_cvt_pk_bf16_f32 v168, v76, v77
    v_lshlrev_b32 v159, 16, v153
    v_and_b32 v160, 0xffff0000, v153
    v_add_f32 v159, v159, v246
    v_add_f32 v160, v160, v247
    v_add_f32 v78, v78, v159
    v_add_f32 v79, v79, v160
    v_cvt_pk_bf16_f32 v169, v78, v79
    v_lshlrev_b32 v159, 16, v154
    v_and_b32 v160, 0xffff0000, v154
    v_add_f32 v159, v159, v248
    v_add_f32 v160, v160, v249
    v_add_f32 v80, v80, v159
    v_add_f32 v81, v81, v160
    v_cvt_pk_bf16_f32 v170, v80, v81
    v_lshlrev_b32 v159, 16, v155
    v_and_b32 v160, 0xffff0000, v155
    v_add_f32 v159, v159, v250
    v_add_f32 v160, v160, v251
    v_add_f32 v82, v82, v159
    v_add_f32 v83, v83, v160
    v_cvt_pk_bf16_f32 v171, v82, v83
    v_lshlrev_b32 v159, 16, v156
    v_and_b32 v160, 0xffff0000, v156
    v_add_f32 v159, v159, v252
    v_add_f32 v160, v160, v253
    v_add_f32 v84, v84, v159
    v_add_f32 v85, v85, v160
    v_cvt_pk_bf16_f32 v172, v84, v85
    v_lshlrev_b32 v159, 16, v157
    v_and_b32 v160, 0xffff0000, v157
    v_add_f32 v159, v159, v254
    v_add_f32 v160, v160, v255
    v_add_f32 v86, v86, v159
    v_add_f32 v87, v87, v160
    v_cvt_pk_bf16_f32 v173, v86, v87
    v_and_b32 v159, 15, v0
    v_lshrrev_b32 v160, 4, v0
    v_mul_u32_u24 v161, 0x500, v159
    v_lshl_add_u32 v161, v160, 3, v161
    buffer_store_dwordx2 v[164:165], v161, s[28:31], s74 offen offset:0
    buffer_store_dwordx2 v[166:167], v161, s[28:31], s74 offen offset:32
    buffer_store_dwordx2 v[168:169], v161, s[28:31], s74 offen offset:64
    buffer_store_dwordx2 v[170:171], v161, s[28:31], s74 offen offset:96
    buffer_store_dwordx2 v[172:173], v161, s[28:31], s74 offen offset:128
    s_branch L_rest_done
L_rest_loader:
    v_and_b32 v1, 15, v0
    v_lshlrev_b32 v1, 2, v1
    v_add_u32 v1, 16384, v1
    s_mov_b32 s56, 0
    s_nop 0
L_poll_47:
    buffer_load_dword v2, v1, s[24:27], 0 offen sc1
    s_waitcnt vmcnt(0)
    v_xor_b32 v2, s45, v2
    v_cmp_ne_u32 vcc, 0, v2
    s_nop 2
    s_cmp_eq_u64 vcc, 0
    s_nop 0
    s_cbranch_scc1 L_polldone_48
    s_add_u32 s56, s56, 1
    s_cmp_lt_u32 s56, 131072
    s_cbranch_scc0 L_polldone_48
    s_branch L_poll_47
L_polldone_48:
    v_lshlrev_b32 v1, 4, v0
    s_barrier
    v_mov_b32 v4, 0
    ds_read_b32 v3, v4 offset:0
    s_waitcnt lgkmcnt(0)
    v_readfirstlane_b32 s100, v3
    s_barrier
    s_lshr_b32 s51, s46, 1
    s_lshl_b32 s52, s44, 1
    s_add_u32 s52, s52, s51
    s_mul_i32 s52, s52, 81920
    s_and_b32 s51, s46, 1
    s_cmp_eq_u32 s51, 0
    s_mov_b32 s53, 5308416
    s_cselect_b32 s53, 2686976, s53
    s_add_u32 s52, s52, s53
    s_mul_i32 s53, s43, 5120
    s_add_u32 s52, s52, s53
    s_sub_u32 s52, s52, 10240
    s_mul_i32 s53, s46, 15360
    s_mov_b32 s54, s52
    s_add_u32 m0, s53, 10240
    s_add_u32 s55, s54, 10240
    buffer_load_dwordx4 v1, s[24:27], s55 offen sc1 lds
    s_add_u32 m0, s53, 11264
    s_add_u32 s55, s54, 11264
    buffer_load_dwordx4 v1, s[24:27], s55 offen sc1 lds
    s_add_u32 m0, s53, 12288
    s_add_u32 s55, s54, 12288
    buffer_load_dwordx4 v1, s[24:27], s55 offen sc1 lds
    s_add_u32 m0, s53, 13312
    s_add_u32 s55, s54, 13312
    buffer_load_dwordx4 v1, s[24:27], s55 offen sc1 lds
    s_add_u32 m0, s53, 14336
    s_add_u32 s55, s54, 14336
    buffer_load_dwordx4 v1, s[24:27], s55 offen sc1 lds
    s_cmp_ge_u32 s43, 1
    s_cselect_b32 s54, s52, 0x7f000000
    s_add_u32 m0, s53, 5120
    s_add_u32 s55, s54, 5120
    buffer_load_dwordx4 v1, s[24:27], s55 offen sc1 lds
    s_add_u32 m0, s53, 6144
    s_add_u32 s55, s54, 6144
    buffer_load_dwordx4 v1, s[24:27], s55 offen sc1 lds
    s_add_u32 m0, s53, 7168
    s_add_u32 s55, s54, 7168
    buffer_load_dwordx4 v1, s[24:27], s55 offen sc1 lds
    s_add_u32 m0, s53, 8192
    s_add_u32 s55, s54, 8192
    buffer_load_dwordx4 v1, s[24:27], s55 offen sc1 lds
    s_add_u32 m0, s53, 9216
    s_add_u32 s55, s54, 9216
    buffer_load_dwordx4 v1, s[24:27], s55 offen sc1 lds
    s_cmp_ge_u32 s43, 2
    s_cselect_b32 s54, s52, 0x7f000000
    s_add_u32 m0, s53, 0
    s_add_u32 s55, s54, 0
    buffer_load_dwordx4 v1, s[24:27], s55 offen sc1 lds
    s_add_u32 m0, s53, 1024
    s_add_u32 s55, s54, 1024
    buffer_load_dwordx4 v1, s[24:27], s55 offen sc1 lds
    s_add_u32 m0, s53, 2048
    s_add_u32 s55, s54, 2048
    buffer_load_dwordx4 v1, s[24:27], s55 offen sc1 lds
    s_add_u32 m0, s53, 3072
    s_add_u32 s55, s54, 3072
    buffer_load_dwordx4 v1, s[24:27], s55 offen sc1 lds
    s_add_u32 m0, s53, 4096
    s_add_u32 s55, s54, 4096
    buffer_load_dwordx4 v1, s[24:27], s55 offen sc1 lds
    s_waitcnt vmcnt(0)
    s_barrier
    v_add_u32 v13, 0, v0
    v_mul_u32_u24 v14, 6554, v13
    v_lshrrev_b32 v14, 16, v14
    v_mul_u32_u24 v15, 10, v14
    v_sub_u32 v13, v13, v15
    v_and_b32 v15, 3, v14
    v_mul_u32_u24 v8, 1, v15
    v_bfe_u32 v15, v14, 2, 2
    v_mad_u32_u24 v8, v15, 40, v8
    v_lshrrev_b32 v15, 4, v14
    v_mad_u32_u24 v8, v15, 20, v8
    v_mul_u32_u24 v8, 1280, v8
    v_lshl_add_u32 v8, v13, 4, v8
    v_add_u32 v13, 64, v0
    v_mul_u32_u24 v14, 6554, v13
    v_lshrrev_b32 v14, 16, v14
    v_mul_u32_u24 v15, 10, v14
    v_sub_u32 v13, v13, v15
    v_and_b32 v15, 3, v14
    v_mul_u32_u24 v9, 1, v15
    v_bfe_u32 v15, v14, 2, 2
    v_mad_u32_u24 v9, v15, 40, v9
    v_lshrrev_b32 v15, 4, v14
    v_mad_u32_u24 v9, v15, 20, v9
    v_mul_u32_u24 v9, 1280, v9
    v_lshl_add_u32 v9, v13, 4, v9
    v_add_u32 v13, 128, v0
    v_mul_u32_u24 v14, 6554, v13
    v_lshrrev_b32 v14, 16, v14
    v_mul_u32_u24 v15, 10, v14
    v_sub_u32 v13, v13, v15
    v_and_b32 v15, 3, v14
    v_mul_u32_u24 v10, 1, v15
    v_bfe_u32 v15, v14, 2, 2
    v_mad_u32_u24 v10, v15, 40, v10
    v_lshrrev_b32 v15, 4, v14
    v_mad_u32_u24 v10, v15, 20, v10
    v_mul_u32_u24 v10, 1280, v10
    v_lshl_add_u32 v10, v13, 4, v10
    v_add_u32 v13, 192, v0
    v_mul_u32_u24 v14, 6554, v13
    v_lshrrev_b32 v14, 16, v14
    v_mul_u32_u24 v15, 10, v14
    v_sub_u32 v13, v13, v15
    v_and_b32 v15, 3, v14
    v_mul_u32_u24 v11, 1, v15
    v_bfe_u32 v15, v14, 2, 2
    v_mad_u32_u24 v11, v15, 40, v11
    v_lshrrev_b32 v15, 4, v14
    v_mad_u32_u24 v11, v15, 20, v11
    v_mul_u32_u24 v11, 1280, v11
    v_lshl_add_u32 v11, v13, 4, v11
    v_add_u32 v13, 256, v0
    v_mul_u32_u24 v14, 6554, v13
    v_lshrrev_b32 v14, 16, v14
    v_mul_u32_u24 v15, 10, v14
    v_sub_u32 v13, v13, v15
    v_and_b32 v15, 3, v14
    v_mul_u32_u24 v12, 1, v15
    v_bfe_u32 v15, v14, 2, 2
    v_mad_u32_u24 v12, v15, 40, v12
    v_lshrrev_b32 v15, 4, v14
    v_mad_u32_u24 v12, v15, 20, v12
    v_mul_u32_u24 v12, 1280, v12
    v_lshl_add_u32 v12, v13, 4, v12
    s_mul_i32 s50, s59, 160
    s_mul_i32 s51, s46, 204800
    s_add_u32 s50, s50, s51
    s_mul_i32 s51, s46, 5120
    s_add_u32 m0, s51, 61440
    s_add_u32 s52, s50, 0
    buffer_load_dwordx4 v8, s[12:15], s52 offen lds
    s_add_u32 m0, s51, 62464
    s_add_u32 s52, s50, 0
    buffer_load_dwordx4 v9, s[12:15], s52 offen lds
    s_add_u32 m0, s51, 63488
    s_add_u32 s52, s50, 0
    buffer_load_dwordx4 v10, s[12:15], s52 offen lds
    s_add_u32 m0, s51, 64512
    s_add_u32 s52, s50, 0
    buffer_load_dwordx4 v11, s[12:15], s52 offen lds
    s_add_u32 m0, s51, 65536
    s_add_u32 s52, s50, 0
    buffer_load_dwordx4 v12, s[12:15], s52 offen lds
    s_add_u32 m0, s51, 81920
    s_add_u32 s52, s50, 5120
    buffer_load_dwordx4 v8, s[12:15], s52 offen lds
    s_add_u32 m0, s51, 82944
    s_add_u32 s52, s50, 5120
    buffer_load_dwordx4 v9, s[12:15], s52 offen lds
    s_add_u32 m0, s51, 83968
    s_add_u32 s52, s50, 5120
    buffer_load_dwordx4 v10, s[12:15], s52 offen lds
    s_add_u32 m0, s51, 84992
    s_add_u32 s52, s50, 5120
    buffer_load_dwordx4 v11, s[12:15], s52 offen lds
    s_add_u32 m0, s51, 86016
    s_add_u32 s52, s50, 5120
    buffer_load_dwordx4 v12, s[12:15], s52 offen lds
    s_add_u32 m0, s51, 102400
    s_add_u32 s52, s50, 10240
    buffer_load_dwordx4 v8, s[12:15], s52 offen lds
    s_add_u32 m0, s51, 103424
    s_add_u32 s52, s50, 10240
    buffer_load_dwordx4 v9, s[12:15], s52 offen lds
    s_add_u32 m0, s51, 104448
    s_add_u32 s52, s50, 10240
    buffer_load_dwordx4 v10, s[12:15], s52 offen lds
    s_add_u32 m0, s51, 105472
    s_add_u32 s52, s50, 10240
    buffer_load_dwordx4 v11, s[12:15], s52 offen lds
    s_add_u32 m0, s51, 106496
    s_add_u32 s52, s50, 10240
    buffer_load_dwordx4 v12, s[12:15], s52 offen lds
    s_add_u32 m0, s51, 122880
    s_add_u32 s52, s50, 15360
    buffer_load_dwordx4 v8, s[12:15], s52 offen lds
    s_add_u32 m0, s51, 123904
    s_add_u32 s52, s50, 15360
    buffer_load_dwordx4 v9, s[12:15], s52 offen lds
    s_add_u32 m0, s51, 124928
    s_add_u32 s52, s50, 15360
    buffer_load_dwordx4 v10, s[12:15], s52 offen lds
    s_add_u32 m0, s51, 125952
    s_add_u32 s52, s50, 15360
    buffer_load_dwordx4 v11, s[12:15], s52 offen lds
    s_add_u32 m0, s51, 126976
    s_add_u32 s52, s50, 15360
    buffer_load_dwordx4 v12, s[12:15], s52 offen lds
    s_add_u32 m0, s51, 143360
    s_add_u32 s52, s50, 20480
    buffer_load_dwordx4 v8, s[12:15], s52 offen lds
    s_add_u32 m0, s51, 144384
    s_add_u32 s52, s50, 20480
    buffer_load_dwordx4 v9, s[12:15], s52 offen lds
    s_add_u32 m0, s51, 145408
    s_add_u32 s52, s50, 20480
    buffer_load_dwordx4 v10, s[12:15], s52 offen lds
    s_add_u32 m0, s51, 146432
    s_add_u32 s52, s50, 20480
    buffer_load_dwordx4 v11, s[12:15], s52 offen lds
    s_add_u32 m0, s51, 147456
    s_add_u32 s52, s50, 20480
    buffer_load_dwordx4 v12, s[12:15], s52 offen lds
    v_lshlrev_b32 v1, 4, v0
    s_lshl_b32 s48, s59, 2
    s_add_u32 s48, s48, s46
    s_mul_i32 s48, s48, 61440
    s_add_u32 s48, s48, 22478848
    buffer_load_dwordx4 v[4:7], v1, s[24:27], s48 offen offset:0 sc1
    buffer_load_dwordx4 v[8:11], v1, s[24:27], s48 offen offset:1024 sc1
    buffer_load_dwordx4 v[12:15], v1, s[24:27], s48 offen offset:2048 sc1
    buffer_load_dwordx4 v[16:19], v1, s[24:27], s48 offen offset:3072 sc1
    s_add_u32 s48, s48, 4096
    buffer_load_dwordx4 v[20:23], v1, s[24:27], s48 offen offset:0 sc1
    buffer_load_dwordx4 v[24:27], v1, s[24:27], s48 offen offset:1024 sc1
    buffer_load_dwordx4 v[28:31], v1, s[24:27], s48 offen offset:2048 sc1
    buffer_load_dwordx4 v[32:35], v1, s[24:27], s48 offen offset:3072 sc1
    s_add_u32 s48, s48, 4096
    buffer_load_dwordx4 v[36:39], v1, s[24:27], s48 offen offset:0 sc1
    buffer_load_dwordx4 v[40:43], v1, s[24:27], s48 offen offset:1024 sc1
    buffer_load_dwordx4 v[44:47], v1, s[24:27], s48 offen offset:2048 sc1
    buffer_load_dwordx4 v[48:51], v1, s[24:27], s48 offen offset:3072 sc1
    s_add_u32 s48, s48, 4096
    buffer_load_dwordx4 v[52:55], v1, s[24:27], s48 offen offset:0 sc1
    buffer_load_dwordx4 v[56:59], v1, s[24:27], s48 offen offset:1024 sc1
    buffer_load_dwordx4 v[60:63], v1, s[24:27], s48 offen offset:2048 sc1
    buffer_load_dwordx4 v[64:67], v1, s[24:27], s48 offen offset:3072 sc1
    s_add_u32 s48, s48, 4096
    buffer_load_dwordx4 v[68:71], v1, s[24:27], s48 offen offset:0 sc1
    buffer_load_dwordx4 v[72:75], v1, s[24:27], s48 offen offset:1024 sc1
    buffer_load_dwordx4 v[76:79], v1, s[24:27], s48 offen offset:2048 sc1
    buffer_load_dwordx4 v[80:83], v1, s[24:27], s48 offen offset:3072 sc1
    s_add_u32 s48, s48, 4096
    buffer_load_dwordx4 v[84:87], v1, s[24:27], s48 offen offset:0 sc1
    buffer_load_dwordx4 v[88:91], v1, s[24:27], s48 offen offset:1024 sc1
    buffer_load_dwordx4 v[92:95], v1, s[24:27], s48 offen offset:2048 sc1
    buffer_load_dwordx4 v[96:99], v1, s[24:27], s48 offen offset:3072 sc1
    s_add_u32 s48, s48, 4096
    buffer_load_dwordx4 v[100:103], v1, s[24:27], s48 offen offset:0 sc1
    buffer_load_dwordx4 v[104:107], v1, s[24:27], s48 offen offset:1024 sc1
    buffer_load_dwordx4 v[108:111], v1, s[24:27], s48 offen offset:2048 sc1
    buffer_load_dwordx4 v[112:115], v1, s[24:27], s48 offen offset:3072 sc1
    s_add_u32 s48, s48, 4096
    buffer_load_dwordx4 v[116:119], v1, s[24:27], s48 offen offset:0 sc1
    buffer_load_dwordx4 v[120:123], v1, s[24:27], s48 offen offset:1024 sc1
    buffer_load_dwordx4 v[124:127], v1, s[24:27], s48 offen offset:2048 sc1
    buffer_load_dwordx4 v[128:131], v1, s[24:27], s48 offen offset:3072 sc1
    s_add_u32 s48, s48, 4096
    buffer_load_dwordx4 v[132:135], v1, s[24:27], s48 offen offset:0 sc1
    buffer_load_dwordx4 v[136:139], v1, s[24:27], s48 offen offset:1024 sc1
    buffer_load_dwordx4 v[140:143], v1, s[24:27], s48 offen offset:2048 sc1
    buffer_load_dwordx4 v[144:147], v1, s[24:27], s48 offen offset:3072 sc1
    s_mov_b32 s48, s47
    s_mul_i32 s48, s48, 15360
    v_lshlrev_b32 v2, 7, v0
    s_mov_b32 exec_hi, 0xfffffff
    buffer_load_dword v250, v2, s[20:23], s48 offen
    s_mov_b64 exec, -1
    s_add_u32 s48, s48, 7680
    s_mov_b32 exec_hi, 0xfffffff
    buffer_load_dword v251, v2, s[20:23], s48 offen
    s_mov_b64 exec, -1
    v_add_u32 v153, 0, v0
    v_mul_u32_u24 v154, 6554, v153
    v_lshrrev_b32 v154, 16, v154
    v_mul_u32_u24 v155, 10, v154
    v_sub_u32 v153, v153, v155
    v_and_b32 v155, 3, v154
    v_mul_u32_u24 v148, 1, v155
    v_bfe_u32 v155, v154, 2, 2
    v_mad_u32_u24 v148, v155, 4, v148
    v_lshrrev_b32 v155, 4, v154
    v_mad_u32_u24 v148, v155, 16, v148
    v_mul_u32_u24 v148, 1280, v148
    v_lshl_add_u32 v148, v153, 4, v148
    v_add_u32 v153, 64, v0
    v_mul_u32_u24 v154, 6554, v153
    v_lshrrev_b32 v154, 16, v154
    v_mul_u32_u24 v155, 10, v154
    v_sub_u32 v153, v153, v155
    v_and_b32 v155, 3, v154
    v_mul_u32_u24 v149, 1, v155
    v_bfe_u32 v155, v154, 2, 2
    v_mad_u32_u24 v149, v155, 4, v149
    v_lshrrev_b32 v155, 4, v154
    v_mad_u32_u24 v149, v155, 16, v149
    v_mul_u32_u24 v149, 1280, v149
    v_lshl_add_u32 v149, v153, 4, v149
    v_add_u32 v153, 128, v0
    v_mul_u32_u24 v154, 6554, v153
    v_lshrrev_b32 v154, 16, v154
    v_mul_u32_u24 v155, 10, v154
    v_sub_u32 v153, v153, v155
    v_and_b32 v155, 3, v154
    v_mul_u32_u24 v150, 1, v155
    v_bfe_u32 v155, v154, 2, 2
    v_mad_u32_u24 v150, v155, 4, v150
    v_lshrrev_b32 v155, 4, v154
    v_mad_u32_u24 v150, v155, 16, v150
    v_mul_u32_u24 v150, 1280, v150
    v_lshl_add_u32 v150, v153, 4, v150
    v_add_u32 v153, 192, v0
    v_mul_u32_u24 v154, 6554, v153
    v_lshrrev_b32 v154, 16, v154
    v_mul_u32_u24 v155, 10, v154
    v_sub_u32 v153, v153, v155
    v_and_b32 v155, 3, v154
    v_mul_u32_u24 v151, 1, v155
    v_bfe_u32 v155, v154, 2, 2
    v_mad_u32_u24 v151, v155, 4, v151
    v_lshrrev_b32 v155, 4, v154
    v_mad_u32_u24 v151, v155, 16, v151
    v_mul_u32_u24 v151, 1280, v151
    v_lshl_add_u32 v151, v153, 4, v151
    v_add_u32 v153, 256, v0
    v_mul_u32_u24 v154, 6554, v153
    v_lshrrev_b32 v154, 16, v154
    v_mul_u32_u24 v155, 10, v154
    v_sub_u32 v153, v153, v155
    v_and_b32 v155, 3, v154
    v_mul_u32_u24 v152, 1, v155
    v_bfe_u32 v155, v154, 2, 2
    v_mad_u32_u24 v152, v155, 4, v152
    v_lshrrev_b32 v155, 4, v154
    v_mad_u32_u24 v152, v155, 16, v152
    v_mul_u32_u24 v152, 1280, v152
    v_lshl_add_u32 v152, v153, 4, v152
    s_mul_i32 s68, s59, 160
    s_mul_i32 s69, s46, 40960
    s_add_u32 s68, s68, s69
    s_mul_i32 s69, s46, 5120
    s_waitcnt vmcnt(2)
    v_mov_b32 v168, s57
    v_mov_b32 v169, s57
    v_mov_b32 v170, s57
    v_mov_b32 v171, s57
    s_nop 1
    v_mfma_f32_16x16x32_bf16 v[156:159], v[4:7], v[168:171], 0
    v_mfma_f32_16x16x32_bf16 v[160:163], v[8:11], v[168:171], 0
    v_mfma_f32_16x16x32_bf16 v[164:167], v[12:15], v[168:171], 0
    v_mfma_f32_16x16x32_bf16 v[156:159], v[16:19], v[168:171], v[156:159]
    v_mfma_f32_16x16x32_bf16 v[160:163], v[20:23], v[168:171], v[160:163]
    v_mfma_f32_16x16x32_bf16 v[164:167], v[24:27], v[168:171], v[164:167]
    v_mfma_f32_16x16x32_bf16 v[156:159], v[28:31], v[168:171], v[156:159]
    v_mfma_f32_16x16x32_bf16 v[160:163], v[32:35], v[168:171], v[160:163]
    v_mfma_f32_16x16x32_bf16 v[164:167], v[36:39], v[168:171], v[164:167]
    v_mfma_f32_16x16x32_bf16 v[156:159], v[40:43], v[168:171], v[156:159]
    v_mfma_f32_16x16x32_bf16 v[160:163], v[44:47], v[168:171], v[160:163]
    v_mfma_f32_16x16x32_bf16 v[164:167], v[48:51], v[168:171], v[164:167]
    v_mfma_f32_16x16x32_bf16 v[156:159], v[52:55], v[168:171], v[156:159]
    v_mfma_f32_16x16x32_bf16 v[160:163], v[56:59], v[168:171], v[160:163]
    v_mfma_f32_16x16x32_bf16 v[164:167], v[60:63], v[168:171], v[164:167]
    v_mfma_f32_16x16x32_bf16 v[156:159], v[64:67], v[168:171], v[156:159]
    v_mfma_f32_16x16x32_bf16 v[160:163], v[68:71], v[168:171], v[160:163]
    v_mfma_f32_16x16x32_bf16 v[164:167], v[72:75], v[168:171], v[164:167]
    v_mfma_f32_16x16x32_bf16 v[156:159], v[76:79], v[168:171], v[156:159]
    v_mfma_f32_16x16x32_bf16 v[160:163], v[80:83], v[168:171], v[160:163]
    v_mfma_f32_16x16x32_bf16 v[164:167], v[84:87], v[168:171], v[164:167]
    v_mfma_f32_16x16x32_bf16 v[156:159], v[88:91], v[168:171], v[156:159]
    v_mfma_f32_16x16x32_bf16 v[160:163], v[92:95], v[168:171], v[160:163]
    v_mfma_f32_16x16x32_bf16 v[164:167], v[96:99], v[168:171], v[164:167]
    v_mfma_f32_16x16x32_bf16 v[156:159], v[100:103], v[168:171], v[156:159]
    v_mfma_f32_16x16x32_bf16 v[160:163], v[104:107], v[168:171], v[160:163]
    v_mfma_f32_16x16x32_bf16 v[164:167], v[108:111], v[168:171], v[164:167]
    v_mfma_f32_16x16x32_bf16 v[156:159], v[112:115], v[168:171], v[156:159]
    v_mfma_f32_16x16x32_bf16 v[160:163], v[116:119], v[168:171], v[160:163]
    v_mfma_f32_16x16x32_bf16 v[164:167], v[120:123], v[168:171], v[164:167]
    v_mfma_f32_16x16x32_bf16 v[156:159], v[124:127], v[168:171], v[156:159]
    v_mfma_f32_16x16x32_bf16 v[160:163], v[128:131], v[168:171], v[160:163]
    v_mfma_f32_16x16x32_bf16 v[164:167], v[132:135], v[168:171], v[164:167]
    v_mfma_f32_16x16x32_bf16 v[156:159], v[136:139], v[168:171], v[156:159]
    v_mfma_f32_16x16x32_bf16 v[160:163], v[140:143], v[168:171], v[160:163]
    v_mfma_f32_16x16x32_bf16 v[164:167], v[144:147], v[168:171], v[164:167]
    s_barrier
    s_add_u32 m0, s69, 0
    s_add_u32 s50, s68, 0
    buffer_load_dwordx4 v148, s[20:23], s50 offen lds
    s_add_u32 m0, s69, 1024
    s_add_u32 s50, s68, 0
    buffer_load_dwordx4 v149, s[20:23], s50 offen lds
    s_add_u32 m0, s69, 2048
    s_add_u32 s50, s68, 0
    buffer_load_dwordx4 v150, s[20:23], s50 offen lds
    s_add_u32 m0, s69, 3072
    s_add_u32 s50, s68, 0
    buffer_load_dwordx4 v151, s[20:23], s50 offen lds
    s_add_u32 m0, s69, 4096
    s_add_u32 s50, s68, 0
    buffer_load_dwordx4 v152, s[20:23], s50 offen lds
    s_add_u32 m0, s69, 20480
    s_add_u32 s50, s68, 983040
    buffer_load_dwordx4 v148, s[20:23], s50 offen lds
    s_add_u32 m0, s69, 21504
    s_add_u32 s50, s68, 983040
    buffer_load_dwordx4 v149, s[20:23], s50 offen lds
    s_add_u32 m0, s69, 22528
    s_add_u32 s50, s68, 983040
    buffer_load_dwordx4 v150, s[20:23], s50 offen lds
    s_add_u32 m0, s69, 23552
    s_add_u32 s50, s68, 983040
    buffer_load_dwordx4 v151, s[20:23], s50 offen lds
    s_add_u32 m0, s69, 24576
    s_add_u32 s50, s68, 983040
    buffer_load_dwordx4 v152, s[20:23], s50 offen lds
    s_add_u32 m0, s69, 40960
    s_add_u32 s50, s68, 163840
    buffer_load_dwordx4 v148, s[20:23], s50 offen lds
    s_add_u32 m0, s69, 41984
    s_add_u32 s50, s68, 163840
    buffer_load_dwordx4 v149, s[20:23], s50 offen lds
    s_add_u32 m0, s69, 43008
    s_add_u32 s50, s68, 163840
    buffer_load_dwordx4 v150, s[20:23], s50 offen lds
    s_add_u32 m0, s69, 44032
    s_add_u32 s50, s68, 163840
    buffer_load_dwordx4 v151, s[20:23], s50 offen lds
    s_add_u32 m0, s69, 45056
    s_add_u32 s50, s68, 163840
    buffer_load_dwordx4 v152, s[20:23], s50 offen lds
    s_barrier
    s_barrier
    s_and_b32 s53, s42, 24
    v_and_b32 v150, 7, v0
    s_lshl_b32 s54, s41, 5
    s_add_u32 s54, s54, s53
    s_lshl_b32 s54, s54, 4
    s_lshl_b32 s55, s46, 2
    s_add_u32 s54, s54, s55
    s_add_u32 s54, s54, 8192
    v_lshl_add_u32 v150, v150, 4, s54
    s_mov_b32 s56, 0
    s_nop 0
L_poll_49:
    buffer_load_dword v151, v150, s[24:27], 0 offen sc1
    s_waitcnt vmcnt(0)
    v_xor_b32 v151, s45, v151
    v_cmp_ne_u32 vcc, 0, v151
    s_nop 2
    s_cmp_eq_u64 vcc, 0
    s_nop 0
    s_cbranch_scc1 L_polldone_50
    s_add_u32 s56, s56, 1
    s_cmp_lt_u32 s56, 131072
    s_cbranch_scc0 L_polldone_50
    s_branch L_poll_49
L_polldone_50:
    v_lshlrev_b32 v150, 4, v0
    s_lshr_b32 s48, s58, 4
    s_add_u32 s48, s48, s46
    s_mul_i32 s48, s48, 20480
    s_add_u32 s48, s48, 10551296
    s_mul_i32 s49, s46, 20480
    s_add_u32 m0, s49, 81920
    s_add_u32 s50, s48, 0
    buffer_load_dwordx4 v150, s[24:27], s50 offen sc1 lds
    s_add_u32 m0, s49, 82944
    s_add_u32 s50, s48, 1024
    buffer_load_dwordx4 v150, s[24:27], s50 offen sc1 lds
    s_add_u32 m0, s49, 83968
    s_add_u32 s50, s48, 2048
    buffer_load_dwordx4 v150, s[24:27], s50 offen sc1 lds
    s_add_u32 m0, s49, 84992
    s_add_u32 s50, s48, 3072
    buffer_load_dwordx4 v150, s[24:27], s50 offen sc1 lds
    s_add_u32 m0, s49, 86016
    s_add_u32 s50, s48, 4096
    buffer_load_dwordx4 v150, s[24:27], s50 offen sc1 lds
    s_add_u32 m0, s49, 87040
    s_add_u32 s50, s48, 5120
    buffer_load_dwordx4 v150, s[24:27], s50 offen sc1 lds
    s_add_u32 m0, s49, 88064
    s_add_u32 s50, s48, 6144
    buffer_load_dwordx4 v150, s[24:27], s50 offen sc1 lds
    s_add_u32 m0, s49, 89088
    s_add_u32 s50, s48, 7168
    buffer_load_dwordx4 v150, s[24:27], s50 offen sc1 lds
    s_add_u32 m0, s49, 90112
    s_add_u32 s50, s48, 8192
    buffer_load_dwordx4 v150, s[24:27], s50 offen sc1 lds
    s_add_u32 m0, s49, 91136
    s_add_u32 s50, s48, 9216
    buffer_load_dwordx4 v150, s[24:27], s50 offen sc1 lds
    v_lshrrev_b32 v151, 4, v0
    v_lshlrev_b32 v152, 3, v151
    s_mul_i32 s50, s59, 384
    s_mul_i32 s51, s46, 96
    s_add_u32 s50, s50, s51
    buffer_load_dwordx2 v[232:233], v152, s[32:35], s50 offen offset:0
    buffer_load_dwordx2 v[234:235], v152, s[32:35], s50 offen offset:32
    buffer_load_dwordx2 v[236:237], v152, s[32:35], s50 offen offset:64
    v_add_u32 v148, 0x10000, v150
    v_add_u32 v149, 0x20000, v150
    v_and_b32 v155, 15, v0
    v_lshlrev_b32 v155, 6, v155
    s_lshl_b32 s73, s58, 6
    s_add_u32 s73, s73, 22282240
    s_waitcnt vmcnt(0)
    s_barrier
    ds_read_b128 v[216:219], v148 offset:16384
    ds_read_b128 v[220:223], v148 offset:36864
    ds_read_b128 v[224:227], v148 offset:57344
    ds_read_b128 v[228:231], v149 offset:12288
    s_waitcnt lgkmcnt(3)
    v_mfma_f32_16x16x32_bf16 v[168:171], v[4:7], v[216:219], 0
    v_mfma_f32_16x16x32_bf16 v[172:175], v[8:11], v[216:219], 0
    v_mfma_f32_16x16x32_bf16 v[176:179], v[12:15], v[216:219], 0
    ds_read_b128 v[216:219], v148 offset:17408
    s_waitcnt lgkmcnt(3)
    v_mfma_f32_16x16x32_bf16 v[180:183], v[4:7], v[220:223], 0
    v_mfma_f32_16x16x32_bf16 v[184:187], v[8:11], v[220:223], 0
    v_mfma_f32_16x16x32_bf16 v[188:191], v[12:15], v[220:223], 0
    ds_read_b128 v[220:223], v148 offset:37888
    s_waitcnt lgkmcnt(3)
    v_mfma_f32_16x16x32_bf16 v[192:195], v[4:7], v[224:227], 0
    v_mfma_f32_16x16x32_bf16 v[196:199], v[8:11], v[224:227], 0
    v_mfma_f32_16x16x32_bf16 v[200:203], v[12:15], v[224:227], 0
    ds_read_b128 v[224:227], v148 offset:58368
    s_waitcnt lgkmcnt(3)
    v_mfma_f32_16x16x32_bf16 v[204:207], v[4:7], v[228:231], 0
    v_mfma_f32_16x16x32_bf16 v[208:211], v[8:11], v[228:231], 0
    v_mfma_f32_16x16x32_bf16 v[212:215], v[12:15], v[228:231], 0
    ds_read_b128 v[228:231], v149 offset:13312
    s_waitcnt lgkmcnt(3)
    v_mfma_f32_16x16x32_bf16 v[168:171], v[16:19], v[216:219], v[168:171]
    v_mfma_f32_16x16x32_bf16 v[172:175], v[20:23], v[216:219], v[172:175]
    v_mfma_f32_16x16x32_bf16 v[176:179], v[24:27], v[216:219], v[176:179]
    ds_read_b128 v[216:219], v148 offset:18432
    s_waitcnt lgkmcnt(3)
    v_mfma_f32_16x16x32_bf16 v[180:183], v[16:19], v[220:223], v[180:183]
    v_mfma_f32_16x16x32_bf16 v[184:187], v[20:23], v[220:223], v[184:187]
    v_mfma_f32_16x16x32_bf16 v[188:191], v[24:27], v[220:223], v[188:191]
    ds_read_b128 v[220:223], v148 offset:38912
    s_waitcnt lgkmcnt(3)
    v_mfma_f32_16x16x32_bf16 v[192:195], v[16:19], v[224:227], v[192:195]
    v_mfma_f32_16x16x32_bf16 v[196:199], v[20:23], v[224:227], v[196:199]
    v_mfma_f32_16x16x32_bf16 v[200:203], v[24:27], v[224:227], v[200:203]
    ds_read_b128 v[224:227], v148 offset:59392
    s_waitcnt lgkmcnt(3)
    v_mfma_f32_16x16x32_bf16 v[204:207], v[16:19], v[228:231], v[204:207]
    v_mfma_f32_16x16x32_bf16 v[208:211], v[20:23], v[228:231], v[208:211]
    v_mfma_f32_16x16x32_bf16 v[212:215], v[24:27], v[228:231], v[212:215]
    ds_read_b128 v[228:231], v149 offset:14336
    buffer_load_dwordx4 v[4:7], v155, s[24:27], s73 offen offset:2048 sc1
    buffer_load_dwordx4 v[8:11], v155, s[24:27], s73 offen offset:2064 sc1
    buffer_load_dwordx4 v[12:15], v155, s[24:27], s73 offen offset:2080 sc1
    buffer_load_dwordx4 v[16:19], v155, s[24:27], s73 offen offset:2096 sc1
    s_waitcnt lgkmcnt(3)
    v_mfma_f32_16x16x32_bf16 v[168:171], v[28:31], v[216:219], v[168:171]
    v_mfma_f32_16x16x32_bf16 v[172:175], v[32:35], v[216:219], v[172:175]
    v_mfma_f32_16x16x32_bf16 v[176:179], v[36:39], v[216:219], v[176:179]
    ds_read_b128 v[216:219], v148 offset:19456
    s_waitcnt lgkmcnt(3)
    v_mfma_f32_16x16x32_bf16 v[180:183], v[28:31], v[220:223], v[180:183]
    v_mfma_f32_16x16x32_bf16 v[184:187], v[32:35], v[220:223], v[184:187]
    v_mfma_f32_16x16x32_bf16 v[188:191], v[36:39], v[220:223], v[188:191]
    ds_read_b128 v[220:223], v148 offset:39936
    s_waitcnt lgkmcnt(3)
    v_mfma_f32_16x16x32_bf16 v[192:195], v[28:31], v[224:227], v[192:195]
    v_mfma_f32_16x16x32_bf16 v[196:199], v[32:35], v[224:227], v[196:199]
    v_mfma_f32_16x16x32_bf16 v[200:203], v[36:39], v[224:227], v[200:203]
    ds_read_b128 v[224:227], v148 offset:60416
    s_waitcnt lgkmcnt(3)
    v_mfma_f32_16x16x32_bf16 v[204:207], v[28:31], v[228:231], v[204:207]
    v_mfma_f32_16x16x32_bf16 v[208:211], v[32:35], v[228:231], v[208:211]
    v_mfma_f32_16x16x32_bf16 v[212:215], v[36:39], v[228:231], v[212:215]
    ds_read_b128 v[228:231], v149 offset:15360
    s_waitcnt lgkmcnt(3)
    v_mfma_f32_16x16x32_bf16 v[168:171], v[40:43], v[216:219], v[168:171]
    v_mfma_f32_16x16x32_bf16 v[172:175], v[44:47], v[216:219], v[172:175]
    v_mfma_f32_16x16x32_bf16 v[176:179], v[48:51], v[216:219], v[176:179]
    ds_read_b128 v[216:219], v148 offset:20480
    s_waitcnt lgkmcnt(3)
    v_mfma_f32_16x16x32_bf16 v[180:183], v[40:43], v[220:223], v[180:183]
    v_mfma_f32_16x16x32_bf16 v[184:187], v[44:47], v[220:223], v[184:187]
    v_mfma_f32_16x16x32_bf16 v[188:191], v[48:51], v[220:223], v[188:191]
    ds_read_b128 v[220:223], v148 offset:40960
    s_waitcnt lgkmcnt(3)
    v_mfma_f32_16x16x32_bf16 v[192:195], v[40:43], v[224:227], v[192:195]
    v_mfma_f32_16x16x32_bf16 v[196:199], v[44:47], v[224:227], v[196:199]
    v_mfma_f32_16x16x32_bf16 v[200:203], v[48:51], v[224:227], v[200:203]
    ds_read_b128 v[224:227], v148 offset:61440
    s_waitcnt lgkmcnt(3)
    v_mfma_f32_16x16x32_bf16 v[204:207], v[40:43], v[228:231], v[204:207]
    v_mfma_f32_16x16x32_bf16 v[208:211], v[44:47], v[228:231], v[208:211]
    v_mfma_f32_16x16x32_bf16 v[212:215], v[48:51], v[228:231], v[212:215]
    ds_read_b128 v[228:231], v149 offset:16384
    s_waitcnt vmcnt(0)
    s_waitcnt lgkmcnt(3)
    v_mfma_f32_16x16x32_bf16 v[168:171], v[52:55], v[216:219], v[168:171]
    v_add_f32 v150, v4, v6
    v_add_f32 v150, v150, v8
    v_mfma_f32_16x16x32_bf16 v[172:175], v[56:59], v[216:219], v[172:175]
    v_add_f32 v150, v150, v10
    v_add_f32 v150, v150, v12
    v_mfma_f32_16x16x32_bf16 v[176:179], v[60:63], v[216:219], v[176:179]
    v_add_f32 v150, v150, v14
    v_add_f32 v150, v150, v16
    ds_read_b128 v[216:219], v148 offset:21504
    s_waitcnt lgkmcnt(3)
    v_mfma_f32_16x16x32_bf16 v[180:183], v[52:55], v[220:223], v[180:183]
    v_add_f32 v150, v150, v18
    v_mul_f32 v150, 0.125, v150
    v_mfma_f32_16x16x32_bf16 v[184:187], v[56:59], v[220:223], v[184:187]
    v_add_f32 v151, v5, v7
    v_add_f32 v151, v151, v9
    v_mfma_f32_16x16x32_bf16 v[188:191], v[60:63], v[220:223], v[188:191]
    v_add_f32 v151, v151, v11
    v_add_f32 v151, v151, v13
    ds_read_b128 v[220:223], v148 offset:41984
    s_waitcnt lgkmcnt(3)
    v_mfma_f32_16x16x32_bf16 v[192:195], v[52:55], v[224:227], v[192:195]
    v_add_f32 v151, v151, v15
    v_add_f32 v151, v151, v17
    v_mfma_f32_16x16x32_bf16 v[196:199], v[56:59], v[224:227], v[196:199]
    v_add_f32 v151, v151, v19
    v_sub_f32 v152, v4, v150
    v_mfma_f32_16x16x32_bf16 v[200:203], v[60:63], v[224:227], v[200:203]
    v_mul_f32 v153, v152, v152
    v_sub_f32 v152, v6, v150
    ds_read_b128 v[224:227], v148 offset:62464
    s_waitcnt lgkmcnt(3)
    v_mfma_f32_16x16x32_bf16 v[204:207], v[52:55], v[228:231], v[204:207]
    v_fmac_f32 v153, v152, v152
    v_sub_f32 v152, v8, v150
    v_mfma_f32_16x16x32_bf16 v[208:211], v[56:59], v[228:231], v[208:211]
    v_fmac_f32 v153, v152, v152
    v_sub_f32 v152, v10, v150
    v_mfma_f32_16x16x32_bf16 v[212:215], v[60:63], v[228:231], v[212:215]
    v_fmac_f32 v153, v152, v152
    v_sub_f32 v152, v12, v150
    ds_read_b128 v[228:231], v149 offset:17408
    s_waitcnt lgkmcnt(3)
    v_mfma_f32_16x16x32_bf16 v[168:171], v[64:67], v[216:219], v[168:171]
    v_fmac_f32 v153, v152, v152
    v_sub_f32 v152, v14, v150
    v_mfma_f32_16x16x32_bf16 v[172:175], v[68:71], v[216:219], v[172:175]
    v_fmac_f32 v153, v152, v152
    v_sub_f32 v152, v16, v150
    v_mfma_f32_16x16x32_bf16 v[176:179], v[72:75], v[216:219], v[176:179]
    v_fmac_f32 v153, v152, v152
    v_sub_f32 v152, v18, v150
    ds_read_b128 v[216:219], v148 offset:22528
    s_waitcnt lgkmcnt(3)
    v_mfma_f32_16x16x32_bf16 v[180:183], v[64:67], v[220:223], v[180:183]
    v_fmac_f32 v153, v152, v152
    v_mov_b32 v154, 0x42a00000
    v_mfma_f32_16x16x32_bf16 v[184:187], v[68:71], v[220:223], v[184:187]
    v_fmac_f32 v151, v153, v154
    v_mov_b32 v154, 0x3727c5ac
    v_mfma_f32_16x16x32_bf16 v[188:191], v[72:75], v[220:223], v[188:191]
    v_fmac_f32 v154, 0x3acccccd, v151
    v_rsq_f32 v238, v154
    ds_read_b128 v[220:223], v148 offset:43008
    s_waitcnt lgkmcnt(3)
    v_mfma_f32_16x16x32_bf16 v[192:195], v[64:67], v[224:227], v[192:195]
    v_mul_f32 v240, v150, v238
    v_sub_f32 v240, 0, v240
    v_mfma_f32_16x16x32_bf16 v[196:199], v[68:71], v[224:227], v[196:199]
    v_mfma_f32_16x16x32_bf16 v[200:203], v[72:75], v[224:227], v[200:203]
    ds_read_b128 v[224:227], v148 offset:63488
    s_waitcnt lgkmcnt(3)
    v_mfma_f32_16x16x32_bf16 v[204:207], v[64:67], v[228:231], v[204:207]
    v_mfma_f32_16x16x32_bf16 v[208:211], v[68:71], v[228:231], v[208:211]
    v_mfma_f32_16x16x32_bf16 v[212:215], v[72:75], v[228:231], v[212:215]
    ds_read_b128 v[228:231], v149 offset:18432
    buffer_load_dwordx4 v[4:7], v155, s[24:27], s73 offen offset:3072 sc1
    buffer_load_dwordx4 v[8:11], v155, s[24:27], s73 offen offset:3088 sc1
    buffer_load_dwordx4 v[12:15], v155, s[24:27], s73 offen offset:3104 sc1
    buffer_load_dwordx4 v[16:19], v155, s[24:27], s73 offen offset:3120 sc1
    s_waitcnt lgkmcnt(3)
    v_mfma_f32_16x16x32_bf16 v[168:171], v[76:79], v[216:219], v[168:171]
    v_mfma_f32_16x16x32_bf16 v[172:175], v[80:83], v[216:219], v[172:175]
    v_mfma_f32_16x16x32_bf16 v[176:179], v[84:87], v[216:219], v[176:179]
    ds_read_b128 v[216:219], v148 offset:23552
    s_waitcnt lgkmcnt(3)
    v_mfma_f32_16x16x32_bf16 v[180:183], v[76:79], v[220:223], v[180:183]
    v_mfma_f32_16x16x32_bf16 v[184:187], v[80:83], v[220:223], v[184:187]
    v_mfma_f32_16x16x32_bf16 v[188:191], v[84:87], v[220:223], v[188:191]
    ds_read_b128 v[220:223], v148 offset:44032
    s_waitcnt lgkmcnt(3)
    v_mfma_f32_16x16x32_bf16 v[192:195], v[76:79], v[224:227], v[192:195]
    v_mfma_f32_16x16x32_bf16 v[196:199], v[80:83], v[224:227], v[196:199]
    v_mfma_f32_16x16x32_bf16 v[200:203], v[84:87], v[224:227], v[200:203]
    ds_read_b128 v[224:227], v148 offset:64512
    s_waitcnt lgkmcnt(3)
    v_mfma_f32_16x16x32_bf16 v[204:207], v[76:79], v[228:231], v[204:207]
    v_mfma_f32_16x16x32_bf16 v[208:211], v[80:83], v[228:231], v[208:211]
    v_mfma_f32_16x16x32_bf16 v[212:215], v[84:87], v[228:231], v[212:215]
    ds_read_b128 v[228:231], v149 offset:19456
    s_waitcnt lgkmcnt(3)
    v_mfma_f32_16x16x32_bf16 v[168:171], v[88:91], v[216:219], v[168:171]
    v_mfma_f32_16x16x32_bf16 v[172:175], v[92:95], v[216:219], v[172:175]
    v_mfma_f32_16x16x32_bf16 v[176:179], v[96:99], v[216:219], v[176:179]
    ds_read_b128 v[216:219], v148 offset:24576
    s_waitcnt lgkmcnt(3)
    v_mfma_f32_16x16x32_bf16 v[180:183], v[88:91], v[220:223], v[180:183]
    v_mfma_f32_16x16x32_bf16 v[184:187], v[92:95], v[220:223], v[184:187]
    v_mfma_f32_16x16x32_bf16 v[188:191], v[96:99], v[220:223], v[188:191]
    ds_read_b128 v[220:223], v148 offset:45056
    s_waitcnt lgkmcnt(3)
    v_mfma_f32_16x16x32_bf16 v[192:195], v[88:91], v[224:227], v[192:195]
    v_mfma_f32_16x16x32_bf16 v[196:199], v[92:95], v[224:227], v[196:199]
    v_mfma_f32_16x16x32_bf16 v[200:203], v[96:99], v[224:227], v[200:203]
    ds_read_b128 v[224:227], v149 offset:0
    s_waitcnt lgkmcnt(3)
    v_mfma_f32_16x16x32_bf16 v[204:207], v[88:91], v[228:231], v[204:207]
    v_mfma_f32_16x16x32_bf16 v[208:211], v[92:95], v[228:231], v[208:211]
    v_mfma_f32_16x16x32_bf16 v[212:215], v[96:99], v[228:231], v[212:215]
    ds_read_b128 v[228:231], v149 offset:20480
    s_waitcnt lgkmcnt(3)
    v_mfma_f32_16x16x32_bf16 v[168:171], v[100:103], v[216:219], v[168:171]
    v_mfma_f32_16x16x32_bf16 v[172:175], v[104:107], v[216:219], v[172:175]
    v_mfma_f32_16x16x32_bf16 v[176:179], v[108:111], v[216:219], v[176:179]
    ds_read_b128 v[216:219], v148 offset:25600
    s_waitcnt lgkmcnt(3)
    v_mfma_f32_16x16x32_bf16 v[180:183], v[100:103], v[220:223], v[180:183]
    v_mfma_f32_16x16x32_bf16 v[184:187], v[104:107], v[220:223], v[184:187]
    v_mfma_f32_16x16x32_bf16 v[188:191], v[108:111], v[220:223], v[188:191]
    ds_read_b128 v[220:223], v148 offset:46080
    s_waitcnt lgkmcnt(3)
    v_mfma_f32_16x16x32_bf16 v[192:195], v[100:103], v[224:227], v[192:195]
    v_mfma_f32_16x16x32_bf16 v[196:199], v[104:107], v[224:227], v[196:199]
    v_mfma_f32_16x16x32_bf16 v[200:203], v[108:111], v[224:227], v[200:203]
    ds_read_b128 v[224:227], v149 offset:1024
    s_waitcnt lgkmcnt(3)
    v_mfma_f32_16x16x32_bf16 v[204:207], v[100:103], v[228:231], v[204:207]
    v_mfma_f32_16x16x32_bf16 v[208:211], v[104:107], v[228:231], v[208:211]
    v_mfma_f32_16x16x32_bf16 v[212:215], v[108:111], v[228:231], v[212:215]
    ds_read_b128 v[228:231], v149 offset:21504
    s_waitcnt lgkmcnt(3)
    v_mfma_f32_16x16x32_bf16 v[168:171], v[112:115], v[216:219], v[168:171]
    v_mfma_f32_16x16x32_bf16 v[172:175], v[116:119], v[216:219], v[172:175]
    v_mfma_f32_16x16x32_bf16 v[176:179], v[120:123], v[216:219], v[176:179]
    ds_read_b128 v[216:219], v148 offset:26624
    s_waitcnt lgkmcnt(3)
    v_mfma_f32_16x16x32_bf16 v[180:183], v[112:115], v[220:223], v[180:183]
    v_mfma_f32_16x16x32_bf16 v[184:187], v[116:119], v[220:223], v[184:187]
    v_mfma_f32_16x16x32_bf16 v[188:191], v[120:123], v[220:223], v[188:191]
    ds_read_b128 v[220:223], v148 offset:47104
    s_waitcnt lgkmcnt(3)
    v_mfma_f32_16x16x32_bf16 v[192:195], v[112:115], v[224:227], v[192:195]
    v_mfma_f32_16x16x32_bf16 v[196:199], v[116:119], v[224:227], v[196:199]
    v_mfma_f32_16x16x32_bf16 v[200:203], v[120:123], v[224:227], v[200:203]
    ds_read_b128 v[224:227], v149 offset:2048
    s_waitcnt lgkmcnt(3)
    v_mfma_f32_16x16x32_bf16 v[204:207], v[112:115], v[228:231], v[204:207]
    v_mfma_f32_16x16x32_bf16 v[208:211], v[116:119], v[228:231], v[208:211]
    v_mfma_f32_16x16x32_bf16 v[212:215], v[120:123], v[228:231], v[212:215]
    ds_read_b128 v[228:231], v149 offset:22528
    s_waitcnt lgkmcnt(3)
    v_mfma_f32_16x16x32_bf16 v[168:171], v[124:127], v[216:219], v[168:171]
    v_mfma_f32_16x16x32_bf16 v[172:175], v[128:131], v[216:219], v[172:175]
    v_mfma_f32_16x16x32_bf16 v[176:179], v[132:135], v[216:219], v[176:179]
    ds_read_b128 v[216:219], v148 offset:27648
    s_waitcnt lgkmcnt(3)
    v_mfma_f32_16x16x32_bf16 v[180:183], v[124:127], v[220:223], v[180:183]
    v_mfma_f32_16x16x32_bf16 v[184:187], v[128:131], v[220:223], v[184:187]
    v_mfma_f32_16x16x32_bf16 v[188:191], v[132:135], v[220:223], v[188:191]
    ds_read_b128 v[220:223], v148 offset:48128
    s_waitcnt lgkmcnt(3)
    v_mfma_f32_16x16x32_bf16 v[192:195], v[124:127], v[224:227], v[192:195]
    v_mfma_f32_16x16x32_bf16 v[196:199], v[128:131], v[224:227], v[196:199]
    v_mfma_f32_16x16x32_bf16 v[200:203], v[132:135], v[224:227], v[200:203]
    ds_read_b128 v[224:227], v149 offset:3072
    s_waitcnt lgkmcnt(3)
    v_mfma_f32_16x16x32_bf16 v[204:207], v[124:127], v[228:231], v[204:207]
    v_mfma_f32_16x16x32_bf16 v[208:211], v[128:131], v[228:231], v[208:211]
    v_mfma_f32_16x16x32_bf16 v[212:215], v[132:135], v[228:231], v[212:215]
    ds_read_b128 v[228:231], v149 offset:23552
    s_waitcnt vmcnt(0)
    s_waitcnt lgkmcnt(3)
    v_mfma_f32_16x16x32_bf16 v[168:171], v[136:139], v[216:219], v[168:171]
    v_add_f32 v150, v4, v6
    v_add_f32 v150, v150, v8
    v_mfma_f32_16x16x32_bf16 v[172:175], v[140:143], v[216:219], v[172:175]
    v_add_f32 v150, v150, v10
    v_add_f32 v150, v150, v12
    v_mfma_f32_16x16x32_bf16 v[176:179], v[144:147], v[216:219], v[176:179]
    v_add_f32 v150, v150, v14
    v_add_f32 v150, v150, v16
    s_waitcnt lgkmcnt(2)
    v_mfma_f32_16x16x32_bf16 v[180:183], v[136:139], v[220:223], v[180:183]
    v_add_f32 v150, v150, v18
    v_mul_f32 v150, 0.125, v150
    v_mfma_f32_16x16x32_bf16 v[184:187], v[140:143], v[220:223], v[184:187]
    v_add_f32 v151, v5, v7
    v_add_f32 v151, v151, v9
    v_mfma_f32_16x16x32_bf16 v[188:191], v[144:147], v[220:223], v[188:191]
    v_add_f32 v151, v151, v11
    v_add_f32 v151, v151, v13
    s_waitcnt lgkmcnt(1)
    v_mfma_f32_16x16x32_bf16 v[192:195], v[136:139], v[224:227], v[192:195]
    v_add_f32 v151, v151, v15
    v_add_f32 v151, v151, v17
    v_mfma_f32_16x16x32_bf16 v[196:199], v[140:143], v[224:227], v[196:199]
    v_add_f32 v151, v151, v19
    v_sub_f32 v152, v4, v150
    v_mfma_f32_16x16x32_bf16 v[200:203], v[144:147], v[224:227], v[200:203]
    v_mul_f32 v153, v152, v152
    v_sub_f32 v152, v6, v150
    s_waitcnt lgkmcnt(0)
    v_mfma_f32_16x16x32_bf16 v[204:207], v[136:139], v[228:231], v[204:207]
    v_fmac_f32 v153, v152, v152
    v_sub_f32 v152, v8, v150
    v_mfma_f32_16x16x32_bf16 v[208:211], v[140:143], v[228:231], v[208:211]
    v_fmac_f32 v153, v152, v152
    v_sub_f32 v152, v10, v150
    v_mfma_f32_16x16x32_bf16 v[212:215], v[144:147], v[228:231], v[212:215]
    v_fmac_f32 v153, v152, v152
    v_sub_f32 v152, v12, v150
    v_fmac_f32 v153, v152, v152
    v_sub_f32 v152, v14, v150
    v_fmac_f32 v153, v152, v152
    v_sub_f32 v152, v16, v150
    v_fmac_f32 v153, v152, v152
    v_sub_f32 v152, v18, v150
    v_fmac_f32 v153, v152, v152
    v_mov_b32 v154, 0x42a00000
    v_fmac_f32 v151, v153, v154
    v_mov_b32 v154, 0x3727c5ac
    v_fmac_f32 v154, 0x3acccccd, v151
    v_rsq_f32 v242, v154
    s_nop 0
    v_mul_f32 v244, v150, v242
    v_sub_f32 v244, 0, v244
    s_barrier
    s_cmp_lg_u32 s40, 4
    s_cbranch_scc1 L_nw_51
    v_lshlrev_b32 v150, 2, v0
    v_add_u32 v150, 155648, v150
    v_mov_b32 v151, 0
    ds_write_b32 v150, v151
    s_nop 0
L_nw_51:
    v_lshlrev_b32 v150, 4, v0
    s_mul_i32 s48, s46, 18432
    s_add_u32 s48, s48, 81920
    v_add_u32 v246, s48, v150
    v_add_u32 v247, 0, v246
    v_add_u32 v246, 9216, v246
    ds_write_b128 v246, v[168:171] offset:0
    ds_write_b128 v246, v[172:175] offset:1024
    ds_write_b128 v246, v[176:179] offset:2048
    ds_write_b128 v246, v[180:183] offset:3072
    ds_write_b128 v246, v[184:187] offset:4096
    ds_write_b128 v246, v[188:191] offset:5120
    ds_write_b128 v246, v[156:159] offset:6144
    ds_write_b128 v246, v[160:163] offset:7168
    ds_write_b128 v246, v[164:167] offset:8192
    s_waitcnt lgkmcnt(0)
    s_barrier
    ds_read_b128 v[168:171], v247 offset:0
    ds_read_b128 v[172:175], v247 offset:1024
    ds_read_b128 v[176:179], v247 offset:2048
    ds_read_b128 v[180:183], v247 offset:3072
    ds_read_b128 v[184:187], v247 offset:4096
    ds_read_b128 v[188:191], v247 offset:5120
    ds_read_b128 v[216:219], v247 offset:6144
    ds_read_b128 v[220:223], v247 offset:7168
    ds_read_b128 v[224:227], v247 offset:8192
    v_lshlrev_b32 v20, 16, v232
    v_and_b32 v21, 0xffff0000, v232
    v_lshlrev_b32 v22, 16, v233
    v_and_b32 v23, 0xffff0000, v233
    v_lshlrev_b32 v24, 16, v234
    v_and_b32 v25, 0xffff0000, v234
    v_lshlrev_b32 v26, 16, v235
    v_and_b32 v27, 0xffff0000, v235
    v_lshlrev_b32 v28, 16, v236
    v_and_b32 v29, 0xffff0000, v236
    v_lshlrev_b32 v30, 16, v237
    v_and_b32 v31, 0xffff0000, v237
    s_waitcnt lgkmcnt(0)
    s_barrier
    v_pk_add_f32 v[156:157], v[156:157], v[216:217]
    v_pk_add_f32 v[158:159], v[158:159], v[218:219]
    v_pk_add_f32 v[160:161], v[160:161], v[220:221]
    v_pk_add_f32 v[162:163], v[162:163], v[222:223]
    v_pk_add_f32 v[164:165], v[164:165], v[224:225]
    v_pk_add_f32 v[166:167], v[166:167], v[226:227]
    v_pk_add_f32 v[192:193], v[192:193], v[168:169]
    v_pk_add_f32 v[194:195], v[194:195], v[170:171]
    v_pk_add_f32 v[196:197], v[196:197], v[172:173]
    v_pk_add_f32 v[198:199], v[198:199], v[174:175]
    v_pk_add_f32 v[200:201], v[200:201], v[176:177]
    v_pk_add_f32 v[202:203], v[202:203], v[178:179]
    v_pk_add_f32 v[204:205], v[204:205], v[180:181]
    v_pk_add_f32 v[206:207], v[206:207], v[182:183]
    v_pk_add_f32 v[208:209], v[208:209], v[184:185]
    v_pk_add_f32 v[210:211], v[210:211], v[186:187]
    v_pk_add_f32 v[212:213], v[212:213], v[188:189]
    v_pk_add_f32 v[214:215], v[214:215], v[190:191]
    s_mov_b32 s70, 0xbdd2d3e8
    s_mov_b32 s71, 0xbdd2d3e8
    v_mov_b32 v248, 0xc0135761
    v_mov_b32 v249, 0xc0135761
    v_pk_fma_f32 v[4:5], v[156:157], v[240:241], v[20:21] op_sel_hi:[1,0,1]
    v_pk_fma_f32 v[6:7], v[158:159], v[240:241], v[22:23] op_sel_hi:[1,0,1]
    v_pk_fma_f32 v[192:193], v[192:193], v[238:239], v[4:5] op_sel_hi:[1,0,1]
    v_pk_fma_f32 v[194:195], v[194:195], v[238:239], v[6:7] op_sel_hi:[1,0,1]
    v_pk_mul_f32 v[4:5], v[192:193], v[192:193]
    v_pk_mul_f32 v[6:7], v[194:195], v[194:195]
    v_pk_fma_f32 v[4:5], v[4:5], s[70:71], v[248:249]
    v_pk_fma_f32 v[6:7], v[6:7], s[70:71], v[248:249]
    v_pk_mul_f32 v[4:5], v[4:5], v[192:193]
    v_pk_mul_f32 v[6:7], v[6:7], v[194:195]
    v_exp_f32 v4, v4
    v_exp_f32 v5, v5
    v_exp_f32 v6, v6
    v_exp_f32 v7, v7
    v_pk_add_f32 v[4:5], v[4:5], 1.0 op_sel_hi:[1,0]
    v_pk_add_f32 v[6:7], v[6:7], 1.0 op_sel_hi:[1,0]
    v_rcp_f32 v4, v4
    v_rcp_f32 v5, v5
    v_rcp_f32 v6, v6
    v_rcp_f32 v7, v7
    v_pk_mul_f32 v[192:193], v[192:193], v[4:5]
    v_pk_mul_f32 v[194:195], v[194:195], v[6:7]
    v_cvt_pk_bf16_f32 v168, v192, v193
    v_cvt_pk_bf16_f32 v169, v194, v195
    v_pk_fma_f32 v[8:9], v[156:157], v[244:245], v[20:21] op_sel_hi:[1,0,1]
    v_pk_fma_f32 v[10:11], v[158:159], v[244:245], v[22:23] op_sel_hi:[1,0,1]
    v_pk_fma_f32 v[204:205], v[204:205], v[242:243], v[8:9] op_sel_hi:[1,0,1]
    v_pk_fma_f32 v[206:207], v[206:207], v[242:243], v[10:11] op_sel_hi:[1,0,1]
    v_pk_mul_f32 v[8:9], v[204:205], v[204:205]
    v_pk_mul_f32 v[10:11], v[206:207], v[206:207]
    v_pk_fma_f32 v[8:9], v[8:9], s[70:71], v[248:249]
    v_pk_fma_f32 v[10:11], v[10:11], s[70:71], v[248:249]
    v_pk_mul_f32 v[8:9], v[8:9], v[204:205]
    v_pk_mul_f32 v[10:11], v[10:11], v[206:207]
    v_exp_f32 v8, v8
    v_exp_f32 v9, v9
    v_exp_f32 v10, v10
    v_exp_f32 v11, v11
    v_pk_add_f32 v[8:9], v[8:9], 1.0 op_sel_hi:[1,0]
    v_pk_add_f32 v[10:11], v[10:11], 1.0 op_sel_hi:[1,0]
    v_rcp_f32 v8, v8
    v_rcp_f32 v9, v9
    v_rcp_f32 v10, v10
    v_rcp_f32 v11, v11
    v_pk_mul_f32 v[204:205], v[204:205], v[8:9]
    v_pk_mul_f32 v[206:207], v[206:207], v[10:11]
    v_cvt_pk_bf16_f32 v172, v204, v205
    v_cvt_pk_bf16_f32 v173, v206, v207
    v_pk_fma_f32 v[4:5], v[160:161], v[240:241], v[24:25] op_sel_hi:[1,0,1]
    v_pk_fma_f32 v[6:7], v[162:163], v[240:241], v[26:27] op_sel_hi:[1,0,1]
    v_pk_fma_f32 v[196:197], v[196:197], v[238:239], v[4:5] op_sel_hi:[1,0,1]
    v_pk_fma_f32 v[198:199], v[198:199], v[238:239], v[6:7] op_sel_hi:[1,0,1]
    v_pk_mul_f32 v[4:5], v[196:197], v[196:197]
    v_pk_mul_f32 v[6:7], v[198:199], v[198:199]
    v_pk_fma_f32 v[4:5], v[4:5], s[70:71], v[248:249]
    v_pk_fma_f32 v[6:7], v[6:7], s[70:71], v[248:249]
    v_pk_mul_f32 v[4:5], v[4:5], v[196:197]
    v_pk_mul_f32 v[6:7], v[6:7], v[198:199]
    v_exp_f32 v4, v4
    v_exp_f32 v5, v5
    v_exp_f32 v6, v6
    v_exp_f32 v7, v7
    v_pk_add_f32 v[4:5], v[4:5], 1.0 op_sel_hi:[1,0]
    v_pk_add_f32 v[6:7], v[6:7], 1.0 op_sel_hi:[1,0]
    v_rcp_f32 v4, v4
    v_rcp_f32 v5, v5
    v_rcp_f32 v6, v6
    v_rcp_f32 v7, v7
    v_pk_mul_f32 v[196:197], v[196:197], v[4:5]
    v_pk_mul_f32 v[198:199], v[198:199], v[6:7]
    v_cvt_pk_bf16_f32 v176, v196, v197
    v_cvt_pk_bf16_f32 v177, v198, v199
    v_pk_fma_f32 v[8:9], v[160:161], v[244:245], v[24:25] op_sel_hi:[1,0,1]
    v_pk_fma_f32 v[10:11], v[162:163], v[244:245], v[26:27] op_sel_hi:[1,0,1]
    v_pk_fma_f32 v[208:209], v[208:209], v[242:243], v[8:9] op_sel_hi:[1,0,1]
    v_pk_fma_f32 v[210:211], v[210:211], v[242:243], v[10:11] op_sel_hi:[1,0,1]
    v_pk_mul_f32 v[8:9], v[208:209], v[208:209]
    v_pk_mul_f32 v[10:11], v[210:211], v[210:211]
    v_pk_fma_f32 v[8:9], v[8:9], s[70:71], v[248:249]
    v_pk_fma_f32 v[10:11], v[10:11], s[70:71], v[248:249]
    v_pk_mul_f32 v[8:9], v[8:9], v[208:209]
    v_pk_mul_f32 v[10:11], v[10:11], v[210:211]
    v_exp_f32 v8, v8
    v_exp_f32 v9, v9
    v_exp_f32 v10, v10
    v_exp_f32 v11, v11
    v_pk_add_f32 v[8:9], v[8:9], 1.0 op_sel_hi:[1,0]
    v_pk_add_f32 v[10:11], v[10:11], 1.0 op_sel_hi:[1,0]
    v_rcp_f32 v8, v8
    v_rcp_f32 v9, v9
    v_rcp_f32 v10, v10
    v_rcp_f32 v11, v11
    v_pk_mul_f32 v[208:209], v[208:209], v[8:9]
    v_pk_mul_f32 v[210:211], v[210:211], v[10:11]
    v_cvt_pk_bf16_f32 v180, v208, v209
    v_cvt_pk_bf16_f32 v181, v210, v211
    v_pk_fma_f32 v[4:5], v[164:165], v[240:241], v[28:29] op_sel_hi:[1,0,1]
    v_pk_fma_f32 v[6:7], v[166:167], v[240:241], v[30:31] op_sel_hi:[1,0,1]
    v_pk_fma_f32 v[200:201], v[200:201], v[238:239], v[4:5] op_sel_hi:[1,0,1]
    v_pk_fma_f32 v[202:203], v[202:203], v[238:239], v[6:7] op_sel_hi:[1,0,1]
    v_pk_mul_f32 v[4:5], v[200:201], v[200:201]
    v_pk_mul_f32 v[6:7], v[202:203], v[202:203]
    v_pk_fma_f32 v[4:5], v[4:5], s[70:71], v[248:249]
    v_pk_fma_f32 v[6:7], v[6:7], s[70:71], v[248:249]
    v_pk_mul_f32 v[4:5], v[4:5], v[200:201]
    v_pk_mul_f32 v[6:7], v[6:7], v[202:203]
    v_exp_f32 v4, v4
    v_exp_f32 v5, v5
    v_exp_f32 v6, v6
    v_exp_f32 v7, v7
    v_pk_add_f32 v[4:5], v[4:5], 1.0 op_sel_hi:[1,0]
    v_pk_add_f32 v[6:7], v[6:7], 1.0 op_sel_hi:[1,0]
    v_rcp_f32 v4, v4
    v_rcp_f32 v5, v5
    v_rcp_f32 v6, v6
    v_rcp_f32 v7, v7
    v_pk_mul_f32 v[200:201], v[200:201], v[4:5]
    v_pk_mul_f32 v[202:203], v[202:203], v[6:7]
    v_cvt_pk_bf16_f32 v184, v200, v201
    v_cvt_pk_bf16_f32 v185, v202, v203
    v_pk_fma_f32 v[8:9], v[164:165], v[244:245], v[28:29] op_sel_hi:[1,0,1]
    v_pk_fma_f32 v[10:11], v[166:167], v[244:245], v[30:31] op_sel_hi:[1,0,1]
    v_pk_fma_f32 v[212:213], v[212:213], v[242:243], v[8:9] op_sel_hi:[1,0,1]
    v_pk_fma_f32 v[214:215], v[214:215], v[242:243], v[10:11] op_sel_hi:[1,0,1]
    v_pk_mul_f32 v[8:9], v[212:213], v[212:213]
    v_pk_mul_f32 v[10:11], v[214:215], v[214:215]
    v_pk_fma_f32 v[8:9], v[8:9], s[70:71], v[248:249]
    v_pk_fma_f32 v[10:11], v[10:11], s[70:71], v[248:249]
    v_pk_mul_f32 v[8:9], v[8:9], v[212:213]
    v_pk_mul_f32 v[10:11], v[10:11], v[214:215]
    v_exp_f32 v8, v8
    v_exp_f32 v9, v9
    v_exp_f32 v10, v10
    v_exp_f32 v11, v11
    v_pk_add_f32 v[8:9], v[8:9], 1.0 op_sel_hi:[1,0]
    v_pk_add_f32 v[10:11], v[10:11], 1.0 op_sel_hi:[1,0]
    v_rcp_f32 v8, v8
    v_rcp_f32 v9, v9
    v_rcp_f32 v10, v10
    v_rcp_f32 v11, v11
    v_pk_mul_f32 v[212:213], v[212:213], v[8:9]
    v_pk_mul_f32 v[214:215], v[214:215], v[10:11]
    v_cvt_pk_bf16_f32 v188, v212, v213
    v_cvt_pk_bf16_f32 v189, v214, v215
    v_and_b32 v150, 15, v0
    v_lshrrev_b32 v151, 4, v0
    v_lshlrev_b32 v152, 8, v151
    v_lshl_add_u32 v152, v150, 4, v152
    s_lshr_b32 s50, s58, 4
    s_mul_i32 s50, s50, 49152
    s_add_u32 s50, s50, 13172736
    s_mul_i32 s51, s59, 12
    s_mul_i32 s52, s46, 3
    s_add_u32 s51, s51, s52
    s_cmp_eq_u32 s100, 0
    s_cbranch_scc1 L_safe_52
    s_add_u32 s52, s51, 0
    s_lshr_b32 s53, s52, 1
    s_lshl_b32 s53, s53, 10
    s_and_b32 s52, s52, 1
    s_lshl_b32 s52, s52, 3
    s_add_u32 s53, s53, s52
    s_add_u32 s53, s53, s50
    s_add_u32 s52, s53, 98304
    buffer_store_dwordx2 v[168:169], v152, s[24:27], s52 offen
    s_add_u32 s52, s53, 147456
    buffer_store_dwordx2 v[172:173], v152, s[24:27], s52 offen
    s_add_u32 s52, s51, 1
    s_lshr_b32 s53, s52, 1
    s_lshl_b32 s53, s53, 10
    s_and_b32 s52, s52, 1
    s_lshl_b32 s52, s52, 3
    s_add_u32 s53, s53, s52
    s_add_u32 s53, s53, s50
    s_add_u32 s52, s53, 98304
    buffer_store_dwordx2 v[176:177], v152, s[24:27], s52 offen
    s_add_u32 s52, s53, 147456
    buffer_store_dwordx2 v[180:181], v152, s[24:27], s52 offen
    s_add_u32 s52, s51, 2
    s_lshr_b32 s53, s52, 1
    s_lshl_b32 s53, s53, 10
    s_and_b32 s52, s52, 1
    s_lshl_b32 s52, s52, 3
    s_add_u32 s53, s53, s52
    s_add_u32 s53, s53, s50
    s_add_u32 s52, s53, 98304
    buffer_store_dwordx2 v[184:185], v152, s[24:27], s52 offen
    s_add_u32 s52, s53, 147456
    buffer_store_dwordx2 v[188:189], v152, s[24:27], s52 offen
    s_branch L_join_53
L_safe_52:
    s_add_u32 s52, s51, 0
    s_lshr_b32 s53, s52, 1
    s_lshl_b32 s53, s53, 10
    s_and_b32 s52, s52, 1
    s_lshl_b32 s52, s52, 3
    s_add_u32 s53, s53, s52
    s_add_u32 s53, s53, s50
    s_add_u32 s52, s53, 98304
    buffer_store_dwordx2 v[168:169], v152, s[24:27], s52 offen sc1
    s_add_u32 s52, s53, 147456
    buffer_store_dwordx2 v[172:173], v152, s[24:27], s52 offen sc1
    s_add_u32 s52, s51, 1
    s_lshr_b32 s53, s52, 1
    s_lshl_b32 s53, s53, 10
    s_and_b32 s52, s52, 1
    s_lshl_b32 s52, s52, 3
    s_add_u32 s53, s53, s52
    s_add_u32 s53, s53, s50
    s_add_u32 s52, s53, 98304
    buffer_store_dwordx2 v[176:177], v152, s[24:27], s52 offen sc1
    s_add_u32 s52, s53, 147456
    buffer_store_dwordx2 v[180:181], v152, s[24:27], s52 offen sc1
    s_add_u32 s52, s51, 2
    s_lshr_b32 s53, s52, 1
    s_lshl_b32 s53, s53, 10
    s_and_b32 s52, s52, 1
    s_lshl_b32 s52, s52, 3
    s_add_u32 s53, s53, s52
    s_add_u32 s53, s53, s50
    s_add_u32 s52, s53, 98304
    buffer_store_dwordx2 v[184:185], v152, s[24:27], s52 offen sc1
    s_add_u32 s52, s53, 147456
    buffer_store_dwordx2 v[188:189], v152, s[24:27], s52 offen sc1
L_join_53:
    s_waitcnt vmcnt(0)
    s_lshl_b32 s48, s41, 5
    s_add_u32 s48, s48, s42
    s_lshl_b32 s48, s48, 3
    s_add_u32 s48, s48, s40
    s_lshl_b32 s48, s48, 2
    s_add_u32 s48, s48, 32768
    v_mov_b32 v150, s45
    v_mov_b32 v151, 0
    s_mov_b64 exec, 1
    s_cmp_eq_u32 s100, 0
    s_cbranch_scc1 L_safe_54
    buffer_store_dword v150, v151, s[24:27], s48 offen
    s_branch L_join_55
L_safe_54:
    buffer_store_dword v150, v151, s[24:27], s48 offen sc1
L_join_55:
    s_mov_b64 exec, -1
    v_add_u32 v9, 0, v0
    v_mul_u32_u24 v10, 6554, v9
    v_lshrrev_b32 v10, 16, v10
    v_mul_u32_u24 v11, 10, v10
    v_sub_u32 v9, v9, v11
    v_and_b32 v11, 3, v10
    v_mul_u32_u24 v4, 1, v11
    v_bfe_u32 v11, v10, 2, 2
    v_mad_u32_u24 v4, v11, 4, v4
    v_lshrrev_b32 v11, 4, v10
    v_mad_u32_u24 v4, v11, 16, v4
    v_mul_u32_u24 v4, 1280, v4
    v_lshl_add_u32 v4, v9, 4, v4
    v_add_u32 v9, 64, v0
    v_mul_u32_u24 v10, 6554, v9
    v_lshrrev_b32 v10, 16, v10
    v_mul_u32_u24 v11, 10, v10
    v_sub_u32 v9, v9, v11
    v_and_b32 v11, 3, v10
    v_mul_u32_u24 v5, 1, v11
    v_bfe_u32 v11, v10, 2, 2
    v_mad_u32_u24 v5, v11, 4, v5
    v_lshrrev_b32 v11, 4, v10
    v_mad_u32_u24 v5, v11, 16, v5
    v_mul_u32_u24 v5, 1280, v5
    v_lshl_add_u32 v5, v9, 4, v5
    v_add_u32 v9, 128, v0
    v_mul_u32_u24 v10, 6554, v9
    v_lshrrev_b32 v10, 16, v10
    v_mul_u32_u24 v11, 10, v10
    v_sub_u32 v9, v9, v11
    v_and_b32 v11, 3, v10
    v_mul_u32_u24 v6, 1, v11
    v_bfe_u32 v11, v10, 2, 2
    v_mad_u32_u24 v6, v11, 4, v6
    v_lshrrev_b32 v11, 4, v10
    v_mad_u32_u24 v6, v11, 16, v6
    v_mul_u32_u24 v6, 1280, v6
    v_lshl_add_u32 v6, v9, 4, v6
    v_add_u32 v9, 192, v0
    v_mul_u32_u24 v10, 6554, v9
    v_lshrrev_b32 v10, 16, v10
    v_mul_u32_u24 v11, 10, v10
    v_sub_u32 v9, v9, v11
    v_and_b32 v11, 3, v10
    v_mul_u32_u24 v7, 1, v11
    v_bfe_u32 v11, v10, 2, 2
    v_mad_u32_u24 v7, v11, 4, v7
    v_lshrrev_b32 v11, 4, v10
    v_mad_u32_u24 v7, v11, 16, v7
    v_mul_u32_u24 v7, 1280, v7
    v_lshl_add_u32 v7, v9, 4, v7
    v_add_u32 v9, 256, v0
    v_mul_u32_u24 v10, 6554, v9
    v_lshrrev_b32 v10, 16, v10
    v_mul_u32_u24 v11, 10, v10
    v_sub_u32 v9, v9, v11
    v_and_b32 v11, 3, v10
    v_mul_u32_u24 v8, 1, v11
    v_bfe_u32 v11, v10, 2, 2
    v_mad_u32_u24 v8, v11, 4, v8
    v_lshrrev_b32 v11, 4, v10
    v_mad_u32_u24 v8, v11, 16, v8
    v_mul_u32_u24 v8, 1280, v8
    v_lshl_add_u32 v8, v9, 4, v8
    s_cmp_eq_u32 s40, 7
    s_nop 0
    s_cbranch_scc1 L_s5_w7_56
    s_mul_i32 s76, s59, 160
    s_cmp_lg_u32 s46, 0
    s_cbranch_scc1 L_s5_lw_58
    s_mov_b32 m0, 81920
    s_add_u32 s50, s76, 327680
    buffer_load_dwordx4 v4, s[20:23], s50 offen lds
    s_mov_b32 m0, 84992
    s_add_u32 s50, s76, 327680
    buffer_load_dwordx4 v7, s[20:23], s50 offen lds
    s_mov_b32 m0, 88064
    s_add_u32 s50, s76, 368640
    buffer_load_dwordx4 v5, s[20:23], s50 offen lds
    s_mov_b32 m0, 91136
    s_add_u32 s50, s76, 368640
    buffer_load_dwordx4 v8, s[20:23], s50 offen lds
    s_mov_b32 m0, 94208
    s_add_u32 s50, s76, 409600
    buffer_load_dwordx4 v6, s[20:23], s50 offen lds
    s_mov_b32 m0, 97280
    s_add_u32 s50, s76, 450560
    buffer_load_dwordx4 v4, s[20:23], s50 offen lds
    s_mov_b32 m0, 100352
    s_add_u32 s50, s76, 450560
    buffer_load_dwordx4 v7, s[20:23], s50 offen lds
    s_mov_b32 m0, 102400
    s_add_u32 s50, s76, 1310720
    buffer_load_dwordx4 v4, s[20:23], s50 offen lds
    s_mov_b32 m0, 105472
    s_add_u32 s50, s76, 1310720
    buffer_load_dwordx4 v7, s[20:23], s50 offen lds
    s_mov_b32 m0, 108544
    s_add_u32 s50, s76, 1351680
    buffer_load_dwordx4 v5, s[20:23], s50 offen lds
    s_mov_b32 m0, 111616
    s_add_u32 s50, s76, 1351680
    buffer_load_dwordx4 v8, s[20:23], s50 offen lds
    s_mov_b32 m0, 114688
    s_add_u32 s50, s76, 1392640
    buffer_load_dwordx4 v6, s[20:23], s50 offen lds
    s_mov_b32 m0, 117760
    s_add_u32 s50, s76, 1433600
    buffer_load_dwordx4 v4, s[20:23], s50 offen lds
    s_mov_b32 m0, 120832
    s_add_u32 s50, s76, 1433600
    buffer_load_dwordx4 v7, s[20:23], s50 offen lds
    s_mov_b32 m0, 122880
    s_add_u32 s50, s76, 491520
    buffer_load_dwordx4 v4, s[20:23], s50 offen lds
    s_mov_b32 m0, 125952
    s_add_u32 s50, s76, 491520
    buffer_load_dwordx4 v7, s[20:23], s50 offen lds
    s_mov_b32 m0, 129024
    s_add_u32 s50, s76, 532480
    buffer_load_dwordx4 v5, s[20:23], s50 offen lds
    s_mov_b32 m0, 132096
    s_add_u32 s50, s76, 532480
    buffer_load_dwordx4 v8, s[20:23], s50 offen lds
    s_mov_b32 m0, 135168
    s_add_u32 s50, s76, 573440
    buffer_load_dwordx4 v6, s[20:23], s50 offen lds
    s_mov_b32 m0, 138240
    s_add_u32 s50, s76, 614400
    buffer_load_dwordx4 v4, s[20:23], s50 offen lds
    s_mov_b32 m0, 141312
    s_add_u32 s50, s76, 614400
    buffer_load_dwordx4 v7, s[20:23], s50 offen lds
    s_waitcnt vmcnt(14)
    v_mov_b32 v12, 155664
    v_mov_b32 v13, 1
    s_mov_b64 exec, 1
    ds_add_u32 v12, v13
    s_mov_b64 exec, -1
    s_waitcnt vmcnt(7)
    v_mov_b32 v12, 155668
    v_mov_b32 v13, 1
    s_mov_b64 exec, 1
    ds_add_u32 v12, v13
    s_mov_b64 exec, -1
    v_mov_b32 v12, 155712
    s_mov_b32 s56, 0
    s_nop 0
L_lw_59:
    ds_read_b32 v13, v12
    s_waitcnt lgkmcnt(0)
    v_readfirstlane_b32 s79, v13
    s_nop 2
    s_cmp_ge_u32 s79, 4
    s_nop 0
    s_cbranch_scc1 L_lwd_60
    s_add_u32 s56, s56, 1
    s_cmp_lt_u32 s56, 4194304
    s_cbranch_scc1 L_lw_59
L_lwd_60:
    s_mov_b32 m0, 0
    s_add_u32 s50, s76, 1474560
    buffer_load_dwordx4 v4, s[20:23], s50 offen lds
    s_mov_b32 m0, 3072
    s_add_u32 s50, s76, 1474560
    buffer_load_dwordx4 v7, s[20:23], s50 offen lds
    s_mov_b32 m0, 6144
    s_add_u32 s50, s76, 1515520
    buffer_load_dwordx4 v5, s[20:23], s50 offen lds
    s_mov_b32 m0, 9216
    s_add_u32 s50, s76, 1515520
    buffer_load_dwordx4 v8, s[20:23], s50 offen lds
    s_mov_b32 m0, 12288
    s_add_u32 s50, s76, 1556480
    buffer_load_dwordx4 v6, s[20:23], s50 offen lds
    s_mov_b32 m0, 15360
    s_add_u32 s50, s76, 1597440
    buffer_load_dwordx4 v4, s[20:23], s50 offen lds
    s_mov_b32 m0, 18432
    s_add_u32 s50, s76, 1597440
    buffer_load_dwordx4 v7, s[20:23], s50 offen lds
    s_mov_b32 m0, 20480
    s_add_u32 s50, s76, 655360
    buffer_load_dwordx4 v4, s[20:23], s50 offen lds
    s_mov_b32 m0, 23552
    s_add_u32 s50, s76, 655360
    buffer_load_dwordx4 v7, s[20:23], s50 offen lds
    s_mov_b32 m0, 26624
    s_add_u32 s50, s76, 696320
    buffer_load_dwordx4 v5, s[20:23], s50 offen lds
    s_mov_b32 m0, 29696
    s_add_u32 s50, s76, 696320
    buffer_load_dwordx4 v8, s[20:23], s50 offen lds
    s_mov_b32 m0, 32768
    s_add_u32 s50, s76, 737280
    buffer_load_dwordx4 v6, s[20:23], s50 offen lds
    s_mov_b32 m0, 35840
    s_add_u32 s50, s76, 778240
    buffer_load_dwordx4 v4, s[20:23], s50 offen lds
    s_mov_b32 m0, 38912
    s_add_u32 s50, s76, 778240
    buffer_load_dwordx4 v7, s[20:23], s50 offen lds
    s_waitcnt vmcnt(14)
    v_mov_b32 v12, 155672
    v_mov_b32 v13, 1
    s_mov_b64 exec, 1
    ds_add_u32 v12, v13
    s_mov_b64 exec, -1
    v_mov_b32 v12, 155716
    s_mov_b32 s56, 0
    s_nop 0
L_lw_61:
    ds_read_b32 v13, v12
    s_waitcnt lgkmcnt(0)
    v_readfirstlane_b32 s79, v13
    s_nop 2
    s_cmp_ge_u32 s79, 4
    s_nop 0
    s_cbranch_scc1 L_lwd_62
    s_add_u32 s56, s56, 1
    s_cmp_lt_u32 s56, 4194304
    s_cbranch_scc1 L_lw_61
L_lwd_62:
    s_mov_b32 m0, 40960
    s_add_u32 s50, s76, 1638400
    buffer_load_dwordx4 v4, s[20:23], s50 offen lds
    s_mov_b32 m0, 44032
    s_add_u32 s50, s76, 1638400
    buffer_load_dwordx4 v7, s[20:23], s50 offen lds
    s_mov_b32 m0, 47104
    s_add_u32 s50, s76, 1679360
    buffer_load_dwordx4 v5, s[20:23], s50 offen lds
    s_mov_b32 m0, 50176
    s_add_u32 s50, s76, 1679360
    buffer_load_dwordx4 v8, s[20:23], s50 offen lds
    s_mov_b32 m0, 53248
    s_add_u32 s50, s76, 1720320
    buffer_load_dwordx4 v6, s[20:23], s50 offen lds
    s_mov_b32 m0, 56320
    s_add_u32 s50, s76, 1761280
    buffer_load_dwordx4 v4, s[20:23], s50 offen lds
    s_mov_b32 m0, 59392
    s_add_u32 s50, s76, 1761280
    buffer_load_dwordx4 v7, s[20:23], s50 offen lds
    s_mov_b32 m0, 61440
    s_add_u32 s50, s76, 819200
    buffer_load_dwordx4 v4, s[20:23], s50 offen lds
    s_mov_b32 m0, 64512
    s_add_u32 s50, s76, 819200
    buffer_load_dwordx4 v7, s[20:23], s50 offen lds
    s_mov_b32 m0, 67584
    s_add_u32 s50, s76, 860160
    buffer_load_dwordx4 v5, s[20:23], s50 offen lds
    s_mov_b32 m0, 70656
    s_add_u32 s50, s76, 860160
    buffer_load_dwordx4 v8, s[20:23], s50 offen lds
    s_mov_b32 m0, 73728
    s_add_u32 s50, s76, 901120
    buffer_load_dwordx4 v6, s[20:23], s50 offen lds
    s_mov_b32 m0, 76800
    s_add_u32 s50, s76, 942080
    buffer_load_dwordx4 v4, s[20:23], s50 offen lds
    s_mov_b32 m0, 79872
    s_add_u32 s50, s76, 942080
    buffer_load_dwordx4 v7, s[20:23], s50 offen lds
    s_waitcnt vmcnt(21)
    v_mov_b32 v12, 155676
    v_mov_b32 v13, 1
    s_mov_b64 exec, 1
    ds_add_u32 v12, v13
    s_mov_b64 exec, -1
    s_waitcnt vmcnt(14)
    v_mov_b32 v12, 155680
    v_mov_b32 v13, 1
    s_mov_b64 exec, 1
    ds_add_u32 v12, v13
    s_mov_b64 exec, -1
    v_mov_b32 v12, 155720
    s_mov_b32 s56, 0
    s_nop 0
L_lw_63:
    ds_read_b32 v13, v12
    s_waitcnt lgkmcnt(0)
    v_readfirstlane_b32 s79, v13
    s_nop 2
    s_cmp_ge_u32 s79, 4
    s_nop 0
    s_cbranch_scc1 L_lwd_64
    s_add_u32 s56, s56, 1
    s_cmp_lt_u32 s56, 4194304
    s_cbranch_scc1 L_lw_63
L_lwd_64:
    s_mov_b32 m0, 81920
    s_add_u32 s50, s76, 1802240
    buffer_load_dwordx4 v4, s[20:23], s50 offen lds
    s_mov_b32 m0, 84992
    s_add_u32 s50, s76, 1802240
    buffer_load_dwordx4 v7, s[20:23], s50 offen lds
    s_mov_b32 m0, 88064
    s_add_u32 s50, s76, 1843200
    buffer_load_dwordx4 v5, s[20:23], s50 offen lds
    s_mov_b32 m0, 91136
    s_add_u32 s50, s76, 1843200
    buffer_load_dwordx4 v8, s[20:23], s50 offen lds
    s_mov_b32 m0, 94208
    s_add_u32 s50, s76, 1884160
    buffer_load_dwordx4 v6, s[20:23], s50 offen lds
    s_mov_b32 m0, 97280
    s_add_u32 s50, s76, 1925120
    buffer_load_dwordx4 v4, s[20:23], s50 offen lds
    s_mov_b32 m0, 100352
    s_add_u32 s50, s76, 1925120
    buffer_load_dwordx4 v7, s[20:23], s50 offen lds
    s_waitcnt vmcnt(14)
    v_mov_b32 v12, 155684
    v_mov_b32 v13, 1
    s_mov_b64 exec, 1
    ds_add_u32 v12, v13
    s_mov_b64 exec, -1
    s_waitcnt vmcnt(7)
    v_mov_b32 v12, 155688
    v_mov_b32 v13, 1
    s_mov_b64 exec, 1
    ds_add_u32 v12, v13
    s_mov_b64 exec, -1
    s_waitcnt vmcnt(0)
    v_mov_b32 v12, 155692
    v_mov_b32 v13, 1
    s_mov_b64 exec, 1
    ds_add_u32 v12, v13
    s_mov_b64 exec, -1
    s_branch L_s5_lj_57
L_s5_lw_58:
    s_cmp_lg_u32 s46, 1
    s_cbranch_scc1 L_s5_lw_65
    s_mov_b32 m0, 82944
    s_add_u32 s50, s76, 327680
    buffer_load_dwordx4 v5, s[20:23], s50 offen lds
    s_mov_b32 m0, 86016
    s_add_u32 s50, s76, 327680
    buffer_load_dwordx4 v8, s[20:23], s50 offen lds
    s_mov_b32 m0, 89088
    s_add_u32 s50, s76, 368640
    buffer_load_dwordx4 v6, s[20:23], s50 offen lds
    s_mov_b32 m0, 92160
    s_add_u32 s50, s76, 409600
    buffer_load_dwordx4 v4, s[20:23], s50 offen lds
    s_mov_b32 m0, 95232
    s_add_u32 s50, s76, 409600
    buffer_load_dwordx4 v7, s[20:23], s50 offen lds
    s_mov_b32 m0, 98304
    s_add_u32 s50, s76, 450560
    buffer_load_dwordx4 v5, s[20:23], s50 offen lds
    s_mov_b32 m0, 101376
    s_add_u32 s50, s76, 450560
    buffer_load_dwordx4 v8, s[20:23], s50 offen lds
    s_mov_b32 m0, 103424
    s_add_u32 s50, s76, 1310720
    buffer_load_dwordx4 v5, s[20:23], s50 offen lds
    s_mov_b32 m0, 106496
    s_add_u32 s50, s76, 1310720
    buffer_load_dwordx4 v8, s[20:23], s50 offen lds
    s_mov_b32 m0, 109568
    s_add_u32 s50, s76, 1351680
    buffer_load_dwordx4 v6, s[20:23], s50 offen lds
    s_mov_b32 m0, 112640
    s_add_u32 s50, s76, 1392640
    buffer_load_dwordx4 v4, s[20:23], s50 offen lds
    s_mov_b32 m0, 115712
    s_add_u32 s50, s76, 1392640
    buffer_load_dwordx4 v7, s[20:23], s50 offen lds
    s_mov_b32 m0, 118784
    s_add_u32 s50, s76, 1433600
    buffer_load_dwordx4 v5, s[20:23], s50 offen lds
    s_mov_b32 m0, 121856
    s_add_u32 s50, s76, 1433600
    buffer_load_dwordx4 v8, s[20:23], s50 offen lds
    s_mov_b32 m0, 123904
    s_add_u32 s50, s76, 491520
    buffer_load_dwordx4 v5, s[20:23], s50 offen lds
    s_mov_b32 m0, 126976
    s_add_u32 s50, s76, 491520
    buffer_load_dwordx4 v8, s[20:23], s50 offen lds
    s_mov_b32 m0, 130048
    s_add_u32 s50, s76, 532480
    buffer_load_dwordx4 v6, s[20:23], s50 offen lds
    s_mov_b32 m0, 133120
    s_add_u32 s50, s76, 573440
    buffer_load_dwordx4 v4, s[20:23], s50 offen lds
    s_mov_b32 m0, 136192
    s_add_u32 s50, s76, 573440
    buffer_load_dwordx4 v7, s[20:23], s50 offen lds
    s_mov_b32 m0, 139264
    s_add_u32 s50, s76, 614400
    buffer_load_dwordx4 v5, s[20:23], s50 offen lds
    s_mov_b32 m0, 142336
    s_add_u32 s50, s76, 614400
    buffer_load_dwordx4 v8, s[20:23], s50 offen lds
    s_waitcnt vmcnt(14)
    v_mov_b32 v12, 155664
    v_mov_b32 v13, 1
    s_mov_b64 exec, 1
    ds_add_u32 v12, v13
    s_mov_b64 exec, -1
    s_waitcnt vmcnt(7)
    v_mov_b32 v12, 155668
    v_mov_b32 v13, 1
    s_mov_b64 exec, 1
    ds_add_u32 v12, v13
    s_mov_b64 exec, -1
    v_mov_b32 v12, 155712
    s_mov_b32 s56, 0
    s_nop 0
L_lw_66:
    ds_read_b32 v13, v12
    s_waitcnt lgkmcnt(0)
    v_readfirstlane_b32 s79, v13
    s_nop 2
    s_cmp_ge_u32 s79, 4
    s_nop 0
    s_cbranch_scc1 L_lwd_67
    s_add_u32 s56, s56, 1
    s_cmp_lt_u32 s56, 4194304
    s_cbranch_scc1 L_lw_66
L_lwd_67:
    s_mov_b32 m0, 1024
    s_add_u32 s50, s76, 1474560
    buffer_load_dwordx4 v5, s[20:23], s50 offen lds
    s_mov_b32 m0, 4096
    s_add_u32 s50, s76, 1474560
    buffer_load_dwordx4 v8, s[20:23], s50 offen lds
    s_mov_b32 m0, 7168
    s_add_u32 s50, s76, 1515520
    buffer_load_dwordx4 v6, s[20:23], s50 offen lds
    s_mov_b32 m0, 10240
    s_add_u32 s50, s76, 1556480
    buffer_load_dwordx4 v4, s[20:23], s50 offen lds
    s_mov_b32 m0, 13312
    s_add_u32 s50, s76, 1556480
    buffer_load_dwordx4 v7, s[20:23], s50 offen lds
    s_mov_b32 m0, 16384
    s_add_u32 s50, s76, 1597440
    buffer_load_dwordx4 v5, s[20:23], s50 offen lds
    s_mov_b32 m0, 19456
    s_add_u32 s50, s76, 1597440
    buffer_load_dwordx4 v8, s[20:23], s50 offen lds
    s_mov_b32 m0, 21504
    s_add_u32 s50, s76, 655360
    buffer_load_dwordx4 v5, s[20:23], s50 offen lds
    s_mov_b32 m0, 24576
    s_add_u32 s50, s76, 655360
    buffer_load_dwordx4 v8, s[20:23], s50 offen lds
    s_mov_b32 m0, 27648
    s_add_u32 s50, s76, 696320
    buffer_load_dwordx4 v6, s[20:23], s50 offen lds
    s_mov_b32 m0, 30720
    s_add_u32 s50, s76, 737280
    buffer_load_dwordx4 v4, s[20:23], s50 offen lds
    s_mov_b32 m0, 33792
    s_add_u32 s50, s76, 737280
    buffer_load_dwordx4 v7, s[20:23], s50 offen lds
    s_mov_b32 m0, 36864
    s_add_u32 s50, s76, 778240
    buffer_load_dwordx4 v5, s[20:23], s50 offen lds
    s_mov_b32 m0, 39936
    s_add_u32 s50, s76, 778240
    buffer_load_dwordx4 v8, s[20:23], s50 offen lds
    s_waitcnt vmcnt(14)
    v_mov_b32 v12, 155672
    v_mov_b32 v13, 1
    s_mov_b64 exec, 1
    ds_add_u32 v12, v13
    s_mov_b64 exec, -1
    v_mov_b32 v12, 155716
    s_mov_b32 s56, 0
    s_nop 0
L_lw_68:
    ds_read_b32 v13, v12
    s_waitcnt lgkmcnt(0)
    v_readfirstlane_b32 s79, v13
    s_nop 2
    s_cmp_ge_u32 s79, 4
    s_nop 0
    s_cbranch_scc1 L_lwd_69
    s_add_u32 s56, s56, 1
    s_cmp_lt_u32 s56, 4194304
    s_cbranch_scc1 L_lw_68
L_lwd_69:
    s_mov_b32 m0, 41984
    s_add_u32 s50, s76, 1638400
    buffer_load_dwordx4 v5, s[20:23], s50 offen lds
    s_mov_b32 m0, 45056
    s_add_u32 s50, s76, 1638400
    buffer_load_dwordx4 v8, s[20:23], s50 offen lds
    s_mov_b32 m0, 48128
    s_add_u32 s50, s76, 1679360
    buffer_load_dwordx4 v6, s[20:23], s50 offen lds
    s_mov_b32 m0, 51200
    s_add_u32 s50, s76, 1720320
    buffer_load_dwordx4 v4, s[20:23], s50 offen lds
    s_mov_b32 m0, 54272
    s_add_u32 s50, s76, 1720320
    buffer_load_dwordx4 v7, s[20:23], s50 offen lds
    s_mov_b32 m0, 57344
    s_add_u32 s50, s76, 1761280
    buffer_load_dwordx4 v5, s[20:23], s50 offen lds
    s_mov_b32 m0, 60416
    s_add_u32 s50, s76, 1761280
    buffer_load_dwordx4 v8, s[20:23], s50 offen lds
    s_mov_b32 m0, 62464
    s_add_u32 s50, s76, 819200
    buffer_load_dwordx4 v5, s[20:23], s50 offen lds
    s_mov_b32 m0, 65536
    s_add_u32 s50, s76, 819200
    buffer_load_dwordx4 v8, s[20:23], s50 offen lds
    s_mov_b32 m0, 68608
    s_add_u32 s50, s76, 860160
    buffer_load_dwordx4 v6, s[20:23], s50 offen lds
    s_mov_b32 m0, 71680
    s_add_u32 s50, s76, 901120
    buffer_load_dwordx4 v4, s[20:23], s50 offen lds
    s_mov_b32 m0, 74752
    s_add_u32 s50, s76, 901120
    buffer_load_dwordx4 v7, s[20:23], s50 offen lds
    s_mov_b32 m0, 77824
    s_add_u32 s50, s76, 942080
    buffer_load_dwordx4 v5, s[20:23], s50 offen lds
    s_mov_b32 m0, 80896
    s_add_u32 s50, s76, 942080
    buffer_load_dwordx4 v8, s[20:23], s50 offen lds
    s_waitcnt vmcnt(21)
    v_mov_b32 v12, 155676
    v_mov_b32 v13, 1
    s_mov_b64 exec, 1
    ds_add_u32 v12, v13
    s_mov_b64 exec, -1
    s_waitcnt vmcnt(14)
    v_mov_b32 v12, 155680
    v_mov_b32 v13, 1
    s_mov_b64 exec, 1
    ds_add_u32 v12, v13
    s_mov_b64 exec, -1
    v_mov_b32 v12, 155720
    s_mov_b32 s56, 0
    s_nop 0
L_lw_70:
    ds_read_b32 v13, v12
    s_waitcnt lgkmcnt(0)
    v_readfirstlane_b32 s79, v13
    s_nop 2
    s_cmp_ge_u32 s79, 4
    s_nop 0
    s_cbranch_scc1 L_lwd_71
    s_add_u32 s56, s56, 1
    s_cmp_lt_u32 s56, 4194304
    s_cbranch_scc1 L_lw_70
L_lwd_71:
    s_mov_b32 m0, 82944
    s_add_u32 s50, s76, 1802240
    buffer_load_dwordx4 v5, s[20:23], s50 offen lds
    s_mov_b32 m0, 86016
    s_add_u32 s50, s76, 1802240
    buffer_load_dwordx4 v8, s[20:23], s50 offen lds
    s_mov_b32 m0, 89088
    s_add_u32 s50, s76, 1843200
    buffer_load_dwordx4 v6, s[20:23], s50 offen lds
    s_mov_b32 m0, 92160
    s_add_u32 s50, s76, 1884160
    buffer_load_dwordx4 v4, s[20:23], s50 offen lds
    s_mov_b32 m0, 95232
    s_add_u32 s50, s76, 1884160
    buffer_load_dwordx4 v7, s[20:23], s50 offen lds
    s_mov_b32 m0, 98304
    s_add_u32 s50, s76, 1925120
    buffer_load_dwordx4 v5, s[20:23], s50 offen lds
    s_mov_b32 m0, 101376
    s_add_u32 s50, s76, 1925120
    buffer_load_dwordx4 v8, s[20:23], s50 offen lds
    s_waitcnt vmcnt(14)
    v_mov_b32 v12, 155684
    v_mov_b32 v13, 1
    s_mov_b64 exec, 1
    ds_add_u32 v12, v13
    s_mov_b64 exec, -1
    s_waitcnt vmcnt(7)
    v_mov_b32 v12, 155688
    v_mov_b32 v13, 1
    s_mov_b64 exec, 1
    ds_add_u32 v12, v13
    s_mov_b64 exec, -1
    s_waitcnt vmcnt(0)
    v_mov_b32 v12, 155692
    v_mov_b32 v13, 1
    s_mov_b64 exec, 1
    ds_add_u32 v12, v13
    s_mov_b64 exec, -1
    s_branch L_s5_lj_57
L_s5_lw_65:
    s_cmp_lg_u32 s46, 2
    s_cbranch_scc1 L_s5_lw_72
    s_mov_b32 m0, 83968
    s_add_u32 s50, s76, 327680
    buffer_load_dwordx4 v6, s[20:23], s50 offen lds
    s_mov_b32 m0, 87040
    s_add_u32 s50, s76, 368640
    buffer_load_dwordx4 v4, s[20:23], s50 offen lds
    s_mov_b32 m0, 90112
    s_add_u32 s50, s76, 368640
    buffer_load_dwordx4 v7, s[20:23], s50 offen lds
    s_mov_b32 m0, 93184
    s_add_u32 s50, s76, 409600
    buffer_load_dwordx4 v5, s[20:23], s50 offen lds
    s_mov_b32 m0, 96256
    s_add_u32 s50, s76, 409600
    buffer_load_dwordx4 v8, s[20:23], s50 offen lds
    s_mov_b32 m0, 99328
    s_add_u32 s50, s76, 450560
    buffer_load_dwordx4 v6, s[20:23], s50 offen lds
    s_mov_b32 m0, 104448
    s_add_u32 s50, s76, 1310720
    buffer_load_dwordx4 v6, s[20:23], s50 offen lds
    s_mov_b32 m0, 107520
    s_add_u32 s50, s76, 1351680
    buffer_load_dwordx4 v4, s[20:23], s50 offen lds
    s_mov_b32 m0, 110592
    s_add_u32 s50, s76, 1351680
    buffer_load_dwordx4 v7, s[20:23], s50 offen lds
    s_mov_b32 m0, 113664
    s_add_u32 s50, s76, 1392640
    buffer_load_dwordx4 v5, s[20:23], s50 offen lds
    s_mov_b32 m0, 116736
    s_add_u32 s50, s76, 1392640
    buffer_load_dwordx4 v8, s[20:23], s50 offen lds
    s_mov_b32 m0, 119808
    s_add_u32 s50, s76, 1433600
    buffer_load_dwordx4 v6, s[20:23], s50 offen lds
    s_mov_b32 m0, 124928
    s_add_u32 s50, s76, 491520
    buffer_load_dwordx4 v6, s[20:23], s50 offen lds
    s_mov_b32 m0, 128000
    s_add_u32 s50, s76, 532480
    buffer_load_dwordx4 v4, s[20:23], s50 offen lds
    s_mov_b32 m0, 131072
    s_add_u32 s50, s76, 532480
    buffer_load_dwordx4 v7, s[20:23], s50 offen lds
    s_mov_b32 m0, 134144
    s_add_u32 s50, s76, 573440
    buffer_load_dwordx4 v5, s[20:23], s50 offen lds
    s_mov_b32 m0, 137216
    s_add_u32 s50, s76, 573440
    buffer_load_dwordx4 v8, s[20:23], s50 offen lds
    s_mov_b32 m0, 140288
    s_add_u32 s50, s76, 614400
    buffer_load_dwordx4 v6, s[20:23], s50 offen lds
    s_waitcnt vmcnt(12)
    v_mov_b32 v12, 155664
    v_mov_b32 v13, 1
    s_mov_b64 exec, 1
    ds_add_u32 v12, v13
    s_mov_b64 exec, -1
    s_waitcnt vmcnt(6)
    v_mov_b32 v12, 155668
    v_mov_b32 v13, 1
    s_mov_b64 exec, 1
    ds_add_u32 v12, v13
    s_mov_b64 exec, -1
    v_mov_b32 v12, 155712
    s_mov_b32 s56, 0
    s_nop 0
L_lw_73:
    ds_read_b32 v13, v12
    s_waitcnt lgkmcnt(0)
    v_readfirstlane_b32 s79, v13
    s_nop 2
    s_cmp_ge_u32 s79, 4
    s_nop 0
    s_cbranch_scc1 L_lwd_74
    s_add_u32 s56, s56, 1
    s_cmp_lt_u32 s56, 4194304
    s_cbranch_scc1 L_lw_73
L_lwd_74:
    s_mov_b32 m0, 2048
    s_add_u32 s50, s76, 1474560
    buffer_load_dwordx4 v6, s[20:23], s50 offen lds
    s_mov_b32 m0, 5120
    s_add_u32 s50, s76, 1515520
    buffer_load_dwordx4 v4, s[20:23], s50 offen lds
    s_mov_b32 m0, 8192
    s_add_u32 s50, s76, 1515520
    buffer_load_dwordx4 v7, s[20:23], s50 offen lds
    s_mov_b32 m0, 11264
    s_add_u32 s50, s76, 1556480
    buffer_load_dwordx4 v5, s[20:23], s50 offen lds
    s_mov_b32 m0, 14336
    s_add_u32 s50, s76, 1556480
    buffer_load_dwordx4 v8, s[20:23], s50 offen lds
    s_mov_b32 m0, 17408
    s_add_u32 s50, s76, 1597440
    buffer_load_dwordx4 v6, s[20:23], s50 offen lds
    s_mov_b32 m0, 22528
    s_add_u32 s50, s76, 655360
    buffer_load_dwordx4 v6, s[20:23], s50 offen lds
    s_mov_b32 m0, 25600
    s_add_u32 s50, s76, 696320
    buffer_load_dwordx4 v4, s[20:23], s50 offen lds
    s_mov_b32 m0, 28672
    s_add_u32 s50, s76, 696320
    buffer_load_dwordx4 v7, s[20:23], s50 offen lds
    s_mov_b32 m0, 31744
    s_add_u32 s50, s76, 737280
    buffer_load_dwordx4 v5, s[20:23], s50 offen lds
    s_mov_b32 m0, 34816
    s_add_u32 s50, s76, 737280
    buffer_load_dwordx4 v8, s[20:23], s50 offen lds
    s_mov_b32 m0, 37888
    s_add_u32 s50, s76, 778240
    buffer_load_dwordx4 v6, s[20:23], s50 offen lds
    s_waitcnt vmcnt(12)
    v_mov_b32 v12, 155672
    v_mov_b32 v13, 1
    s_mov_b64 exec, 1
    ds_add_u32 v12, v13
    s_mov_b64 exec, -1
    v_mov_b32 v12, 155716
    s_mov_b32 s56, 0
    s_nop 0
L_lw_75:
    ds_read_b32 v13, v12
    s_waitcnt lgkmcnt(0)
    v_readfirstlane_b32 s79, v13
    s_nop 2
    s_cmp_ge_u32 s79, 4
    s_nop 0
    s_cbranch_scc1 L_lwd_76
    s_add_u32 s56, s56, 1
    s_cmp_lt_u32 s56, 4194304
    s_cbranch_scc1 L_lw_75
L_lwd_76:
    s_mov_b32 m0, 43008
    s_add_u32 s50, s76, 1638400
    buffer_load_dwordx4 v6, s[20:23], s50 offen lds
    s_mov_b32 m0, 46080
    s_add_u32 s50, s76, 1679360
    buffer_load_dwordx4 v4, s[20:23], s50 offen lds
    s_mov_b32 m0, 49152
    s_add_u32 s50, s76, 1679360
    buffer_load_dwordx4 v7, s[20:23], s50 offen lds
    s_mov_b32 m0, 52224
    s_add_u32 s50, s76, 1720320
    buffer_load_dwordx4 v5, s[20:23], s50 offen lds
    s_mov_b32 m0, 55296
    s_add_u32 s50, s76, 1720320
    buffer_load_dwordx4 v8, s[20:23], s50 offen lds
    s_mov_b32 m0, 58368
    s_add_u32 s50, s76, 1761280
    buffer_load_dwordx4 v6, s[20:23], s50 offen lds
    s_mov_b32 m0, 63488
    s_add_u32 s50, s76, 819200
    buffer_load_dwordx4 v6, s[20:23], s50 offen lds
    s_mov_b32 m0, 66560
    s_add_u32 s50, s76, 860160
    buffer_load_dwordx4 v4, s[20:23], s50 offen lds
    s_mov_b32 m0, 69632
    s_add_u32 s50, s76, 860160
    buffer_load_dwordx4 v7, s[20:23], s50 offen lds
    s_mov_b32 m0, 72704
    s_add_u32 s50, s76, 901120
    buffer_load_dwordx4 v5, s[20:23], s50 offen lds
    s_mov_b32 m0, 75776
    s_add_u32 s50, s76, 901120
    buffer_load_dwordx4 v8, s[20:23], s50 offen lds
    s_mov_b32 m0, 78848
    s_add_u32 s50, s76, 942080
    buffer_load_dwordx4 v6, s[20:23], s50 offen lds
    s_waitcnt vmcnt(18)
    v_mov_b32 v12, 155676
    v_mov_b32 v13, 1
    s_mov_b64 exec, 1
    ds_add_u32 v12, v13
    s_mov_b64 exec, -1
    s_waitcnt vmcnt(12)
    v_mov_b32 v12, 155680
    v_mov_b32 v13, 1
    s_mov_b64 exec, 1
    ds_add_u32 v12, v13
    s_mov_b64 exec, -1
    v_mov_b32 v12, 155720
    s_mov_b32 s56, 0
    s_nop 0
L_lw_77:
    ds_read_b32 v13, v12
    s_waitcnt lgkmcnt(0)
    v_readfirstlane_b32 s79, v13
    s_nop 2
    s_cmp_ge_u32 s79, 4
    s_nop 0
    s_cbranch_scc1 L_lwd_78
    s_add_u32 s56, s56, 1
    s_cmp_lt_u32 s56, 4194304
    s_cbranch_scc1 L_lw_77
L_lwd_78:
    s_mov_b32 m0, 83968
    s_add_u32 s50, s76, 1802240
    buffer_load_dwordx4 v6, s[20:23], s50 offen lds
    s_mov_b32 m0, 87040
    s_add_u32 s50, s76, 1843200
    buffer_load_dwordx4 v4, s[20:23], s50 offen lds
    s_mov_b32 m0, 90112
    s_add_u32 s50, s76, 1843200
    buffer_load_dwordx4 v7, s[20:23], s50 offen lds
    s_mov_b32 m0, 93184
    s_add_u32 s50, s76, 1884160
    buffer_load_dwordx4 v5, s[20:23], s50 offen lds
    s_mov_b32 m0, 96256
    s_add_u32 s50, s76, 1884160
    buffer_load_dwordx4 v8, s[20:23], s50 offen lds
    s_mov_b32 m0, 99328
    s_add_u32 s50, s76, 1925120
    buffer_load_dwordx4 v6, s[20:23], s50 offen lds
    s_waitcnt vmcnt(12)
    v_mov_b32 v12, 155684
    v_mov_b32 v13, 1
    s_mov_b64 exec, 1
    ds_add_u32 v12, v13
    s_mov_b64 exec, -1
    s_waitcnt vmcnt(6)
    v_mov_b32 v12, 155688
    v_mov_b32 v13, 1
    s_mov_b64 exec, 1
    ds_add_u32 v12, v13
    s_mov_b64 exec, -1
    s_waitcnt vmcnt(0)
    v_mov_b32 v12, 155692
    v_mov_b32 v13, 1
    s_mov_b64 exec, 1
    ds_add_u32 v12, v13
    s_mov_b64 exec, -1
    s_branch L_s5_lj_57
L_s5_lw_72:
L_s5_w7_56:
    v_mov_b32 v12, 155712
    s_mov_b32 s56, 0
    s_nop 0
L_lw_79:
    ds_read_b32 v13, v12
    s_waitcnt lgkmcnt(0)
    v_readfirstlane_b32 s79, v13
    s_nop 2
    s_cmp_ge_u32 s79, 4
    s_nop 0
    s_cbranch_scc1 L_lwd_80
    s_add_u32 s56, s56, 1
    s_cmp_lt_u32 s56, 4194304
    s_cbranch_scc1 L_lw_79
L_lwd_80:
    s_cmp_lg_u32 s42, 0
    s_cbranch_scc1 L_nowb_81
    s_cmp_lg_u32 s40, 7
    s_cbranch_scc1 L_nowb_81
    buffer_wbl2 sc1
L_nowb_81:
    v_mov_b32 v12, 155720
    s_mov_b32 s56, 0
    s_nop 0
L_lw_82:
    ds_read_b32 v13, v12
    s_waitcnt lgkmcnt(0)
    v_readfirstlane_b32 s79, v13
    s_nop 2
    s_cmp_ge_u32 s79, 4
    s_nop 0
    s_cbranch_scc1 L_lwd_83
    s_add_u32 s56, s56, 1
    s_cmp_lt_u32 s56, 4194304
    s_cbranch_scc1 L_lw_82
L_lwd_83:
    s_cmp_lg_u32 s42, 0
    s_cbranch_scc1 L_nowb_84
    s_cmp_lg_u32 s40, 7
    s_cbranch_scc1 L_nowb_84
    buffer_wbl2 sc1
L_nowb_84:
L_s5_lj_57:
    s_barrier
    s_barrier
L_rest_done:
    s_cmp_lg_u32 s2, 0
    s_cbranch_scc1 L_noepoch_85
    s_cmp_lg_u32 s40, 4
    s_cbranch_scc1 L_noepoch_85
    v_lshlrev_b32 v10, 2, v0
    v_add_u32 v10, 0, v10
    v_lshlrev_b32 v11, 2, v0
    v_add_u32 v11, 256, v11
    v_lshlrev_b32 v12, 2, v0
    v_add_u32 v12, 512, v12
    v_lshlrev_b32 v13, 2, v0
    v_add_u32 v13, 768, v13
    s_mov_b32 s56, 0
    s_nop 0
L_poll_86:
    buffer_load_dword v14, v10, s[24:27], 0 offen sc1
    buffer_load_dword v15, v11, s[24:27], 0 offen sc1
    buffer_load_dword v16, v12, s[24:27], 0 offen sc1
    buffer_load_dword v17, v13, s[24:27], 0 offen sc1
    s_waitcnt vmcnt(0)
    v_subrev_u32 v14, s45, v14
    v_subrev_u32 v15, s45, v15
    v_subrev_u32 v16, s45, v16
    v_subrev_u32 v17, s45, v17
    v_or_b32 v18, v14, v15
    v_or_b32 v18, v18, v16
    v_or_b32 v18, v18, v17
    v_cmp_le_u32 vcc, 8, v18
    s_nop 2
    s_cmp_eq_u64 vcc, 0
    s_nop 0
    s_cbranch_scc1 L_polldone_87
    s_add_u32 s56, s56, 1
    s_cmp_lt_u32 s56, 131072
    s_cbranch_scc0 L_polldone_87
    s_branch L_poll_86
L_polldone_87:
    s_mov_b32 s48, 20480
    v_mov_b32 v1, s45
    v_mov_b32 v2, 0
    s_mov_b64 exec, 1
    buffer_store_dword v1, v2, s[24:27], s48 offen sc1
    s_mov_b64 exec, -1
L_noepoch_85:
L_exit:
    s_endpgm
.section .rodata,"a"
.p2align 6
.amdhsa_kernel sequential_preLN__sliding_block__mixer_channel_mlp__prompt_kernel
  .amdhsa_next_free_vgpr 256
  .amdhsa_next_free_sgpr 102
  .amdhsa_accum_offset 256
  .amdhsa_group_segment_fixed_size 0
  .amdhsa_kernarg_size 88
  .amdhsa_user_sgpr_count 2
  .amdhsa_user_sgpr_kernarg_segment_ptr 1
  .amdhsa_system_sgpr_workgroup_id_x 1
.end_amdhsa_kernel
```
